```python
import torch

def _softmax(x, axis=-1):
    return torch.softmax(x, dim=axis)
def _gelu(x):
    return torch.nn.functional.gelu(x, approximate="tanh")
def _silu(x):
    return torch.nn.functional.silu(x)
def _sigmoid(x):
    return torch.sigmoid(x)
def _layernorm(x, axis=-1, eps=1e-5):
    m = x.mean(dim=axis, keepdim=True)
    v = x.var(dim=axis, keepdim=True, unbiased=False)
    return (x - m) / torch.sqrt(v + eps)
def _scatter_add(tgt, idx, src, axis=0):
    return tgt.clone().index_add_(axis, idx, src)
def _segment_sum(src, seg, n):
    out = torch.zeros((n,) + src.shape[1:], dtype=src.dtype)
    return out.index_add_(0, seg, src)
def _pad(x, pw):
    flat = tuple(v for pair in reversed(pw) for v in pair)
    return torch.nn.functional.pad(x, flat)

kernel_name = 'parallel_sum__ssm_conv_s4__mixer_channel_mlp__prompt'

def setup_inputs():

    _w = (lambda a: (lambda t: t.to(torch.bfloat16) if t.is_floating_point() else t)(torch.as_tensor(a)))
    def _A_setup():
        B, L, D, N = 1, 2048, 640, 192
        A_re = -(lambda _x: torch.exp(torch.as_tensor(_x)))((lambda *s: torch.randn(*s, dtype=torch.bfloat16) * 3.2)(D, N))
        A_im = torch.pi * (lambda *s: torch.randn(*s, dtype=torch.bfloat16) * 0.05)(D, N)
        B_re = (lambda *s: torch.randn(*s, dtype=torch.bfloat16) * 0.1)(D, N)
        B_im = (lambda *s: torch.randn(*s, dtype=torch.bfloat16) * 0.1)(D, N)
        C_re = (lambda *s: torch.randn(*s, dtype=torch.bfloat16) * 0.1)(D, N)
        C_im = (lambda *s: torch.randn(*s, dtype=torch.bfloat16) * 0.1)(D, N)
        log_dt = (lambda *s: torch.randn(*s, dtype=torch.bfloat16) * 0.05)(D) * 0.5 - 4.0
        Dskip = (lambda *s: torch.randn(*s, dtype=torch.bfloat16) * 0.05)(D)
        return {
            "u": _w((lambda *s: torch.randn(*s, dtype=torch.bfloat16) * 0.05)(B, L, D)),
            "A_re": _w(A_re),
            "A_im": _w(A_im),
            "B_re": _w(B_re),
            "B_im": _w(B_im),
            "C_re": _w(C_re),
            "C_im": _w(C_im),
            "log_dt": _w(log_dt),
            "Dskip": _w(Dskip),
        }
    _A_in = _A_setup()

    def _B_setup():
        B, S, D, F = 1, 2048, 640, 1536
        return {
            "x": _w((lambda *s: torch.randn(*s, dtype=torch.bfloat16) * 0.05)(B, S, D)),
            "w1": _w((lambda *s: torch.randn(*s, dtype=torch.bfloat16) * 1.6)(D, F) * (D ** -0.5)),
            "b1": _w((lambda *s: torch.randn(*s, dtype=torch.bfloat16) * 0.8)(F)),
            "w2": _w((lambda *s: torch.randn(*s, dtype=torch.bfloat16) * 0.05)(F, D) * (F ** -0.5)),
            "b2": _w((lambda *s: torch.randn(*s, dtype=torch.bfloat16) * 0.05)(D)),
        }
    _B_in = _B_setup()

    return {
        "A_u": _A_in["u"],
        "A_A_re": _A_in["A_re"],
        "A_A_im": _A_in["A_im"],
        "A_B_re": _A_in["B_re"],
        "A_B_im": _A_in["B_im"],
        "A_C_re": _A_in["C_re"],
        "A_C_im": _A_in["C_im"],
        "A_log_dt": _A_in["log_dt"],
        "A_Dskip": _A_in["Dskip"],
        "B_x": _B_in["x"],
        "B_w1": _B_in["w1"],
        "B_b1": _B_in["b1"],
        "B_w2": _B_in["w2"],
        "B_b2": _B_in["b2"],
    }

def reference(A_u, A_A_re, A_A_im, A_B_re, A_B_im, A_C_re, A_C_im, A_log_dt, A_Dskip, B_x, B_w1, B_b1, B_w2, B_b2):
    def _A_ref(u, A_re, A_im, B_re, B_im, C_re, C_im, log_dt, Dskip):
        Bsz, L, D = u.shape
        dt = torch.exp(log_dt)[:, None]
        A = A_re + 1j * A_im
        Bc = B_re + 1j * B_im
        Cc = C_re + 1j * C_im
        logdA = dt * A
        dB = dt * Bc
        l = (lambda x, dt: x.to(dt))(torch.arange(L), A_re.dtype)
        P = torch.exp(logdA[:, :, None] * l[None, None, :])
        K = torch.einsum("dn,dnl,dn->dl", Cc, P, dB).real
        L2 = 2 * L
        Kp = _pad(K, ((0, 0), (0, L)))
        up = (lambda x, *d: x.permute(*d))(u, 0, 2, 1)
        up = _pad(up, ((0, 0), (0, 0), (0, L)))
        Kf = (lambda x, axes=(-2,-1): torch.fft.rfft2(x.float(), dim=axes))(Kp[:, None, :], axes=(-2, -1))
        Uf = (lambda x, axes=(-2,-1): torch.fft.rfft2(x.float(), dim=axes))(up[:, :, None, :], axes=(-2, -1))
        Yf = Uf * Kf[None, :, :, :]
        y = (lambda x, s, axes=(-2,-1): torch.fft.irfft2(x, s=s, dim=axes).to(torch.bfloat16))(Yf, (1, L2), axes=(-2, -1))[:, :, 0, :L]
        y = (lambda x, *d: x.permute(*d))(y, 0, 2, 1) + u * Dskip[None, None, :]
        return y

    def _B_ref(x, w1, b1, w2, b2):
        y = _layernorm(x, axis=-1)
        h = _gelu(torch.einsum("bsd,df->bsf", y, w1) + b1)
        return torch.einsum("bsf,fd->bsd", h, w2) + b2

    x = A_u
    xn = _layernorm(x, axis=-1)
    return x + _A_ref(xn, A_A_re, A_A_im, A_B_re, A_B_im, A_C_re, A_C_im, A_log_dt, A_Dskip) + _B_ref(xn, B_w1, B_b1, B_w2, B_b2)
```

```asm
; @launch grid=(256,1,1) block=(512,1,1) lds=163840
.amdgcn_target "amdgcn-amd-amdhsa--gfx950"
.text
.globl parallel_sum__ssm_conv_s4__mixer_channel_mlp__prompt_kernel
.p2align 8
.type parallel_sum__ssm_conv_s4__mixer_channel_mlp__prompt_kernel,@function
parallel_sum__ssm_conv_s4__mixer_channel_mlp__prompt_kernel:
    s_cmp_ge_u32 s2, 256
    s_cbranch_scc1 L_end
    s_load_dwordx16 s[16:31], s[0:1], 0
    s_load_dwordx16 s[32:47], s[0:1], 64
    s_load_dwordx2 s[48:49], s[0:1], 128
    s_getpc_b64 s[50:51]
L_pc:
    v_lshrrev_b32 v6, 6, v0
    v_and_b32 v1, 63, v0
    v_readfirstlane_b32 s100, v6
    s_and_b32 s4, s2, 7
    s_lshr_b32 s5, s2, 3
    s_lshl_b32 s12, s5, 11
    v_lshl_add_u32 v6, v0, 2, s12
    v_min_u32 v6, L_table_end-L_pc-8, v6
    global_load_dword v7, v6, s[50:51]
    s_lshl_b32 s13, 1, s5
    s_sub_u32 s13, s13, 1
    s_and_b32 s13, s13, 2233830435
    s_bcnt1_i32_b32 s9, s13
    s_sub_u32 s13, s5, s9
    s_min_u32 s13, s13, 15
    s_lshl_b32 s6, s4, 4
    s_add_u32 s6, s6, s13
    s_mul_i32 s12, s6, 20480
    v_lshrrev_b32 v9, 5, v0
    v_lshlrev_b32 v9, 10, v9
    v_lshl_add_u32 v9, v0, 3, v9
    v_add_u32 v9, s12, v9
    s_add_u32 s50, s50, L_table-L_pc
    s_addc_u32 s51, s51, 0
    v_lshlrev_b32 v2, 4, v1
    v_and_b32 v0, 255, v0
    v_mov_b32 v4, 1
    v_mov_b32 v5, 40704
    v_mov_b32 v12, 0
    v_lshl_add_u32 v6, v1, 2, v5
    ds_write_b32 v6, v12
    v_mov_b32 v6, 0x7ffffff0
    v_cmp_eq_u32 vcc, 0, v1
    s_and_b32 s3, s100, 3
    s_lshl_b32 s101, s2, 3
    v_cndmask_b32 v3, v6, v1, vcc
    s_add_u32 s101, s101, s100
    s_bitcmp1_b32 2233830435, s5
    s_waitcnt lgkmcnt(0)
    s_cbranch_scc1 L_G
    global_load_dwordx2 v[48:49], v9, s[16:17] offset:0
    global_load_dwordx2 v[50:51], v9, s[16:17] offset:256
    global_load_dwordx2 v[52:53], v9, s[16:17] offset:512
    global_load_dwordx2 v[54:55], v9, s[16:17] offset:768
    global_load_dwordx2 v[56:57], v9, s[16:17] offset:1024
    s_sub_u32 s9, s5, s9
    s_mul_i32 s11, s4, 20
    s_add_u32 s11, s11, s9
    s_and_b32 s12, s9, 1
    s_lshl_b32 s7, s4, 1
    s_add_u32 s7, s7, s12
    s_lshr_b32 s10, s9, 1
    s_cmp_ge_u32 s100, 4
    s_cbranch_scc1 L_SC
    s_mov_b32 s62, 268435456
    s_mov_b32 s63, 0x20000
    s_mov_b32 s58, 268435456
    s_mov_b32 s59, 0x20000
    s_mov_b32 s70, 256
    s_mov_b32 s71, 0x20000
    s_mov_b32 s54, 2621440
    s_mov_b32 s55, 0x20000
    s_mov_b32 s74, 1966080
    s_mov_b32 s75, 0x20000
    s_mov_b32 s66, 2621440
    s_mov_b32 s67, 0x20000
    s_mov_b64 s[60:61], s[48:49]
    s_mov_b64 s[56:57], s[48:49]
    s_mov_b64 s[68:69], s[46:47]
    s_mov_b64 s[52:53], s[16:17]
    s_mov_b64 s[72:73], s[40:41]
    s_mov_b64 s[64:65], s[44:45]
    s_cmp_ge_u32 s9, 16
    s_cselect_b32 s58, 0, s58
    s_lshr_b32 s12, s6, 3
    s_mul_i32 s12, s12, 2048
    s_bfe_u32 s13, s6, 0x20001
    s_mul_i32 s13, s13, 64
    s_add_u32 s12, s12, s13
    s_add_u32 s12, s12, 393216
    s_lshl_b32 s13, s6, 7
    s_add_u32 s13, s13, 524288
    v_mov_b32 v130, 0
    v_lshrrev_b32 v118, 3, v1
    v_mul_i32_i24 v40, 224, v118
    v_lshl_add_u32 v40, v1, 2, v40
    v_lshrrev_b32 v119, 5, v1
    v_mul_i32_i24 v41, 16256, v119
    v_lshl_add_u32 v41, v1, 2, v41
    s_cmp_lg_u32 s3, 0
    s_cbranch_scc1 L_alt1001_b
    buffer_store_dword v130, v40, s[56:59], s12 offen sc1
    buffer_store_dword v130, v41, s[56:59], s13 offen sc1
L_alt1001_b:
L_alt1001_e:
    s_mov_b64 exec, 0
    s_cmp_eq_u32 s3, 0
    s_cbranch_scc1 L_SM_hop0
    s_cmp_eq_u32 s3, 1
    s_cbranch_scc1 L_SM_hop1
    s_cmp_eq_u32 s3, 2
    s_cbranch_scc1 L_SM_hop2
    s_branch L_SM_ret
L_SM_ret:
    s_mov_b64 exec, -1
    s_lshl_b32 s14, s11, 5
    s_add_u32 s14, s14, s3
    s_lshl_b32 s14, s14, 2
    s_add_u32 s49, s14, 524288
    s_lshl_b32 s77, s3, 10
    s_lshl_b32 s78, s10, 7
    v_lshrrev_b32 v121, 2, v1
    v_and_b32 v120, 4, v121
    v_xor_b32 v120, v120, v1
    v_lshrrev_b32 v122, 3, v0
    v_mul_i32_i24 v19, 1152, v122
    v_lshrrev_b32 v123, 6, v0
    v_lshl_add_u32 v19, v123, 10, v19
    v_lshl_add_u32 v19, v120, 4, v19
    s_lshl_b32 s12, s9, 2
    s_add_u32 s12, s12, s3
    s_mul_i32 s13, s4, 80
    s_add_u32 s13, s13, s12
    s_mul_i32 s13, s13, 3072
    v_min_u32 v30, 23, v1
    v_lshl_add_u32 v31, v30, 7, s13
    v_cmp_le_u32 vcc, 12, v30
    s_lshr_b32 s13, s4, 1
    s_mul_i32 s13, s13, 80
    s_add_u32 s13, s13, s12
    s_lshl_b32 s13, s13, 2
    s_and_b32 s12, s4, 1
    s_add_u32 s13, s13, s12
    s_mul_i32 s13, s13, 1536
    v_cndmask_b32 v44, 0, 12, vcc
    v_add_u32 v30, v30, v44
    v_lshl_add_u32 v30, v30, 7, s13
    global_load_dword v45, v30, s[36:37]
    s_lshr_b32 s13, s6, 1
    s_mul_i32 s13, s13, 40960
    s_and_b32 s14, s6, 1
    s_lshl_b32 s14, s14, 8
    s_add_u32 s13, s13, s14
    s_add_u32 s13, s13, 1048576
    s_lshl_b32 s12, s6, 6
    s_lshl_b32 s14, s6, 2
    v_lshl_add_u32 v43, v1, 2, s12
    v_lshl_add_u32 v42, v1, 9, s14
    v_cmp_gt_u32 vcc, 16, v1
    s_nop 1
    v_cndmask_b32 v43, v42, v43, vcc
    v_mov_b32 v8, 1
    v_lshrrev_b32 v124, 4, v0
    v_mul_i32_i24 v42, -64, v124
    v_lshl_add_u32 v42, v0, 2, v42
    v_add_u32 v42, 163584, v42
    v_mul_i32_i24 v40, 1312, v0
    s_mov_b32 s15, -20976
    v_mad_i32_i24 v40, v124, s15, v40
    v_lshl_add_u32 v40, v123, 8, v40
    v_add_u32 v40, 142592, v40
    v_lshl_add_u32 v41, v0, 4, 0
    v_lshl_add_u32 v41, v124, 8, v41
    v_lshl_add_u32 v41, v123, 13, v41
    s_mul_i32 s12, s100, 2624
    s_add_u32 s12, s12, 142592
    v_lshrrev_b32 v86, 5, v1
    v_mul_u32_u24 v58, 1056, v86
    v_lshl_add_u32 v58, v1, 3, v58
    v_add_u32 v58, s12, v58
    s_lshl_b32 s12, s100, 3
    s_add_u32 s12, s12, 163584
    v_lshl_add_u32 v59, v86, 2, s12
    s_mov_b32 s12, 0xffff0000
    s_branch L_SM1
L_SC:
    s_mul_i32 s13, s11, 1536
    v_lshl_add_u32 v92, v0, 2, s13
    v_lshrrev_b32 v95, 6, v0
    v_lshl_add_u32 v92, v95, 7, v92
    v_lshl_add_u32 v93, v0, 1, s13
    v_lshl_add_u32 v93, v95, 8, v93
    s_lshl_b32 s13, s11, 3
    v_lshl_add_u32 v94, v95, 1, s13
    global_load_ushort v128, v94, s[30:31]
    global_load_dword v34, v92, s[18:19]
    global_load_dword v35, v92, s[20:21]
    global_load_dword v36, v92, s[22:23]
    global_load_dword v37, v92, s[24:25]
    global_load_dword v38, v92, s[26:27]
    global_load_dword v39, v92, s[28:29]
    global_load_ushort v40, v93, s[18:19] offset:256
    global_load_ushort v41, v93, s[20:21] offset:256
    global_load_ushort v42, v93, s[22:23] offset:256
    global_load_ushort v43, v93, s[24:25] offset:256
    global_load_ushort v44, v93, s[26:27] offset:256
    global_load_ushort v45, v93, s[28:29] offset:256
    global_load_ushort v131, v94, s[32:33]
    global_load_ushort v132, v94, s[42:43]
    s_mov_b64 exec, 0
    s_cmp_eq_u32 s3, 0
    s_cbranch_scc1 L_SC_hop0
    s_cmp_eq_u32 s3, 1
    s_cbranch_scc1 L_SC_hop1
    s_cmp_eq_u32 s3, 2
    s_cbranch_scc1 L_SC_hop2
    s_branch L_SC_hop3
L_SC_ret:
    s_mov_b64 exec, -1
    s_mul_i32 s12, s100, 2624
    s_add_u32 s12, s12, 142592
    v_lshrrev_b32 v86, 5, v1
    v_mul_u32_u24 v58, 1056, v86
    v_lshl_add_u32 v58, v1, 3, v58
    v_add_u32 v58, s12, v58
    s_lshl_b32 s12, s100, 3
    s_add_u32 s12, s12, 163584
    v_lshl_add_u32 v59, v86, 2, s12
    s_mov_b32 s12, 0xffff0000
    s_branch L_SC1
L_G:
    s_cmp_lg_u32 s101, 3
    s_cbranch_scc1 L_alt3010_b
    v_mov_b32 v13, 0
    v_mov_b32 v14, 0
    v_mov_b32 v15, 0
    v_add_u32 v11, 4096, v2
    v_add_u32 v10, 12288, v2
    global_store_dwordx4 v11, v[12:15], s[48:49] offset:-4096 sc1
    global_store_dwordx4 v11, v[12:15], s[48:49] offset:-3072 sc1
    global_store_dwordx4 v11, v[12:15], s[48:49] offset:-2048 sc1
    global_store_dwordx4 v11, v[12:15], s[48:49] offset:-1024 sc1
    global_store_dwordx4 v11, v[12:15], s[48:49] offset:0 sc1
    global_store_dwordx4 v11, v[12:15], s[48:49] offset:1024 sc1
    global_store_dwordx4 v11, v[12:15], s[48:49] offset:2048 sc1
    global_store_dwordx4 v11, v[12:15], s[48:49] offset:3072 sc1
    global_store_dwordx4 v10, v[12:15], s[48:49] offset:-4096 sc1
    global_store_dwordx4 v10, v[12:15], s[48:49] offset:-3072 sc1
    global_store_dwordx4 v10, v[12:15], s[48:49] offset:-2048 sc1
    global_store_dwordx4 v10, v[12:15], s[48:49] offset:-1024 sc1
    s_mov_b64 exec, 1
    s_waitcnt vmcnt(0)
    global_store_dword v12, v4, s[46:47] sc1
    s_mov_b64 exec, -1
L_alt3010_b:
L_alt3010_e:
    s_and_b32 s12, s9, 3
    s_lshr_b32 s13, s4, 1
    s_lshl_b32 s7, s13, 2
    s_add_u32 s7, s7, s12
    s_and_b32 s13, s4, 1
    s_mul_i32 s13, s13, 3
    s_lshr_b32 s8, s9, 2
    s_add_u32 s8, s8, s13
    s_cmp_ge_u32 s100, 4
    s_cbranch_scc1 L_GC
    s_lshl_b32 s12, s9, 2
    s_add_u32 s12, s12, s3
    s_mul_i32 s12, s12, 40
    v_min_u32 v100, 39, v1
    v_add_u32 v100, s12, v100
    s_mul_i32 s13, s4, 245760
    v_lshl_add_u32 v102, v100, 7, s13
    v_mul_u32_u24 v101, 5462, v100
    v_lshrrev_b32 v101, 16, v101
    v_mul_u32_u24 v101, 1536, v101
    v_lshl_add_u32 v101, v100, 7, v101
    s_lshr_b32 s13, s4, 1
    s_mul_i32 s13, s13, 491520
    s_and_b32 s14, s4, 1
    s_mul_i32 s14, s14, 1536
    s_add_u32 s13, s13, s14
    v_add_u32 v101, s13, v101
    s_barrier
    s_mov_b32 s62, 268435456
    s_mov_b32 s63, 0x20000
    s_mov_b32 s70, 256
    s_mov_b32 s71, 0x20000
    s_mov_b64 s[60:61], s[48:49]
    s_mov_b64 s[68:69], s[46:47]
    s_lshl_b32 s13, s8, 9
    v_lshrrev_b32 v104, 5, v0
    v_mul_i32_i24 v103, -64, v104
    v_lshl_add_u32 v103, v0, 1, v103
    v_add_u32 v103, s13, v103
    global_load_ushort v88, v103, s[38:39] offset:0
    global_load_ushort v89, v103, s[38:39] offset:64
    global_load_ushort v90, v103, s[38:39] offset:128
    global_load_ushort v91, v103, s[38:39] offset:192
    global_load_ushort v92, v103, s[38:39] offset:256
    global_load_ushort v93, v103, s[38:39] offset:320
    global_load_ushort v94, v103, s[38:39] offset:384
    global_load_ushort v95, v103, s[38:39] offset:448
    s_mov_b64 exec, 0
    s_cmp_eq_u32 s3, 0
    s_cbranch_scc1 L_GM_hop0
    s_cmp_eq_u32 s3, 1
    s_cbranch_scc1 L_GM_hop1
    s_cmp_eq_u32 s3, 2
    s_cbranch_scc1 L_GM_hop2
    s_branch L_GM_hop3
L_GM_ret:
    s_mov_b64 exec, -1
    v_lshrrev_b32 v105, 2, v1
    v_mul_i32_i24 v10, 96, v105
    v_lshrrev_b32 v106, 4, v1
    s_mov_b32 s15, -608
    v_mad_i32_i24 v10, v106, s15, v10
    v_lshrrev_b32 v107, 5, v1
    s_mov_b32 s15, 960
    v_mad_i32_i24 v10, v107, s15, v10
    v_lshl_add_u32 v10, v1, 3, v10
    v_lshrrev_b32 v108, 3, v1
    v_lshl_add_u32 v10, v108, 6, v10
    v_add_u32 v12, 61440, v10
    v_add_u32 v14, 122880, v10
    v_mul_i32_i24 v11, 96, v105
    s_mov_b32 s15, -64
    v_mad_i32_i24 v11, v108, s15, v11
    s_mov_b32 s15, -352
    v_mad_i32_i24 v11, v106, s15, v11
    s_mov_b32 s15, 960
    v_mad_i32_i24 v11, v107, s15, v11
    v_lshl_add_u32 v11, v1, 3, v11
    v_add_u32 v11, 64, v11
    v_add_u32 v13, 61440, v11
    v_add_u32 v15, 122880, v11
    v_lshrrev_b32 v109, 6, v0
    s_mov_b32 s15, 40704
    v_lshl_add_u32 v16, v109, 0, s15
    s_lshl_b32 s44, s7, 2
    s_add_u32 s44, s44, s3
    s_lshl_b32 s14, s7, 5
    s_add_u32 s14, s14, s3
    s_mul_i32 s14, s14, 16
    s_add_u32 s14, s14, s8
    s_lshl_b32 s14, s14, 2
    s_add_u32 s49, s14, 393216
    s_mul_i32 s82, s44, 98304
    s_lshl_b32 s14, s8, 14
    s_add_u32 s82, s82, s14
    s_add_u32 s82, s82, 11010048
    s_lshl_b32 s45, s44, 7
    s_mul_i32 s80, s44, 40960
    s_add_u32 s80, s80, 1048576
    v_lshlrev_b32 v9, 2, v1
    s_lshr_b32 s12, s9, 2
    s_add_u32 s72, s80, 0
    s_add_u32 s73, s80, 10240
    s_add_u32 s74, s80, 20480
    s_add_u32 s75, s80, 30720
    v_mov_b32 v83, 0
    v_mov_b32 v84, 0
    v_mov_b32 v85, 0
    v_mov_b32 v86, 0
    s_branch L_GM1
L_GC:
    v_lshrrev_b32 v101, 2, v1
    v_and_b32 v100, 4, v101
    v_xor_b32 v100, v100, v1
    v_lshrrev_b32 v102, 3, v0
    v_mul_i32_i24 v23, 2944, v102
    v_lshrrev_b32 v103, 6, v0
    s_mov_b32 s15, 99328
    v_mad_i32_i24 v23, v103, s15, v23
    v_lshl_add_u32 v23, v100, 4, v23
    s_mov_b32 s58, 1966080
    s_mov_b32 s59, 0x20000
    s_mov_b32 s62, 268435456
    s_mov_b32 s63, 0x20000
    s_mov_b64 s[56:57], s[36:37]
    s_mov_b64 s[60:61], s[48:49]
    s_lshl_b32 s78, s8, 9
    s_mul_i32 s77, s3, 5120
    s_lshr_b32 s12, s9, 2
    s_add_u32 s72, s78, 0
    s_add_u32 s73, s78, 491520
    s_add_u32 s74, s78, 983040
    s_add_u32 s75, s78, 1474560
    s_mov_b32 s15, 40704
    v_lshl_add_u32 v16, v103, 0, s15
    s_mul_i32 s12, s4, 12
    s_add_u32 s12, s12, s9
    s_lshl_b32 s12, s12, 2
    s_add_u32 s12, s12, s3
    s_mul_i32 s12, s12, 5120
    v_min_u32 v24, 39, v1
    v_lshl_add_u32 v24, v24, 7, s12
    s_mov_b64 exec, 0
    s_cmp_eq_u32 s3, 0
    s_cbranch_scc1 L_GC_hop0
    s_cmp_eq_u32 s3, 1
    s_cbranch_scc1 L_GC_ret
    s_cmp_eq_u32 s3, 2
    s_cbranch_scc1 L_GC_ret
    s_branch L_GC_ret
L_GC_ret:
    s_mov_b64 exec, -1
    s_branch L_GC1
L_end:
    s_endpgm
.p2align 12
L_SM1:
L_SM_hop0:
    s_cbranch_execz L_SM_ret
    s_nop 0
    s_waitcnt vmcnt(5)
    v_lshlrev_b32 v60, 16, v48
    v_and_b32 v61, s12, v48
    v_pk_mul_f32 v[82:83], v[60:61], v[60:61]
    v_lshlrev_b32 v62, 16, v49
    v_and_b32 v63, s12, v49
    v_pk_add_f32 v[80:81], v[60:61], v[62:63]
    v_pk_fma_f32 v[82:83], v[62:63], v[62:63], v[82:83]
    s_waitcnt vmcnt(4)
    v_lshlrev_b32 v64, 16, v50
    v_and_b32 v65, s12, v50
    v_pk_add_f32 v[80:81], v[80:81], v[64:65]
    v_pk_fma_f32 v[82:83], v[64:65], v[64:65], v[82:83]
    v_lshlrev_b32 v66, 16, v51
    v_and_b32 v67, s12, v51
    v_pk_add_f32 v[80:81], v[80:81], v[66:67]
    v_pk_fma_f32 v[82:83], v[66:67], v[66:67], v[82:83]
    s_waitcnt vmcnt(3)
    v_lshlrev_b32 v68, 16, v52
    v_and_b32 v69, s12, v52
    v_pk_add_f32 v[80:81], v[80:81], v[68:69]
    v_pk_fma_f32 v[82:83], v[68:69], v[68:69], v[82:83]
    v_lshlrev_b32 v70, 16, v53
    v_and_b32 v71, s12, v53
    v_pk_add_f32 v[80:81], v[80:81], v[70:71]
    v_pk_fma_f32 v[82:83], v[70:71], v[70:71], v[82:83]
    s_waitcnt vmcnt(2)
    v_lshlrev_b32 v72, 16, v54
    v_and_b32 v73, s12, v54
    v_pk_add_f32 v[80:81], v[80:81], v[72:73]
    v_pk_fma_f32 v[82:83], v[72:73], v[72:73], v[82:83]
    v_lshlrev_b32 v74, 16, v55
    v_and_b32 v75, s12, v55
    v_pk_add_f32 v[80:81], v[80:81], v[74:75]
    v_pk_fma_f32 v[82:83], v[74:75], v[74:75], v[82:83]
    s_waitcnt vmcnt(1)
    v_lshlrev_b32 v76, 16, v56
    v_and_b32 v77, s12, v56
    v_pk_add_f32 v[80:81], v[80:81], v[76:77]
    v_pk_fma_f32 v[82:83], v[76:77], v[76:77], v[82:83]
    v_lshlrev_b32 v78, 16, v57
    v_and_b32 v79, s12, v57
    v_pk_add_f32 v[80:81], v[80:81], v[78:79]
    v_pk_fma_f32 v[82:83], v[78:79], v[78:79], v[82:83]
    v_add_f32 v80, v80, v81
    v_add_f32 v82, v82, v83
    s_nop 0
    v_add_f32_dpp v80, v80, v80 quad_perm:[1,0,3,2] row_mask:0xf bank_mask:0xf
    v_add_f32_dpp v82, v82, v82 quad_perm:[1,0,3,2] row_mask:0xf bank_mask:0xf
    s_nop 0
    v_add_f32_dpp v80, v80, v80 quad_perm:[2,3,0,1] row_mask:0xf bank_mask:0xf
    v_add_f32_dpp v82, v82, v82 quad_perm:[2,3,0,1] row_mask:0xf bank_mask:0xf
    s_nop 0
    v_add_f32_dpp v80, v80, v80 row_half_mirror row_mask:0xf bank_mask:0xf
    v_add_f32_dpp v82, v82, v82 row_half_mirror row_mask:0xf bank_mask:0xf
    s_nop 0
    v_add_f32_dpp v80, v80, v80 row_mirror row_mask:0xf bank_mask:0xf
    v_add_f32_dpp v82, v82, v82 row_mirror row_mask:0xf bank_mask:0xf
    v_mov_b32 v81, v80
    v_mov_b32 v83, v82
    s_nop 0
    v_permlane16_swap_b32 v80, v81
    v_permlane16_swap_b32 v82, v83
    v_add_f32 v80, v80, v81
    v_add_f32 v82, v82, v83
    v_mul_f32 v80, 0xbacccccd, v80
    v_mul_f32 v82, 0x3acccccd, v82
    v_fma_f32 v82, -v80, v80, v82
    v_max_f32 v82, 0, v82
    v_add_f32 v86, 0x3727c5ac, v82
    v_rsq_f32 v84, v86
    s_nop 0
    v_mul_f32 v85, v84, v80
    v_pk_fma_f32 v[86:87], v[60:61], v[84:85], v[84:85] op_sel:[0,0,1] op_sel_hi:[1,0,1]
    v_cvt_pk_bf16_f32 v48, v86, v87
    v_pk_fma_f32 v[88:89], v[62:63], v[84:85], v[84:85] op_sel:[0,0,1] op_sel_hi:[1,0,1]
    v_cvt_pk_bf16_f32 v49, v88, v89
    v_pk_fma_f32 v[86:87], v[64:65], v[84:85], v[84:85] op_sel:[0,0,1] op_sel_hi:[1,0,1]
    v_cvt_pk_bf16_f32 v50, v86, v87
    v_pk_fma_f32 v[88:89], v[66:67], v[84:85], v[84:85] op_sel:[0,0,1] op_sel_hi:[1,0,1]
    v_cvt_pk_bf16_f32 v51, v88, v89
    v_pk_fma_f32 v[86:87], v[68:69], v[84:85], v[84:85] op_sel:[0,0,1] op_sel_hi:[1,0,1]
    v_cvt_pk_bf16_f32 v52, v86, v87
    v_pk_fma_f32 v[88:89], v[70:71], v[84:85], v[84:85] op_sel:[0,0,1] op_sel_hi:[1,0,1]
    v_cvt_pk_bf16_f32 v53, v88, v89
    v_pk_fma_f32 v[86:87], v[72:73], v[84:85], v[84:85] op_sel:[0,0,1] op_sel_hi:[1,0,1]
    v_cvt_pk_bf16_f32 v54, v86, v87
    v_pk_fma_f32 v[88:89], v[74:75], v[84:85], v[84:85] op_sel:[0,0,1] op_sel_hi:[1,0,1]
    v_cvt_pk_bf16_f32 v55, v88, v89
    v_pk_fma_f32 v[86:87], v[76:77], v[84:85], v[84:85] op_sel:[0,0,1] op_sel_hi:[1,0,1]
    v_cvt_pk_bf16_f32 v56, v86, v87
    v_pk_fma_f32 v[88:89], v[78:79], v[84:85], v[84:85] op_sel:[0,0,1] op_sel_hi:[1,0,1]
    v_cvt_pk_bf16_f32 v57, v88, v89
    v_mul_f32 v86, v84, v84
    v_fmaak_f32 v86, v86, v82, 0x3727c5ac
    v_sqrt_f32 v86, v86
    ds_write_b64 v58, v[48:49] offset:0
    ds_write_b64 v58, v[50:51] offset:256
    ds_write_b64 v58, v[52:53] offset:512
    ds_write_b64 v58, v[54:55] offset:768
    ds_write_b64 v58, v[56:57] offset:1024
    ds_write_b32 v59, v86
    s_waitcnt lgkmcnt(0)
    s_barrier
    ds_read_b128 v[48:51], v40 offset:0
    ds_read_b128 v[52:55], v40 offset:64
    ds_read_b128 v[56:59], v40 offset:128
    ds_read_b128 v[60:63], v40 offset:192
    ds_read_b128 v[64:67], v40 offset:256
    ds_read_b32 v28, v42
    s_waitcnt lgkmcnt(5)
    buffer_store_dwordx4 v[48:51], v41, s[56:59], s13 offen offset:0 sc1
    s_waitcnt lgkmcnt(4)
    buffer_store_dwordx4 v[52:55], v41, s[56:59], s13 offen offset:2048 sc1
    s_add_u32 s13, s13, 4096
    s_waitcnt lgkmcnt(3)
    buffer_store_dwordx4 v[56:59], v41, s[56:59], s13 offen offset:0 sc1
    s_waitcnt lgkmcnt(2)
    buffer_store_dwordx4 v[60:63], v41, s[56:59], s13 offen offset:2048 sc1
    s_add_u32 s13, s13, 4096
    s_waitcnt lgkmcnt(1)
    buffer_store_dwordx4 v[64:67], v41, s[56:59], s13 offen offset:0 sc1
    s_cmp_lg_u32 s3, 3
    s_cbranch_scc1 L_alt1002_b
    buffer_load_dword v8, v130, s[68:71], 0 offen offset:0 sc1
L_alt1002_b:
L_alt1002_e:
    s_setprio 2
    s_waitcnt vmcnt(0)
    v_cmp_gt_u32 vcc, 1, v8
    s_cbranch_vccnz L_SM_p1_spin
L_SM_p1_ok:
    s_mov_b64 exec, 1
    s_waitcnt vmcnt(0)
    ds_add_rtn_u32 v9, v5, v4 offset:0
    s_mov_b64 exec, 0xffff
    s_waitcnt lgkmcnt(0)
    v_readfirstlane_b32 s14, v9
    s_nop 0
    s_cmp_eq_u32 s14, 3
    s_cselect_b32 s58, s58, 0
    buffer_store_dword v28, v43, s[56:59], 0 offen sc1
    s_mov_b64 exec, 0xff0000
    buffer_store_dword v28, v43, s[56:59], 0 offen sc1
    s_mov_b64 exec, -1
    s_setprio 0
    global_load_dword v46, v31, s[40:41]
    s_lshl_b32 s44, s7, 2
    s_add_u32 s44, s44, s3
    s_mov_b32 s15, 40704
    v_lshl_add_u32 v16, v123, 0, s15
    v_mul_i32_i24 v10, 96, v121
    v_lshrrev_b32_e64 v96, 4, v1
    s_mov_b32 s15, -608
    v_mad_i32_i24 v10, v96, s15, v10
    s_mov_b32 s15, 448
    v_mad_i32_i24 v10, v119, s15, v10
    v_lshl_add_u32 v10, v1, 3, v10
    v_lshl_add_u32 v10, v118, 6, v10
    v_add_u32 v12, 65536, v10
    v_add_u32 v14, 114688, v10
    v_mul_i32_i24 v11, 96, v121
    s_mov_b32 s15, -64
    v_mad_i32_i24 v11, v118, s15, v11
    s_mov_b32 s15, -352
    v_mad_i32_i24 v11, v96, s15, v11
    s_mov_b32 s15, 448
    v_mad_i32_i24 v11, v119, s15, v11
    v_lshl_add_u32 v11, v1, 3, v11
    v_add_u32 v11, 64, v11
    v_add_u32 v13, 65536, v11
    v_add_u32 v15, 114688, v11
    s_mul_i32 s14, s10, 39
    v_min_u32 v29, 38, v1
    v_add_u32 v29, s14, v29
    v_min_u32 v29, 383, v29
    v_lshrrev_b32_e64 v18, 4, v29
    v_mul_u32_u24 v18, 14336, v18
    v_lshl_add_u32 v29, v29, 7, v18
    s_mul_i32 s48, s7, 393216
    s_add_u32 s48, s48, 11010048
    v_lshrrev_b32 v18, 3, v1
    v_mul_u32_u24 v18, 32, v18
    v_lshl_add_u32 v18, v1, 2, v18
    s_mul_i32 s14, s7, 2048
    s_add_u32 s46, s14, 393216
    v_mul_i32_i24 v21, 1152, v122
    s_mov_b32 s15, 30720
    v_mad_i32_i24 v21, v123, s15, v21
    v_lshl_add_u32 v21, v0, 4, v21
    v_mul_i32_i24 v24, -4144, v119
    v_lshl_add_u32 v24, v1, 7, v24
    v_lshl_add_u32 v24, v118, 4, v24
    v_lshl_add_u32 v24, v123, 13, v24
    v_add_u32 v24, 114688, v24
    v_mul_i32_i24 v20, -8256, v119
    v_lshl_add_u32 v20, v1, 8, v20
    v_lshl_add_u32 v20, v121, 4, v20
    v_lshl_add_u32 v20, v123, 5, v20
    v_lshrrev_b32_e64 v97, 7, v0
    v_lshl_add_u32 v20, v97, 6, v20
    v_add_u32 v20, 90112, v20
    v_mul_i32_i24 v22, 144, v1
    s_mov_b32 s15, -4592
    v_mad_i32_i24 v22, v119, s15, v22
    s_mov_b32 s15, 4608
    v_mad_i32_i24 v22, v123, s15, v22
    v_add_u32 v22, 114688, v22
    v_mul_i32_i24 v23, 3456, v123
    v_lshl_add_u32 v23, v0, 4, v23
    v_lshl_add_u32 v23, v122, 4, v23
    v_add_u32 v23, 114688, v23
    v_mul_i32_i24 v27, 10144, v1
    s_mov_b32 s15, -40560
    v_mad_i32_i24 v27, v121, s15, v27
    v_lshl_add_u32 v27, v123, 10, v27
    v_add_u32 v27, 5984, v27
    s_and_b32 s14, s11, 1
    s_lshl_b32 s14, s14, 3
    v_mul_i32_i24 v26, -496, v121
    s_mov_b32 s15, 448
    v_mad_i32_i24 v26, v96, s15, v26
    v_lshl_add_u32 v26, v1, 7, v26
    v_lshl_add_u32 v26, v123, 13, v26
    v_add_u32 v26, 114688, v26
    v_add_u32_e64 v26, s14, v26
    v_mul_i32_i24 v25, 40448, v119
    s_mov_b32 s15, 655360
    v_mad_i32_i24 v25, v123, s15, v25
    v_lshl_add_u32 v25, v1, 4, v25
    v_mul_i32_i24 v98, -20, v119
    v_lshrrev_b32_e64 v100, 1, v1
    v_lshl_add_u32 v98, v100, 0, v98
    v_mul_i32_i24 v99, -32, v100
    v_lshl_add_u32 v99, v1, 4, v99
    v_mov_b32 v32, 0x3f80
    v_lshlrev_b32 v99, v99, v32
    v_cmp_eq_u32 vcc, 0, v98
    s_nop 1
    v_cndmask_b32 v32, 0, v99, vcc
    v_cmp_eq_u32 vcc, 1, v98
    s_nop 1
    v_cndmask_b32 v33, 0, v99, vcc
    v_cmp_eq_u32 vcc, 2, v98
    s_nop 1
    v_cndmask_b32 v34, 0, v99, vcc
    v_cmp_eq_u32 vcc, 3, v98
    s_nop 1
    v_cndmask_b32 v35, 0, v99, vcc
    v_cmp_eq_u32 vcc, 8, v98
    s_nop 1
    v_cndmask_b32 v36, 0, v99, vcc
    v_cmp_eq_u32 vcc, 9, v98
    s_nop 1
    v_cndmask_b32 v37, 0, v99, vcc
    v_cmp_eq_u32 vcc, 10, v98
    s_nop 1
    v_cndmask_b32 v38, 0, v99, vcc
    v_cmp_eq_u32 vcc, 11, v98
    s_nop 1
    v_cndmask_b32_e64 v39, 0, v99, vcc
    s_mul_i32 s82, s44, 98304
    s_add_u32 s82, s82, 11010048
    s_mul_i32 s80, s7, 163840
    s_add_u32 s80, s80, s78
    s_lshl_b32 s76, s3, 13
    ds_read_b32 v6, v5 offset:0
    s_waitcnt lgkmcnt(0)
    v_cmp_gt_u32 vcc, 4, v6
    s_cbranch_vccnz L_SM_p2_spin
L_SM_p2_ok:
    s_add_u32 m0, s76, 114688
    s_add_u32 s12, s80, 0
    buffer_load_dwordx4 v21, s[52:55], s12 offen lds
    s_add_u32 m0, s76, 115728
    s_add_u32 s12, s80, 10240
    buffer_load_dwordx4 v21, s[52:55], s12 offen lds
    s_add_u32 m0, s76, 116768
    s_add_u32 s12, s80, 20480
    buffer_load_dwordx4 v21, s[52:55], s12 offen lds
    s_add_u32 m0, s76, 117808
    s_add_u32 s12, s80, 30720
    buffer_load_dwordx4 v21, s[52:55], s12 offen lds
    s_add_u32 m0, s77, 40960
    s_add_u32 s79, s78, 0
    s_nop 0
    buffer_load_dwordx4 v19, s[72:75], s79 offen lds
    s_add_u32 m0, s77, 45056
    s_add_u32 s79, s78, 327680
    buffer_load_dwordx4 v19, s[72:75], s79 offen lds
    s_add_u32 m0, s77, 49152
    s_add_u32 s79, s78, 655360
    buffer_load_dwordx4 v19, s[72:75], s79 offen lds
    s_add_u32 m0, s77, 53248
    s_add_u32 s79, s78, 983040
    buffer_load_dwordx4 v19, s[72:75], s79 offen lds
    s_add_u32 m0, s77, 57344
    s_add_u32 s79, s78, 1310720
    s_waitcnt vmcnt(3)
    buffer_load_dwordx4 v19, s[72:75], s79 offen lds
    s_add_u32 m0, s77, 61440
    s_add_u32 s79, s78, 1638400
    s_waitcnt vmcnt(3)
    buffer_load_dwordx4 v19, s[72:75], s79 offen lds
    v_lshlrev_b32 v9, 2, v1
    s_lshl_b32 s45, s4, 2
    s_add_u32 s45, s45, s3
    s_lshl_b32 s45, s45, 7
    s_add_u32 s45, s45, 8192
    s_mov_b32 exec_hi, 0x0
    v_mov_b32_e64 v6, 0
    buffer_atomic_add v6, v9, s[60:63], s45 offen offset:0 sc0 sc1
    s_mov_b32 exec_hi, -1
    ds_read_b128 v[96:99], v24 offset:0
    ds_read_b128 v[100:103], v24 offset:32
    ds_read_b128 v[104:107], v24 offset:64
    ds_read_b128 v[108:111], v24 offset:96
    s_waitcnt lgkmcnt(3)
    v_mfma_f32_32x32x16_bf16 v[64:79], v[32:35], v[96:99], 0
    s_waitcnt lgkmcnt(2)
    v_mfma_f32_32x32x16_bf16 v[64:79], v[36:39], v[100:103], v[64:79]
    s_waitcnt lgkmcnt(1)
    v_mfma_f32_32x32x16_bf16 v[80:95], v[32:35], v[104:107], 0
    s_waitcnt lgkmcnt(0)
    v_mfma_f32_32x32x16_bf16 v[80:95], v[36:39], v[108:111], v[80:95]
    s_lshr_b32 s12, s11, 1
    s_lshl_b32 s12, s12, 9
    s_add_u32 s12, s12, 1048576
    s_waitcnt vmcnt(0)
    v_cmp_gt_u32 vcc, 1, v6
    s_nop 0
    s_lshl_b64 vcc, vcc, 32
    s_cbranch_scc1 L_SM_p3_spin
L_SM_p3_ok:
    s_add_u32 m0, s76, 114688
    s_nop 0
    buffer_load_dwordx4 v25, s[60:63], s12 offen sc1 lds
    s_add_u32 m0, s76, 115712
    s_add_u32 s12, s12, 81920
    buffer_load_dwordx4 v25, s[60:63], s12 offen sc1 lds
    s_add_u32 m0, s76, 116736
    s_add_u32 s12, s12, 81920
    buffer_load_dwordx4 v25, s[60:63], s12 offen sc1 lds
    s_add_u32 m0, s76, 117760
    s_add_u32 s12, s12, 81920
    buffer_load_dwordx4 v25, s[60:63], s12 offen sc1 lds
    s_add_u32 m0, s76, 118784
    s_add_u32 s12, s12, 81920
    buffer_load_dwordx4 v25, s[60:63], s12 offen sc1 lds
    s_add_u32 m0, s76, 119808
    s_add_u32 s12, s12, 81920
    buffer_load_dwordx4 v25, s[60:63], s12 offen sc1 lds
    s_add_u32 m0, s76, 120832
    s_add_u32 s12, s12, 81920
    buffer_load_dwordx4 v25, s[60:63], s12 offen sc1 lds
    s_add_u32 m0, s76, 121856
    s_add_u32 s12, s12, 81920
    buffer_load_dwordx4 v25, s[60:63], s12 offen sc1 lds
    s_waitcnt vmcnt(0)
    s_nop 0
    ds_read_b64_tr_b16 v[96:97], v26 offset:0
    ds_read_b64_tr_b16 v[98:99], v26 offset:64
    ds_read_b64_tr_b16 v[100:101], v26 offset:2048
    ds_read_b64_tr_b16 v[102:103], v26 offset:2112
    ds_read_b64_tr_b16 v[104:105], v26 offset:4096
    ds_read_b64_tr_b16 v[106:107], v26 offset:4160
    ds_read_b64_tr_b16 v[108:109], v26 offset:6144
    ds_read_b64_tr_b16 v[110:111], v26 offset:6208
    s_add_u32 m0, s77, 65536
    s_add_u32 s79, s78, 40960
    buffer_load_dwordx4 v19, s[72:75], s79 offen lds
    s_add_u32 m0, s77, 69632
    s_add_u32 s79, s78, 368640
    buffer_load_dwordx4 v19, s[72:75], s79 offen lds
    s_add_u32 m0, s77, 73728
    s_add_u32 s79, s78, 696320
    buffer_load_dwordx4 v19, s[72:75], s79 offen lds
    s_add_u32 m0, s77, 77824
    s_add_u32 s79, s78, 1024000
    buffer_load_dwordx4 v19, s[72:75], s79 offen lds
    s_add_u32 m0, s77, 81920
    s_add_u32 s79, s78, 1351680
    buffer_load_dwordx4 v19, s[72:75], s79 offen lds
    s_add_u32 m0, s77, 86016
    s_add_u32 s79, s78, 1679360
    buffer_load_dwordx4 v19, s[72:75], s79 offen lds
    s_setprio 2
    ds_read_b32 v7, v5 offset:8
    s_waitcnt lgkmcnt(0)
    v_cmp_gt_u32 vcc, 4, v7
    s_cbranch_vccnz L_SM_p4_spin
L_SM_p4_ok:
    ds_write_b128 v27, v[96:99] offset:0
    ds_write_b128 v27, v[100:103] offset:256
    ds_write_b128 v27, v[104:107] offset:512
    ds_write_b128 v27, v[108:111] offset:768
    s_mov_b64 exec, 1
    ds_add_u32 v5, v4 offset:12
    s_mov_b64 exec, -1
    s_setprio 0
    s_add_u32 m0, s77, 90112
    s_add_u32 s79, s78, 81920
    s_waitcnt vmcnt(3)
    buffer_load_dwordx4 v19, s[72:75], s79 offen lds
    s_add_u32 m0, s77, 94208
    s_add_u32 s79, s78, 409600
    s_waitcnt vmcnt(3)
    buffer_load_dwordx4 v19, s[72:75], s79 offen lds
    s_add_u32 m0, s77, 98304
    s_add_u32 s79, s78, 737280
    s_waitcnt vmcnt(3)
    buffer_load_dwordx4 v19, s[72:75], s79 offen lds
    s_add_u32 m0, s77, 102400
    s_add_u32 s79, s78, 1064960
    s_waitcnt vmcnt(3)
    buffer_load_dwordx4 v19, s[72:75], s79 offen lds
    s_add_u32 m0, s77, 106496
    s_add_u32 s79, s78, 1392640
    s_waitcnt vmcnt(3)
    buffer_load_dwordx4 v19, s[72:75], s79 offen lds
    s_add_u32 m0, s77, 110592
    s_add_u32 s79, s78, 1720320
    s_waitcnt vmcnt(3)
    buffer_load_dwordx4 v19, s[72:75], s79 offen lds
    ds_read_b32 v7, v5 offset:12
    s_waitcnt lgkmcnt(0)
    v_cmp_gt_u32 vcc, 4, v7
    s_cbranch_vccnz L_SM_p5_spin
L_SM_p5_ok:
    s_add_u32 m0, s77, 114688
    s_add_u32 s79, s78, 122880
    buffer_load_dwordx4 v19, s[72:75], s79 offen lds
    s_add_u32 m0, s77, 118784
    s_add_u32 s79, s78, 450560
    buffer_load_dwordx4 v19, s[72:75], s79 offen lds
    s_add_u32 m0, s77, 122880
    s_add_u32 s79, s78, 778240
    s_waitcnt vmcnt(5)
    buffer_load_dwordx4 v19, s[72:75], s79 offen lds
    s_add_u32 m0, s77, 126976
    s_add_u32 s79, s78, 1105920
    s_waitcnt vmcnt(5)
    buffer_load_dwordx4 v19, s[72:75], s79 offen lds
    s_add_u32 m0, s77, 131072
    s_add_u32 s79, s78, 1433600
    s_waitcnt vmcnt(5)
    buffer_load_dwordx4 v19, s[72:75], s79 offen lds
    s_add_u32 m0, s77, 135168
    s_add_u32 s79, s78, 1761280
    s_waitcnt vmcnt(5)
    buffer_load_dwordx4 v19, s[72:75], s79 offen lds
    s_add_u32 m0, s77, 139264
    s_add_u32 s79, s78, 163840
    s_waitcnt vmcnt(5)
    buffer_load_dwordx4 v19, s[72:75], s79 offen lds
    s_add_u32 m0, s77, 143360
    s_add_u32 s79, s78, 491520
    s_waitcnt vmcnt(5)
    buffer_load_dwordx4 v19, s[72:75], s79 offen lds
    s_add_u32 m0, s77, 147456
    s_add_u32 s79, s78, 819200
    s_waitcnt vmcnt(5)
    buffer_load_dwordx4 v19, s[72:75], s79 offen lds
    s_add_u32 m0, s77, 151552
    s_add_u32 s79, s78, 1146880
    s_waitcnt vmcnt(5)
    buffer_load_dwordx4 v19, s[72:75], s79 offen lds
    s_add_u32 m0, s77, 155648
    s_add_u32 s79, s78, 1474560
    s_waitcnt vmcnt(5)
    buffer_load_dwordx4 v19, s[72:75], s79 offen lds
    s_add_u32 m0, s77, 159744
    s_add_u32 s79, s78, 1802240
    s_waitcnt vmcnt(5)
    buffer_load_dwordx4 v19, s[72:75], s79 offen lds
    s_mov_b64 exec, 1
    s_waitcnt vmcnt(0)
    ds_add_u32 v5, v4 offset:16
    s_mov_b64 exec, -1
    ds_read_b32 v7, v5 offset:16
    s_waitcnt lgkmcnt(0)
    v_cmp_gt_u32 vcc, 4, v7
    s_cbranch_vccnz L_SM_p6_spin
L_SM_p6_ok:
    ds_read_b64_tr_b16 v[40:41], v10 offset:40960
    ds_read_b64_tr_b16 v[42:43], v10 offset:41984
    ds_read_b64_tr_b16 v[44:45], v11 offset:40960
    ds_read_b64_tr_b16 v[46:47], v11 offset:41984
    ds_read_b64_tr_b16 v[48:49], v10 offset:43008
    ds_read_b64_tr_b16 v[50:51], v10 offset:44032
    ds_read_b64_tr_b16 v[52:53], v11 offset:43008
    ds_read_b64_tr_b16 v[54:55], v11 offset:44032
    ds_read_b64_tr_b16 v[56:57], v10 offset:45056
    ds_read_b64_tr_b16 v[58:59], v10 offset:46080
    s_cmp_lg_u32 s3, 0
    s_cbranch_scc1 L_alt1003_b
    v_mov_b32 v9, 1
    s_mov_b32 exec_lo, 0x3f3f3f3f
    s_mov_b32 exec_hi, 0x3f3f3f3f
    v_mov_b32 v9, 0
    buffer_atomic_add v9, v18, s[60:63], s46 offen offset:0 sc0 sc1
    s_mov_b64 exec, -1
    s_waitcnt vmcnt(0)
    v_cmp_gt_u32_e64 vcc, 1, v9
    s_nop 0
    s_lshl_b64 vcc, vcc, 32
    s_cbranch_scc1 L_SM_p7_spin
L_SM_p7_ok:
    s_add_u32 s12, s48, 0
    buffer_load_dword v8, v29, s[60:63], s12 offen sc1
    ds_write_b32 v5, v4 offset:32
L_alt1003_b:
L_alt1003_e:
    ds_read_b32 v7, v5 offset:32
    s_waitcnt lgkmcnt(0)
    v_cmp_gt_u32 vcc, 1, v7
    s_cbranch_vccnz L_SM_p9_spin
L_SM_p9_ok:
    s_add_u32 s83, s82, 0
    buffer_load_dwordx4 a[0:3], v2, s[60:63], s83 offen offset:0 sc1
    buffer_load_dwordx4 a[4:7], v2, s[60:63], s83 offen offset:1024 sc1
    s_add_u32 s83, s82, 16384
    buffer_load_dwordx4 a[8:11], v2, s[60:63], s83 offen offset:0 sc1
    buffer_load_dwordx4 a[12:15], v2, s[60:63], s83 offen offset:1024 sc1
    s_add_u32 s83, s82, 32768
    buffer_load_dwordx4 a[16:19], v2, s[60:63], s83 offen offset:0 sc1
    buffer_load_dwordx4 a[20:23], v2, s[60:63], s83 offen offset:1024 sc1
    s_add_u32 s83, s82, 49152
    buffer_load_dwordx4 a[24:27], v2, s[60:63], s83 offen offset:0 sc1
    buffer_load_dwordx4 a[28:31], v2, s[60:63], s83 offen offset:1024 sc1
    s_add_u32 s83, s82, 65536
    buffer_load_dwordx4 a[32:35], v2, s[60:63], s83 offen offset:0 sc1
    buffer_load_dwordx4 a[36:39], v2, s[60:63], s83 offen offset:1024 sc1
    s_add_u32 s83, s82, 81920
    buffer_load_dwordx4 a[40:43], v2, s[60:63], s83 offen offset:0 sc1
    buffer_load_dwordx4 a[44:47], v2, s[60:63], s83 offen offset:1024 sc1
    s_cmp_lg_u32 s3, 0
    s_cbranch_scc1 L_alt1004_b
    v_cmp_gt_u32_e64 vcc, 1, v9
    s_cbranch_vccnz L_SM_p8_spin
L_SM_p8_ok:
    s_add_u32 s12, s48, 2048
    s_waitcnt vmcnt(12)
    buffer_load_dword v8, v29, s[60:63], s12 offen sc1
    ds_write_b32 v5, v4 offset:36
L_alt1004_b:
L_alt1004_e:
    ds_read_b32 v7, v5 offset:36
    s_waitcnt lgkmcnt(0)
    v_cmp_gt_u32_e64 vcc, 1, v7
    s_cbranch_vccnz L_SM_p10_spin
L_SM_p10_ok:
    s_add_u32 s83, s82, 2048
    buffer_load_dwordx4 a[48:51], v2, s[60:63], s83 offen offset:0 sc1
    buffer_load_dwordx4 a[52:55], v2, s[60:63], s83 offen offset:1024 sc1
    s_add_u32 s83, s82, 18432
    buffer_load_dwordx4 a[56:59], v2, s[60:63], s83 offen offset:0 sc1
    buffer_load_dwordx4 a[60:63], v2, s[60:63], s83 offen offset:1024 sc1
    s_add_u32 s83, s82, 34816
    buffer_load_dwordx4 a[64:67], v2, s[60:63], s83 offen offset:0 sc1
    buffer_load_dwordx4 a[68:71], v2, s[60:63], s83 offen offset:1024 sc1
    s_add_u32 s83, s82, 51200
    buffer_load_dwordx4 a[72:75], v2, s[60:63], s83 offen offset:0 sc1
    buffer_load_dwordx4 a[76:79], v2, s[60:63], s83 offen offset:1024 sc1
    s_add_u32 s83, s82, 67584
    buffer_load_dwordx4 a[80:83], v2, s[60:63], s83 offen offset:0 sc1
    buffer_load_dwordx4 a[84:87], v2, s[60:63], s83 offen offset:1024 sc1
    s_add_u32 s83, s82, 83968
    buffer_load_dwordx4 a[88:91], v2, s[60:63], s83 offen offset:0 sc1
    buffer_load_dwordx4 a[92:95], v2, s[60:63], s83 offen offset:1024 sc1
    s_cmp_lg_u32 s3, 0
    s_cbranch_scc1 L_alt1005_b
    v_mov_b32 v9, 1
    s_mov_b32 exec_lo, 0x3f3f3f3f
    s_mov_b32 exec_hi, 0x0
    v_mov_b32_e64 v9, 0
    buffer_atomic_add v9, v18, s[60:63], s46 offen offset:512 sc0 sc1
    s_mov_b64 exec, -1
L_alt1005_b:
L_alt1005_e:
    s_waitcnt vmcnt(23)
    v_mfma_f32_32x32x16_bf16 v[64:79], v[40:43], a[0:3], v[64:79]
    ds_read_b64_tr_b16 v[60:61], v11 offset:45056
    ds_read_b64_tr_b16 v[62:63], v11 offset:46080
    v_mfma_f32_32x32x16_bf16 v[80:95], v[44:47], a[0:3], v[80:95]
    ds_read_b64_tr_b16 v[40:41], v10 offset:47104
    ds_read_b64_tr_b16 v[42:43], v10 offset:48128
    s_waitcnt vmcnt(22)
    v_mfma_f32_32x32x16_bf16 v[64:79], v[48:51], a[4:7], v[64:79]
    ds_read_b64_tr_b16 v[44:45], v11 offset:47104
    ds_read_b64_tr_b16 v[46:47], v11 offset:48128
    v_mfma_f32_32x32x16_bf16 v[80:95], v[52:55], a[4:7], v[80:95]
    ds_read_b64_tr_b16 v[48:49], v10 offset:49152
    ds_read_b64_tr_b16 v[50:51], v10 offset:50176
    s_waitcnt vmcnt(21)
    v_mfma_f32_32x32x16_bf16 v[64:79], v[56:59], a[8:11], v[64:79]
    ds_read_b64_tr_b16 v[52:53], v11 offset:49152
    ds_read_b64_tr_b16 v[54:55], v11 offset:50176
    s_waitcnt lgkmcnt(6)
    v_mfma_f32_32x32x16_bf16 v[80:95], v[60:63], a[8:11], v[80:95]
    ds_read_b64_tr_b16 v[56:57], v10 offset:51200
    ds_read_b64_tr_b16 v[58:59], v10 offset:52224
    s_waitcnt vmcnt(20)
    v_mfma_f32_32x32x16_bf16 v[64:79], v[40:43], a[12:15], v[64:79]
    ds_read_b64_tr_b16 v[60:61], v11 offset:51200
    ds_read_b64_tr_b16 v[62:63], v11 offset:52224
    s_waitcnt lgkmcnt(6)
    v_mfma_f32_32x32x16_bf16 v[80:95], v[44:47], a[12:15], v[80:95]
    ds_read_b64_tr_b16 v[40:41], v10 offset:53248
    ds_read_b64_tr_b16 v[42:43], v10 offset:54272
    s_waitcnt vmcnt(19)
    v_mfma_f32_32x32x16_bf16 v[64:79], v[48:51], a[16:19], v[64:79]
    ds_read_b64_tr_b16 v[44:45], v11 offset:53248
    ds_read_b64_tr_b16 v[46:47], v11 offset:54272
    s_waitcnt lgkmcnt(6)
    v_mfma_f32_32x32x16_bf16 v[80:95], v[52:55], a[16:19], v[80:95]
    ds_read_b64_tr_b16 v[48:49], v10 offset:55296
    ds_read_b64_tr_b16 v[50:51], v10 offset:56320
    s_waitcnt vmcnt(18)
    v_mfma_f32_32x32x16_bf16 v[64:79], v[56:59], a[20:23], v[64:79]
    ds_read_b64_tr_b16 v[52:53], v11 offset:55296
    ds_read_b64_tr_b16 v[54:55], v11 offset:56320
    s_waitcnt lgkmcnt(6)
    v_mfma_f32_32x32x16_bf16 v[80:95], v[60:63], a[20:23], v[80:95]
    ds_read_b64_tr_b16 v[56:57], v10 offset:57344
    ds_read_b64_tr_b16 v[58:59], v10 offset:58368
    s_waitcnt vmcnt(17)
    v_mfma_f32_32x32x16_bf16 v[64:79], v[40:43], a[24:27], v[64:79]
L_SM_hop1:
    s_cbranch_execz L_SM_ret
    s_nop 0
    ds_read_b64_tr_b16 v[60:61], v11 offset:57344
    ds_read_b64_tr_b16 v[62:63], v11 offset:58368
    s_waitcnt lgkmcnt(6)
    v_mfma_f32_32x32x16_bf16 v[80:95], v[44:47], a[24:27], v[80:95]
    ds_read_b64_tr_b16 v[40:41], v10 offset:59392
    ds_read_b64_tr_b16 v[42:43], v10 offset:60416
    s_waitcnt vmcnt(16)
    v_mfma_f32_32x32x16_bf16 v[64:79], v[48:51], a[28:31], v[64:79]
    ds_read_b64_tr_b16 v[44:45], v11 offset:59392
    ds_read_b64_tr_b16 v[46:47], v11 offset:60416
    s_waitcnt lgkmcnt(6)
    v_mfma_f32_32x32x16_bf16 v[80:95], v[52:55], a[28:31], v[80:95]
    ds_read_b64_tr_b16 v[48:49], v10 offset:61440
    ds_read_b64_tr_b16 v[50:51], v10 offset:62464
    s_waitcnt vmcnt(15)
    v_mfma_f32_32x32x16_bf16 v[64:79], v[56:59], a[32:35], v[64:79]
    ds_read_b64_tr_b16 v[52:53], v11 offset:61440
    ds_read_b64_tr_b16 v[54:55], v11 offset:62464
    s_waitcnt lgkmcnt(6)
    v_mfma_f32_32x32x16_bf16 v[80:95], v[60:63], a[32:35], v[80:95]
    ds_read_b64_tr_b16 v[56:57], v10 offset:63488
    ds_read_b64_tr_b16 v[58:59], v10 offset:64512
    s_waitcnt vmcnt(14)
    v_mfma_f32_32x32x16_bf16 v[64:79], v[40:43], a[36:39], v[64:79]
    ds_read_b64_tr_b16 v[60:61], v11 offset:63488
    ds_read_b64_tr_b16 v[62:63], v11 offset:64512
    s_waitcnt lgkmcnt(6)
    v_mfma_f32_32x32x16_bf16 v[80:95], v[44:47], a[36:39], v[80:95]
    ds_read_b64_tr_b16 v[40:41], v12 offset:0
    ds_read_b64_tr_b16 v[42:43], v12 offset:1024
    s_waitcnt vmcnt(13)
    v_mfma_f32_32x32x16_bf16 v[64:79], v[48:51], a[40:43], v[64:79]
    ds_read_b64_tr_b16 v[44:45], v13 offset:0
    ds_read_b64_tr_b16 v[46:47], v13 offset:1024
    s_waitcnt lgkmcnt(6)
    v_mfma_f32_32x32x16_bf16 v[80:95], v[52:55], a[40:43], v[80:95]
    ds_read_b64_tr_b16 v[48:49], v12 offset:2048
    ds_read_b64_tr_b16 v[50:51], v12 offset:3072
    ds_write_b8 v16, v4 offset:68
    s_waitcnt vmcnt(12)
    v_mfma_f32_32x32x16_bf16 v[64:79], v[56:59], a[44:47], v[64:79]
    ds_read_b64_tr_b16 v[52:53], v13 offset:2048
    ds_read_b64_tr_b16 v[54:55], v13 offset:3072
    s_waitcnt lgkmcnt(7)
    v_mfma_f32_32x32x16_bf16 v[80:95], v[60:63], a[44:47], v[80:95]
    ds_read_b64_tr_b16 v[56:57], v12 offset:4096
    ds_read_b64_tr_b16 v[58:59], v12 offset:5120
    s_cmp_lg_u32 s3, 0
    s_cbranch_scc1 L_alt1006_b
    s_waitcnt vmcnt(0)
    v_cmp_gt_u32 vcc, 1, v9
    s_nop 0
    s_lshl_b64 vcc, vcc, 32
    s_cbranch_scc1 L_SM_p11_spin
L_SM_p11_ok:
    s_add_u32 s12, s48, 4096
    buffer_load_dword v8, v29, s[60:63], s12 offen sc1
    ds_write_b32 v5, v4 offset:40
L_alt1006_b:
L_alt1006_e:
    ds_read_b32 v6, v5 offset:40
    s_waitcnt lgkmcnt(0)
    v_cmp_gt_u32 vcc, 1, v6
    s_cbranch_vccnz L_SM_p16_spin
L_SM_p16_ok:
    s_waitcnt vmcnt(11)
    v_mfma_f32_32x32x16_bf16 v[64:79], v[40:43], a[48:51], v[64:79]
    ds_read_b64_tr_b16 v[60:61], v13 offset:4096
    ds_read_b64_tr_b16 v[62:63], v13 offset:5120
    s_add_u32 s83, s82, 4096
    buffer_load_dwordx4 a[96:99], v2, s[60:63], s83 offen offset:0 sc1
    v_mfma_f32_32x32x16_bf16 v[80:95], v[44:47], a[48:51], v[80:95]
    ds_read_b64_tr_b16 v[40:41], v12 offset:6144
    ds_read_b64_tr_b16 v[42:43], v12 offset:7168
    s_waitcnt vmcnt(11)
    v_mfma_f32_32x32x16_bf16 v[64:79], v[48:51], a[52:55], v[64:79]
    ds_read_b64_tr_b16 v[44:45], v13 offset:6144
    ds_read_b64_tr_b16 v[46:47], v13 offset:7168
    buffer_load_dwordx4 a[100:103], v2, s[60:63], s83 offen offset:1024 sc1
    v_mfma_f32_32x32x16_bf16 v[80:95], v[52:55], a[52:55], v[80:95]
    ds_read_b64_tr_b16 v[48:49], v12 offset:8192
    ds_read_b64_tr_b16 v[50:51], v12 offset:9216
    s_waitcnt vmcnt(11)
    v_mfma_f32_32x32x16_bf16 v[64:79], v[56:59], a[56:59], v[64:79]
    ds_read_b64_tr_b16 v[52:53], v13 offset:8192
    ds_read_b64_tr_b16 v[54:55], v13 offset:9216
    s_add_u32 s83, s82, 20480
    buffer_load_dwordx4 a[104:107], v2, s[60:63], s83 offen offset:0 sc1
    s_waitcnt lgkmcnt(6)
    v_mfma_f32_32x32x16_bf16 v[80:95], v[60:63], a[56:59], v[80:95]
    ds_read_b64_tr_b16 v[56:57], v12 offset:10240
    ds_read_b64_tr_b16 v[58:59], v12 offset:11264
    s_waitcnt vmcnt(11)
    v_mfma_f32_32x32x16_bf16 v[64:79], v[40:43], a[60:63], v[64:79]
    ds_read_b64_tr_b16 v[60:61], v13 offset:10240
    ds_read_b64_tr_b16 v[62:63], v13 offset:11264
    buffer_load_dwordx4 a[108:111], v2, s[60:63], s83 offen offset:1024 sc1
    s_waitcnt lgkmcnt(6)
    v_mfma_f32_32x32x16_bf16 v[80:95], v[44:47], a[60:63], v[80:95]
    ds_read_b64_tr_b16 v[40:41], v12 offset:12288
    ds_read_b64_tr_b16 v[42:43], v12 offset:13312
    s_waitcnt vmcnt(11)
    v_mfma_f32_32x32x16_bf16 v[64:79], v[48:51], a[64:67], v[64:79]
    ds_read_b64_tr_b16 v[44:45], v13 offset:12288
    ds_read_b64_tr_b16 v[46:47], v13 offset:13312
    s_add_u32 s83, s82, 36864
    buffer_load_dwordx4 a[112:115], v2, s[60:63], s83 offen offset:0 sc1
    s_waitcnt lgkmcnt(6)
    v_mfma_f32_32x32x16_bf16 v[80:95], v[52:55], a[64:67], v[80:95]
    ds_read_b64_tr_b16 v[48:49], v12 offset:14336
    ds_read_b64_tr_b16 v[50:51], v12 offset:15360
    s_waitcnt vmcnt(11)
    v_mfma_f32_32x32x16_bf16 v[64:79], v[56:59], a[68:71], v[64:79]
    ds_read_b64_tr_b16 v[52:53], v13 offset:14336
    ds_read_b64_tr_b16 v[54:55], v13 offset:15360
    buffer_load_dwordx4 a[116:119], v2, s[60:63], s83 offen offset:1024 sc1
    s_waitcnt lgkmcnt(6)
    v_mfma_f32_32x32x16_bf16 v[80:95], v[60:63], a[68:71], v[80:95]
    ds_read_b64_tr_b16 v[56:57], v12 offset:16384
    ds_read_b64_tr_b16 v[58:59], v12 offset:17408
    s_waitcnt vmcnt(11)
    v_mfma_f32_32x32x16_bf16 v[64:79], v[40:43], a[72:75], v[64:79]
    ds_read_b64_tr_b16 v[60:61], v13 offset:16384
    ds_read_b64_tr_b16 v[62:63], v13 offset:17408
    s_add_u32 s83, s82, 53248
    buffer_load_dwordx4 v[112:115], v2, s[60:63], s83 offen offset:0 sc1
    s_waitcnt lgkmcnt(6)
    v_mfma_f32_32x32x16_bf16 v[80:95], v[44:47], a[72:75], v[80:95]
    ds_read_b64_tr_b16 v[40:41], v12 offset:18432
    ds_read_b64_tr_b16 v[42:43], v12 offset:19456
    s_waitcnt vmcnt(11)
    v_mfma_f32_32x32x16_bf16 v[64:79], v[48:51], a[76:79], v[64:79]
    ds_read_b64_tr_b16 v[44:45], v13 offset:18432
    ds_read_b64_tr_b16 v[46:47], v13 offset:19456
    buffer_load_dwordx4 v[116:119], v2, s[60:63], s83 offen offset:1024 sc1
    s_waitcnt lgkmcnt(6)
    v_mfma_f32_32x32x16_bf16 v[80:95], v[52:55], a[76:79], v[80:95]
    ds_read_b64_tr_b16 v[48:49], v12 offset:20480
    ds_read_b64_tr_b16 v[50:51], v12 offset:21504
    s_waitcnt vmcnt(11)
    v_mfma_f32_32x32x16_bf16 v[64:79], v[56:59], a[80:83], v[64:79]
    ds_read_b64_tr_b16 v[52:53], v13 offset:20480
    ds_read_b64_tr_b16 v[54:55], v13 offset:21504
    s_add_u32 s83, s82, 69632
    buffer_load_dwordx4 v[120:123], v2, s[60:63], s83 offen offset:0 sc1
    s_waitcnt lgkmcnt(6)
    v_mfma_f32_32x32x16_bf16 v[80:95], v[60:63], a[80:83], v[80:95]
    ds_read_b64_tr_b16 v[56:57], v12 offset:22528
    ds_read_b64_tr_b16 v[58:59], v12 offset:23552
    s_waitcnt vmcnt(11)
    v_mfma_f32_32x32x16_bf16 v[64:79], v[40:43], a[84:87], v[64:79]
    ds_read_b64_tr_b16 v[60:61], v13 offset:22528
    ds_read_b64_tr_b16 v[62:63], v13 offset:23552
    buffer_load_dwordx4 v[124:127], v2, s[60:63], s83 offen offset:1024 sc1
    s_waitcnt lgkmcnt(6)
    v_mfma_f32_32x32x16_bf16 v[80:95], v[44:47], a[84:87], v[80:95]
    ds_read_b64_tr_b16 v[40:41], v12 offset:24576
    ds_read_b64_tr_b16 v[42:43], v12 offset:25600
    ds_read_b32 v6, v5 offset:44
    s_waitcnt vmcnt(11)
    v_mfma_f32_32x32x16_bf16 v[64:79], v[48:51], a[88:91], v[64:79]
    ds_read_b64_tr_b16 v[44:45], v13 offset:24576
    ds_read_b64_tr_b16 v[46:47], v13 offset:25600
    s_add_u32 s83, s82, 86016
    buffer_load_dwordx4 v[128:131], v2, s[60:63], s83 offen offset:0 sc1
    s_waitcnt lgkmcnt(7)
    v_mfma_f32_32x32x16_bf16 v[80:95], v[52:55], a[88:91], v[80:95]
    ds_read_b64_tr_b16 v[48:49], v12 offset:26624
    ds_read_b64_tr_b16 v[50:51], v12 offset:27648
    ds_write_b8 v16, v4 offset:72
    s_waitcnt vmcnt(11)
    v_mfma_f32_32x32x16_bf16 v[64:79], v[56:59], a[92:95], v[64:79]
    ds_read_b64_tr_b16 v[52:53], v13 offset:26624
    ds_read_b64_tr_b16 v[54:55], v13 offset:27648
    buffer_load_dwordx4 v[132:135], v2, s[60:63], s83 offen offset:1024 sc1
    s_waitcnt lgkmcnt(8)
    v_mfma_f32_32x32x16_bf16 v[80:95], v[60:63], a[92:95], v[80:95]
    ds_read_b64_tr_b16 v[56:57], v12 offset:28672
    ds_read_b64_tr_b16 v[58:59], v12 offset:29696
    s_waitcnt lgkmcnt(9)
    v_cmp_gt_u32_e64 vcc, 1, v6
    s_cbranch_vccnz L_SM_p17_spin
L_SM_p17_ok:
    s_waitcnt vmcnt(11)
    v_mfma_f32_32x32x16_bf16 v[64:79], v[40:43], a[96:99], v[64:79]
    ds_read_b64_tr_b16 v[60:61], v13 offset:28672
    ds_read_b64_tr_b16 v[62:63], v13 offset:29696
    s_add_u32 s83, s82, 6144
    buffer_load_dwordx4 a[0:3], v2, s[60:63], s83 offen offset:0 sc1
    s_waitcnt lgkmcnt(7)
    v_mfma_f32_32x32x16_bf16 v[80:95], v[44:47], a[96:99], v[80:95]
    ds_read_b64_tr_b16 v[40:41], v12 offset:30720
    ds_read_b64_tr_b16 v[42:43], v12 offset:31744
    s_waitcnt vmcnt(11)
    v_mfma_f32_32x32x16_bf16 v[64:79], v[48:51], a[100:103], v[64:79]
    ds_read_b64_tr_b16 v[44:45], v13 offset:30720
    ds_read_b64_tr_b16 v[46:47], v13 offset:31744
    buffer_load_dwordx4 a[4:7], v2, s[60:63], s83 offen offset:1024 sc1
    s_waitcnt lgkmcnt(6)
    v_mfma_f32_32x32x16_bf16 v[80:95], v[52:55], a[100:103], v[80:95]
    ds_read_b64_tr_b16 v[48:49], v12 offset:32768
    ds_read_b64_tr_b16 v[50:51], v12 offset:33792
    s_waitcnt vmcnt(11)
    v_mfma_f32_32x32x16_bf16 v[64:79], v[56:59], a[104:107], v[64:79]
    ds_read_b64_tr_b16 v[52:53], v13 offset:32768
    ds_read_b64_tr_b16 v[54:55], v13 offset:33792
    s_add_u32 s83, s82, 22528
    buffer_load_dwordx4 a[8:11], v2, s[60:63], s83 offen offset:0 sc1
    s_waitcnt lgkmcnt(6)
    v_mfma_f32_32x32x16_bf16 v[80:95], v[60:63], a[104:107], v[80:95]
    ds_read_b64_tr_b16 v[56:57], v12 offset:34816
    ds_read_b64_tr_b16 v[58:59], v12 offset:35840
    s_waitcnt vmcnt(11)
    v_mfma_f32_32x32x16_bf16 v[64:79], v[40:43], a[108:111], v[64:79]
    ds_read_b64_tr_b16 v[60:61], v13 offset:34816
    ds_read_b64_tr_b16 v[62:63], v13 offset:35840
    buffer_load_dwordx4 a[12:15], v2, s[60:63], s83 offen offset:1024 sc1
    s_waitcnt lgkmcnt(6)
    v_mfma_f32_32x32x16_bf16 v[80:95], v[44:47], a[108:111], v[80:95]
    ds_read_b64_tr_b16 v[40:41], v12 offset:36864
    ds_read_b64_tr_b16 v[42:43], v12 offset:37888
    s_waitcnt vmcnt(11)
    v_mfma_f32_32x32x16_bf16 v[64:79], v[48:51], a[112:115], v[64:79]
    ds_read_b64_tr_b16 v[44:45], v13 offset:36864
    ds_read_b64_tr_b16 v[46:47], v13 offset:37888
    s_add_u32 s83, s82, 38912
    buffer_load_dwordx4 a[16:19], v2, s[60:63], s83 offen offset:0 sc1
    s_waitcnt lgkmcnt(6)
    v_mfma_f32_32x32x16_bf16 v[80:95], v[52:55], a[112:115], v[80:95]
    ds_read_b64_tr_b16 v[48:49], v12 offset:38912
    ds_read_b64_tr_b16 v[50:51], v12 offset:39936
    s_waitcnt vmcnt(11)
    v_mfma_f32_32x32x16_bf16 v[64:79], v[56:59], a[116:119], v[64:79]
    ds_read_b64_tr_b16 v[52:53], v13 offset:38912
    ds_read_b64_tr_b16 v[54:55], v13 offset:39936
    buffer_load_dwordx4 a[20:23], v2, s[60:63], s83 offen offset:1024 sc1
    s_waitcnt lgkmcnt(6)
    v_mfma_f32_32x32x16_bf16 v[80:95], v[60:63], a[116:119], v[80:95]
    ds_read_b64_tr_b16 v[56:57], v12 offset:40960
    ds_read_b64_tr_b16 v[58:59], v12 offset:41984
    s_waitcnt vmcnt(11)
    v_mfma_f32_32x32x16_bf16 v[64:79], v[40:43], v[112:115], v[64:79]
    ds_read_b64_tr_b16 v[60:61], v13 offset:40960
    ds_read_b64_tr_b16 v[62:63], v13 offset:41984
    s_add_u32 s83, s82, 55296
    buffer_load_dwordx4 a[24:27], v2, s[60:63], s83 offen offset:0 sc1
    s_waitcnt lgkmcnt(6)
    v_mfma_f32_32x32x16_bf16 v[80:95], v[44:47], v[112:115], v[80:95]
    ds_read_b64_tr_b16 v[40:41], v12 offset:43008
    ds_read_b64_tr_b16 v[42:43], v12 offset:44032
    s_waitcnt vmcnt(11)
    v_mfma_f32_32x32x16_bf16 v[64:79], v[48:51], v[116:119], v[64:79]
    ds_read_b64_tr_b16 v[44:45], v13 offset:43008
    ds_read_b64_tr_b16 v[46:47], v13 offset:44032
    buffer_load_dwordx4 a[28:31], v2, s[60:63], s83 offen offset:1024 sc1
    s_waitcnt lgkmcnt(6)
    v_mfma_f32_32x32x16_bf16 v[80:95], v[52:55], v[116:119], v[80:95]
    ds_read_b64_tr_b16 v[48:49], v12 offset:45056
    ds_read_b64_tr_b16 v[50:51], v12 offset:46080
    s_waitcnt vmcnt(11)
    v_mfma_f32_32x32x16_bf16 v[64:79], v[56:59], v[120:123], v[64:79]
    ds_read_b64_tr_b16 v[52:53], v13 offset:45056
    ds_read_b64_tr_b16 v[54:55], v13 offset:46080
    s_add_u32 s83, s82, 71680
    buffer_load_dwordx4 a[32:35], v2, s[60:63], s83 offen offset:0 sc1
    s_waitcnt lgkmcnt(6)
    v_mfma_f32_32x32x16_bf16 v[80:95], v[60:63], v[120:123], v[80:95]
    ds_read_b64_tr_b16 v[56:57], v12 offset:47104
    ds_read_b64_tr_b16 v[58:59], v12 offset:48128
    s_waitcnt vmcnt(11)
    v_mfma_f32_32x32x16_bf16 v[64:79], v[40:43], v[124:127], v[64:79]
    ds_read_b64_tr_b16 v[60:61], v13 offset:47104
    ds_read_b64_tr_b16 v[62:63], v13 offset:48128
    buffer_load_dwordx4 a[36:39], v2, s[60:63], s83 offen offset:1024 sc1
    s_waitcnt lgkmcnt(6)
    v_mfma_f32_32x32x16_bf16 v[80:95], v[44:47], v[124:127], v[80:95]
    ds_read_b64_tr_b16 v[40:41], v14 offset:0
    ds_read_b64_tr_b16 v[42:43], v14 offset:1024
    ds_read_b32 v6, v5 offset:48
    s_waitcnt vmcnt(11)
    v_mfma_f32_32x32x16_bf16 v[64:79], v[48:51], v[128:131], v[64:79]
    ds_read_b64_tr_b16 v[44:45], v15 offset:0
    ds_read_b64_tr_b16 v[46:47], v15 offset:1024
    s_add_u32 s83, s82, 88064
    buffer_load_dwordx4 a[40:43], v2, s[60:63], s83 offen offset:0 sc1
    s_waitcnt lgkmcnt(7)
    v_mfma_f32_32x32x16_bf16 v[80:95], v[52:55], v[128:131], v[80:95]
    ds_read_b64_tr_b16 v[48:49], v14 offset:2048
    ds_read_b64_tr_b16 v[50:51], v14 offset:3072
    ds_write_b8 v16, v4 offset:76
    s_waitcnt vmcnt(11)
    v_mfma_f32_32x32x16_bf16 v[64:79], v[56:59], v[132:135], v[64:79]
    ds_read_b64_tr_b16 v[52:53], v15 offset:2048
    ds_read_b64_tr_b16 v[54:55], v15 offset:3072
    buffer_load_dwordx4 a[44:47], v2, s[60:63], s83 offen offset:1024 sc1
    s_waitcnt lgkmcnt(8)
    v_mfma_f32_32x32x16_bf16 v[80:95], v[60:63], v[132:135], v[80:95]
    ds_read_b64_tr_b16 v[56:57], v14 offset:4096
    ds_read_b64_tr_b16 v[58:59], v14 offset:5120
    s_waitcnt lgkmcnt(9)
    v_cmp_gt_u32_e64 vcc, 1, v6
    s_cbranch_vccnz L_SM_p18_spin
L_SM_p18_ok:
    s_waitcnt vmcnt(11)
    v_mfma_f32_32x32x16_bf16 v[64:79], v[40:43], a[0:3], v[64:79]
    ds_read_b64_tr_b16 v[60:61], v15 offset:4096
    ds_read_b64_tr_b16 v[62:63], v15 offset:5120
    s_add_u32 s83, s82, 8192
    buffer_load_dwordx4 a[48:51], v2, s[60:63], s83 offen offset:0 sc1
    s_waitcnt lgkmcnt(7)
    v_mfma_f32_32x32x16_bf16 v[80:95], v[44:47], a[0:3], v[80:95]
    ds_read_b64_tr_b16 v[40:41], v14 offset:6144
    ds_read_b64_tr_b16 v[42:43], v14 offset:7168
    s_waitcnt vmcnt(11)
    v_mfma_f32_32x32x16_bf16 v[64:79], v[48:51], a[4:7], v[64:79]
    ds_read_b64_tr_b16 v[44:45], v15 offset:6144
    ds_read_b64_tr_b16 v[46:47], v15 offset:7168
    buffer_load_dwordx4 a[52:55], v2, s[60:63], s83 offen offset:1024 sc1
    s_waitcnt lgkmcnt(6)
    v_mfma_f32_32x32x16_bf16 v[80:95], v[52:55], a[4:7], v[80:95]
    ds_read_b64_tr_b16 v[48:49], v14 offset:8192
    ds_read_b64_tr_b16 v[50:51], v14 offset:9216
    s_waitcnt vmcnt(11)
    v_mfma_f32_32x32x16_bf16 v[64:79], v[56:59], a[8:11], v[64:79]
    ds_read_b64_tr_b16 v[52:53], v15 offset:8192
    ds_read_b64_tr_b16 v[54:55], v15 offset:9216
    s_add_u32 s83, s82, 24576
    buffer_load_dwordx4 a[56:59], v2, s[60:63], s83 offen offset:0 sc1
    s_waitcnt lgkmcnt(6)
    v_mfma_f32_32x32x16_bf16 v[80:95], v[60:63], a[8:11], v[80:95]
    ds_read_b64_tr_b16 v[56:57], v14 offset:10240
    ds_read_b64_tr_b16 v[58:59], v14 offset:11264
    s_waitcnt vmcnt(11)
    v_mfma_f32_32x32x16_bf16 v[64:79], v[40:43], a[12:15], v[64:79]
    ds_read_b64_tr_b16 v[60:61], v15 offset:10240
    ds_read_b64_tr_b16 v[62:63], v15 offset:11264
    buffer_load_dwordx4 a[60:63], v2, s[60:63], s83 offen offset:1024 sc1
    s_waitcnt lgkmcnt(6)
    v_mfma_f32_32x32x16_bf16 v[80:95], v[44:47], a[12:15], v[80:95]
    ds_read_b64_tr_b16 v[40:41], v14 offset:12288
    ds_read_b64_tr_b16 v[42:43], v14 offset:13312
    s_waitcnt vmcnt(11)
    v_mfma_f32_32x32x16_bf16 v[64:79], v[48:51], a[16:19], v[64:79]
    ds_read_b64_tr_b16 v[44:45], v15 offset:12288
    ds_read_b64_tr_b16 v[46:47], v15 offset:13312
    s_add_u32 s83, s82, 40960
    buffer_load_dwordx4 a[64:67], v2, s[60:63], s83 offen offset:0 sc1
    s_waitcnt lgkmcnt(6)
    v_mfma_f32_32x32x16_bf16 v[80:95], v[52:55], a[16:19], v[80:95]
    ds_read_b64_tr_b16 v[48:49], v14 offset:14336
    ds_read_b64_tr_b16 v[50:51], v14 offset:15360
    s_waitcnt vmcnt(11)
    v_mfma_f32_32x32x16_bf16 v[64:79], v[56:59], a[20:23], v[64:79]
    ds_read_b64_tr_b16 v[52:53], v15 offset:14336
    ds_read_b64_tr_b16 v[54:55], v15 offset:15360
    buffer_load_dwordx4 a[68:71], v2, s[60:63], s83 offen offset:1024 sc1
    s_waitcnt lgkmcnt(6)
    v_mfma_f32_32x32x16_bf16 v[80:95], v[60:63], a[20:23], v[80:95]
    ds_read_b64_tr_b16 v[56:57], v14 offset:16384
    ds_read_b64_tr_b16 v[58:59], v14 offset:17408
    s_waitcnt vmcnt(11)
    v_mfma_f32_32x32x16_bf16 v[64:79], v[40:43], a[24:27], v[64:79]
    ds_read_b64_tr_b16 v[60:61], v15 offset:16384
    ds_read_b64_tr_b16 v[62:63], v15 offset:17408
    s_add_u32 s83, s82, 57344
    buffer_load_dwordx4 a[72:75], v2, s[60:63], s83 offen offset:0 sc1
    s_waitcnt lgkmcnt(6)
    v_mfma_f32_32x32x16_bf16 v[80:95], v[44:47], a[24:27], v[80:95]
    ds_read_b64_tr_b16 v[40:41], v14 offset:18432
    ds_read_b64_tr_b16 v[42:43], v14 offset:19456
    s_waitcnt vmcnt(11)
    v_mfma_f32_32x32x16_bf16 v[64:79], v[48:51], a[28:31], v[64:79]
    ds_read_b64_tr_b16 v[44:45], v15 offset:18432
    ds_read_b64_tr_b16 v[46:47], v15 offset:19456
    buffer_load_dwordx4 a[76:79], v2, s[60:63], s83 offen offset:1024 sc1
    s_waitcnt lgkmcnt(6)
    v_mfma_f32_32x32x16_bf16 v[80:95], v[52:55], a[28:31], v[80:95]
    ds_read_b64_tr_b16 v[48:49], v14 offset:20480
    ds_read_b64_tr_b16 v[50:51], v14 offset:21504
    s_waitcnt vmcnt(11)
    v_mfma_f32_32x32x16_bf16 v[64:79], v[56:59], a[32:35], v[64:79]
    ds_read_b64_tr_b16 v[52:53], v15 offset:20480
    ds_read_b64_tr_b16 v[54:55], v15 offset:21504
    s_add_u32 s83, s82, 73728
    buffer_load_dwordx4 a[80:83], v2, s[60:63], s83 offen offset:0 sc1
    s_waitcnt lgkmcnt(6)
    v_mfma_f32_32x32x16_bf16 v[80:95], v[60:63], a[32:35], v[80:95]
    ds_read_b64_tr_b16 v[56:57], v14 offset:22528
    ds_read_b64_tr_b16 v[58:59], v14 offset:23552
    s_waitcnt vmcnt(11)
    v_mfma_f32_32x32x16_bf16 v[64:79], v[40:43], a[36:39], v[64:79]
    ds_read_b64_tr_b16 v[60:61], v15 offset:22528
    ds_read_b64_tr_b16 v[62:63], v15 offset:23552
    buffer_load_dwordx4 a[84:87], v2, s[60:63], s83 offen offset:1024 sc1
    s_waitcnt lgkmcnt(6)
    v_mfma_f32_32x32x16_bf16 v[80:95], v[44:47], a[36:39], v[80:95]
    ds_read_b64_tr_b16 v[40:41], v14 offset:24576
    ds_read_b64_tr_b16 v[42:43], v14 offset:25600
    ds_read_b32 v6, v5 offset:52
    s_waitcnt vmcnt(11)
    v_mfma_f32_32x32x16_bf16 v[64:79], v[48:51], a[40:43], v[64:79]
    ds_read_b64_tr_b16 v[44:45], v15 offset:24576
    ds_read_b64_tr_b16 v[46:47], v15 offset:25600
    s_add_u32 s83, s82, 90112
    buffer_load_dwordx4 a[88:91], v2, s[60:63], s83 offen offset:0 sc1
    s_waitcnt lgkmcnt(7)
    v_mfma_f32_32x32x16_bf16 v[80:95], v[52:55], a[40:43], v[80:95]
    ds_read_b64_tr_b16 v[48:49], v14 offset:26624
    ds_read_b64_tr_b16 v[50:51], v14 offset:27648
    ds_write_b8 v16, v4 offset:80
    s_waitcnt vmcnt(11)
    v_mfma_f32_32x32x16_bf16 v[64:79], v[56:59], a[44:47], v[64:79]
    ds_read_b64_tr_b16 v[52:53], v15 offset:26624
    ds_read_b64_tr_b16 v[54:55], v15 offset:27648
    buffer_load_dwordx4 a[92:95], v2, s[60:63], s83 offen offset:1024 sc1
    s_waitcnt lgkmcnt(8)
    v_mfma_f32_32x32x16_bf16 v[80:95], v[60:63], a[44:47], v[80:95]
    ds_read_b64_tr_b16 v[56:57], v14 offset:28672
    ds_read_b64_tr_b16 v[58:59], v14 offset:29696
    s_waitcnt lgkmcnt(9)
    v_cmp_gt_u32_e64 vcc, 1, v6
    s_cbranch_vccnz L_SM_p19_spin
L_SM_p19_ok:
    s_waitcnt vmcnt(11)
    v_mfma_f32_32x32x16_bf16 v[64:79], v[40:43], a[48:51], v[64:79]
    ds_read_b64_tr_b16 v[60:61], v15 offset:28672
    ds_read_b64_tr_b16 v[62:63], v15 offset:29696
    s_add_u32 s83, s82, 10240
    buffer_load_dwordx4 a[96:99], v2, s[60:63], s83 offen offset:0 sc1
    s_waitcnt lgkmcnt(7)
    v_mfma_f32_32x32x16_bf16 v[80:95], v[44:47], a[48:51], v[80:95]
    ds_read_b64_tr_b16 v[40:41], v14 offset:30720
    ds_read_b64_tr_b16 v[42:43], v14 offset:31744
    s_waitcnt vmcnt(11)
    v_mfma_f32_32x32x16_bf16 v[64:79], v[48:51], a[52:55], v[64:79]
    ds_read_b64_tr_b16 v[44:45], v15 offset:30720
    ds_read_b64_tr_b16 v[46:47], v15 offset:31744
    buffer_load_dwordx4 a[100:103], v2, s[60:63], s83 offen offset:1024 sc1
    s_waitcnt lgkmcnt(6)
    v_mfma_f32_32x32x16_bf16 v[80:95], v[52:55], a[52:55], v[80:95]
    ds_read_b64_tr_b16 v[48:49], v14 offset:32768
    ds_read_b64_tr_b16 v[50:51], v14 offset:33792
    s_waitcnt vmcnt(11)
    v_mfma_f32_32x32x16_bf16 v[64:79], v[56:59], a[56:59], v[64:79]
    ds_read_b64_tr_b16 v[52:53], v15 offset:32768
    ds_read_b64_tr_b16 v[54:55], v15 offset:33792
    s_add_u32 s83, s82, 26624
    buffer_load_dwordx4 a[104:107], v2, s[60:63], s83 offen offset:0 sc1
    s_waitcnt lgkmcnt(6)
    v_mfma_f32_32x32x16_bf16 v[80:95], v[60:63], a[56:59], v[80:95]
    ds_read_b64_tr_b16 v[56:57], v14 offset:34816
    ds_read_b64_tr_b16 v[58:59], v14 offset:35840
    s_waitcnt vmcnt(11)
    v_mfma_f32_32x32x16_bf16 v[64:79], v[40:43], a[60:63], v[64:79]
    ds_read_b64_tr_b16 v[60:61], v15 offset:34816
    ds_read_b64_tr_b16 v[62:63], v15 offset:35840
    buffer_load_dwordx4 a[108:111], v2, s[60:63], s83 offen offset:1024 sc1
    s_waitcnt lgkmcnt(6)
    v_mfma_f32_32x32x16_bf16 v[80:95], v[44:47], a[60:63], v[80:95]
    ds_read_b64_tr_b16 v[40:41], v14 offset:36864
    ds_read_b64_tr_b16 v[42:43], v14 offset:37888
    s_waitcnt vmcnt(11)
    v_mfma_f32_32x32x16_bf16 v[64:79], v[48:51], a[64:67], v[64:79]
    ds_read_b64_tr_b16 v[44:45], v15 offset:36864
    ds_read_b64_tr_b16 v[46:47], v15 offset:37888
    s_add_u32 s83, s82, 43008
    buffer_load_dwordx4 a[112:115], v2, s[60:63], s83 offen offset:0 sc1
    s_waitcnt lgkmcnt(6)
    v_mfma_f32_32x32x16_bf16 v[80:95], v[52:55], a[64:67], v[80:95]
    ds_read_b64_tr_b16 v[48:49], v14 offset:38912
    ds_read_b64_tr_b16 v[50:51], v14 offset:39936
    s_waitcnt vmcnt(11)
    v_mfma_f32_32x32x16_bf16 v[64:79], v[56:59], a[68:71], v[64:79]
    ds_read_b64_tr_b16 v[52:53], v15 offset:38912
    ds_read_b64_tr_b16 v[54:55], v15 offset:39936
    buffer_load_dwordx4 a[116:119], v2, s[60:63], s83 offen offset:1024 sc1
    s_waitcnt lgkmcnt(6)
    v_mfma_f32_32x32x16_bf16 v[80:95], v[60:63], a[68:71], v[80:95]
    ds_read_b64_tr_b16 v[56:57], v14 offset:40960
    ds_read_b64_tr_b16 v[58:59], v14 offset:41984
    ds_read_b32 v7, v5 offset:104
    s_waitcnt vmcnt(11)
    v_mfma_f32_32x32x16_bf16 v[64:79], v[40:43], a[72:75], v[64:79]
    ds_read_b64_tr_b16 v[60:61], v15 offset:40960
    ds_read_b64_tr_b16 v[62:63], v15 offset:41984
    s_add_u32 s83, s82, 59392
    buffer_load_dwordx4 v[112:115], v2, s[60:63], s83 offen offset:0 sc1
    s_waitcnt lgkmcnt(7)
    v_mfma_f32_32x32x16_bf16 v[80:95], v[44:47], a[72:75], v[80:95]
    ds_read_b64_tr_b16 v[40:41], v14 offset:43008
    ds_read_b64_tr_b16 v[42:43], v14 offset:44032
    s_waitcnt vmcnt(11)
    v_mfma_f32_32x32x16_bf16 v[64:79], v[48:51], a[76:79], v[64:79]
    ds_read_b64_tr_b16 v[44:45], v15 offset:43008
    ds_read_b64_tr_b16 v[46:47], v15 offset:44032
    buffer_load_dwordx4 v[116:119], v2, s[60:63], s83 offen offset:1024 sc1
    s_waitcnt lgkmcnt(7)
    v_mfma_f32_32x32x16_bf16 v[80:95], v[52:55], a[76:79], v[80:95]
    ds_read_b64_tr_b16 v[48:49], v14 offset:45056
    ds_read_b64_tr_b16 v[50:51], v14 offset:46080
    s_waitcnt vmcnt(11)
    v_mfma_f32_32x32x16_bf16 v[64:79], v[56:59], a[80:83], v[64:79]
    ds_read_b64_tr_b16 v[52:53], v15 offset:45056
    ds_read_b64_tr_b16 v[54:55], v15 offset:46080
    s_add_u32 s83, s82, 75776
    buffer_load_dwordx4 v[120:123], v2, s[60:63], s83 offen offset:0 sc1
    s_waitcnt lgkmcnt(6)
    v_mfma_f32_32x32x16_bf16 v[80:95], v[60:63], a[80:83], v[80:95]
    ds_read_b64_tr_b16 v[56:57], v14 offset:47104
    ds_read_b64_tr_b16 v[58:59], v14 offset:48128
    v_cmp_gt_u32 vcc, 16843009, v7
    s_cbranch_vccnz L_SM_p12_spin
L_SM_p12_ok:
    s_waitcnt vmcnt(11)
    v_mfma_f32_32x32x16_bf16 v[64:79], v[40:43], a[84:87], v[64:79]
    ds_read_b64_tr_b16 v[60:61], v15 offset:47104
    ds_read_b64_tr_b16 v[62:63], v15 offset:48128
    buffer_load_dwordx4 v[124:127], v2, s[60:63], s83 offen offset:1024 sc1
    s_waitcnt lgkmcnt(6)
    v_mfma_f32_32x32x16_bf16 v[80:95], v[44:47], a[84:87], v[80:95]
    ds_read_b64_tr_b16 v[40:41], v10 offset:0
    ds_read_b64_tr_b16 v[42:43], v10 offset:1024
    ds_read_b32 v6, v5 offset:56
    s_waitcnt vmcnt(11)
    v_mfma_f32_32x32x16_bf16 v[64:79], v[48:51], a[88:91], v[64:79]
    ds_read_b64_tr_b16 v[44:45], v11 offset:0
    ds_read_b64_tr_b16 v[46:47], v11 offset:1024
    s_add_u32 s83, s82, 92160
    buffer_load_dwordx4 v[128:131], v2, s[60:63], s83 offen offset:0 sc1
    s_waitcnt lgkmcnt(7)
    v_mfma_f32_32x32x16_bf16 v[80:95], v[52:55], a[88:91], v[80:95]
    ds_read_b64_tr_b16 v[48:49], v10 offset:2048
    ds_read_b64_tr_b16 v[50:51], v10 offset:3072
    s_waitcnt vmcnt(11)
    v_mfma_f32_32x32x16_bf16 v[64:79], v[56:59], a[92:95], v[64:79]
    ds_read_b64_tr_b16 v[52:53], v11 offset:2048
    ds_read_b64_tr_b16 v[54:55], v11 offset:3072
    buffer_load_dwordx4 v[132:135], v2, s[60:63], s83 offen offset:1024 sc1
    s_waitcnt lgkmcnt(7)
    v_mfma_f32_32x32x16_bf16 v[80:95], v[60:63], a[92:95], v[80:95]
    ds_read_b64_tr_b16 v[56:57], v10 offset:4096
    ds_read_b64_tr_b16 v[58:59], v10 offset:5120
    ds_read_b32 v7, v5 offset:116
    s_waitcnt lgkmcnt(0)
    v_cmp_gt_u32_e64 vcc, 1, v7
    s_cbranch_vccnz L_SM_p20_spin
L_SM_p20_ok:
    ds_read_b128 v[96:99], v20 offset:0
    ds_read_b128 v[100:103], v20 offset:16
    ds_read_b128 v[104:107], v20 offset:8320
    ds_read_b128 v[108:111], v20 offset:8336
    s_waitcnt lgkmcnt(3)
    v_mfma_f32_32x32x16_bf16 v[64:79], v[96:99], v[32:35], v[64:79]
    s_waitcnt lgkmcnt(2)
    v_mfma_f32_32x32x16_bf16 v[64:79], v[100:103], v[36:39], v[64:79]
    s_waitcnt lgkmcnt(1)
    v_mfma_f32_32x32x16_bf16 v[80:95], v[104:107], v[32:35], v[80:95]
    s_waitcnt lgkmcnt(0)
    v_mfma_f32_32x32x16_bf16 v[80:95], v[108:111], v[36:39], v[80:95]
    v_cmp_gt_u32_e64 vcc, 1, v6
    s_cbranch_vccnz L_SM_p21_spin
L_SM_p21_ok:
    s_waitcnt vmcnt(11)
    v_mfma_f32_32x32x16_bf16 v[64:79], v[40:43], a[96:99], v[64:79]
    ds_read_b64_tr_b16 v[60:61], v11 offset:4096
    ds_read_b64_tr_b16 v[62:63], v11 offset:5120
    s_add_u32 s83, s82, 12288
    buffer_load_dwordx4 a[0:3], v2, s[60:63], s83 offen offset:0 sc1
    v_mfma_f32_32x32x16_bf16 v[80:95], v[44:47], a[96:99], v[80:95]
    ds_read_b64_tr_b16 v[40:41], v10 offset:6144
    ds_read_b64_tr_b16 v[42:43], v10 offset:7168
    s_waitcnt vmcnt(11)
    v_mfma_f32_32x32x16_bf16 v[64:79], v[48:51], a[100:103], v[64:79]
    ds_read_b64_tr_b16 v[44:45], v11 offset:6144
    ds_read_b64_tr_b16 v[46:47], v11 offset:7168
    buffer_load_dwordx4 a[4:7], v2, s[60:63], s83 offen offset:1024 sc1
    v_mfma_f32_32x32x16_bf16 v[80:95], v[52:55], a[100:103], v[80:95]
    ds_read_b64_tr_b16 v[48:49], v10 offset:8192
    ds_read_b64_tr_b16 v[50:51], v10 offset:9216
    s_waitcnt vmcnt(11)
    v_mfma_f32_32x32x16_bf16 v[64:79], v[56:59], a[104:107], v[64:79]
    ds_read_b64_tr_b16 v[52:53], v11 offset:8192
    ds_read_b64_tr_b16 v[54:55], v11 offset:9216
    s_add_u32 s83, s82, 28672
    buffer_load_dwordx4 a[8:11], v2, s[60:63], s83 offen offset:0 sc1
    s_waitcnt lgkmcnt(6)
    v_mfma_f32_32x32x16_bf16 v[80:95], v[60:63], a[104:107], v[80:95]
    ds_read_b64_tr_b16 v[56:57], v10 offset:10240
L_SM_hop2:
    s_cbranch_execz L_SM_ret
    s_nop 0
    ds_read_b64_tr_b16 v[58:59], v10 offset:11264
    s_waitcnt vmcnt(11)
    v_mfma_f32_32x32x16_bf16 v[64:79], v[40:43], a[108:111], v[64:79]
    ds_read_b64_tr_b16 v[60:61], v11 offset:10240
    ds_read_b64_tr_b16 v[62:63], v11 offset:11264
    buffer_load_dwordx4 a[12:15], v2, s[60:63], s83 offen offset:1024 sc1
    s_waitcnt lgkmcnt(6)
    v_mfma_f32_32x32x16_bf16 v[80:95], v[44:47], a[108:111], v[80:95]
    ds_read_b64_tr_b16 v[40:41], v10 offset:12288
    ds_read_b64_tr_b16 v[42:43], v10 offset:13312
    s_waitcnt vmcnt(11)
    v_mfma_f32_32x32x16_bf16 v[64:79], v[48:51], a[112:115], v[64:79]
    ds_read_b64_tr_b16 v[44:45], v11 offset:12288
    ds_read_b64_tr_b16 v[46:47], v11 offset:13312
    s_add_u32 s83, s82, 45056
    buffer_load_dwordx4 a[16:19], v2, s[60:63], s83 offen offset:0 sc1
    s_waitcnt lgkmcnt(6)
    v_mfma_f32_32x32x16_bf16 v[80:95], v[52:55], a[112:115], v[80:95]
    ds_read_b64_tr_b16 v[48:49], v10 offset:14336
    ds_read_b64_tr_b16 v[50:51], v10 offset:15360
    s_waitcnt vmcnt(11)
    v_mfma_f32_32x32x16_bf16 v[64:79], v[56:59], a[116:119], v[64:79]
    ds_read_b64_tr_b16 v[52:53], v11 offset:14336
    ds_read_b64_tr_b16 v[54:55], v11 offset:15360
    buffer_load_dwordx4 a[20:23], v2, s[60:63], s83 offen offset:1024 sc1
    s_waitcnt lgkmcnt(6)
    v_mfma_f32_32x32x16_bf16 v[80:95], v[60:63], a[116:119], v[80:95]
    ds_read_b64_tr_b16 v[56:57], v10 offset:16384
    ds_read_b64_tr_b16 v[58:59], v10 offset:17408
    ds_read_b32 v7, v5 offset:108
    s_waitcnt vmcnt(11)
    v_mfma_f32_32x32x16_bf16 v[64:79], v[40:43], v[112:115], v[64:79]
    ds_read_b64_tr_b16 v[60:61], v11 offset:16384
    ds_read_b64_tr_b16 v[62:63], v11 offset:17408
    s_add_u32 s83, s82, 61440
    buffer_load_dwordx4 a[24:27], v2, s[60:63], s83 offen offset:0 sc1
    s_waitcnt lgkmcnt(7)
    v_mfma_f32_32x32x16_bf16 v[80:95], v[44:47], v[112:115], v[80:95]
    ds_read_b64_tr_b16 v[40:41], v10 offset:18432
    ds_read_b64_tr_b16 v[42:43], v10 offset:19456
    s_waitcnt vmcnt(11)
    v_mfma_f32_32x32x16_bf16 v[64:79], v[48:51], v[116:119], v[64:79]
    ds_read_b64_tr_b16 v[44:45], v11 offset:18432
    ds_read_b64_tr_b16 v[46:47], v11 offset:19456
    buffer_load_dwordx4 a[28:31], v2, s[60:63], s83 offen offset:1024 sc1
    s_waitcnt lgkmcnt(7)
    v_mfma_f32_32x32x16_bf16 v[80:95], v[52:55], v[116:119], v[80:95]
    ds_read_b64_tr_b16 v[48:49], v10 offset:20480
    ds_read_b64_tr_b16 v[50:51], v10 offset:21504
    s_waitcnt vmcnt(11)
    v_mfma_f32_32x32x16_bf16 v[64:79], v[56:59], v[120:123], v[64:79]
    ds_read_b64_tr_b16 v[52:53], v11 offset:20480
    ds_read_b64_tr_b16 v[54:55], v11 offset:21504
    s_add_u32 s83, s82, 77824
    buffer_load_dwordx4 a[32:35], v2, s[60:63], s83 offen offset:0 sc1
    s_waitcnt lgkmcnt(6)
    v_mfma_f32_32x32x16_bf16 v[80:95], v[60:63], v[120:123], v[80:95]
    ds_read_b64_tr_b16 v[56:57], v10 offset:22528
    ds_read_b64_tr_b16 v[58:59], v10 offset:23552
    v_cmp_gt_u32 vcc, 16843009, v7
    s_cbranch_vccnz L_SM_p13_spin
L_SM_p13_ok:
    s_waitcnt vmcnt(11)
    v_mfma_f32_32x32x16_bf16 v[64:79], v[40:43], v[124:127], v[64:79]
    ds_read_b64_tr_b16 v[60:61], v11 offset:22528
    ds_read_b64_tr_b16 v[62:63], v11 offset:23552
    buffer_load_dwordx4 a[36:39], v2, s[60:63], s83 offen offset:1024 sc1
    s_waitcnt lgkmcnt(6)
    v_mfma_f32_32x32x16_bf16 v[80:95], v[44:47], v[124:127], v[80:95]
    ds_read_b64_tr_b16 v[40:41], v10 offset:40960
    ds_read_b64_tr_b16 v[42:43], v10 offset:41984
    ds_read_b32 v6, v5 offset:60
    s_waitcnt vmcnt(11)
    v_mfma_f32_32x32x16_bf16 v[64:79], v[48:51], v[128:131], v[64:79]
    ds_read_b64_tr_b16 v[44:45], v11 offset:40960
    ds_read_b64_tr_b16 v[46:47], v11 offset:41984
    s_add_u32 s83, s82, 94208
    buffer_load_dwordx4 a[40:43], v2, s[60:63], s83 offen offset:0 sc1
    s_waitcnt lgkmcnt(7)
    v_mfma_f32_32x32x16_bf16 v[80:95], v[52:55], v[128:131], v[80:95]
    ds_read_b64_tr_b16 v[48:49], v10 offset:43008
    ds_read_b64_tr_b16 v[50:51], v10 offset:44032
    s_waitcnt vmcnt(11)
    v_mfma_f32_32x32x16_bf16 v[64:79], v[56:59], v[132:135], v[64:79]
    ds_read_b64_tr_b16 v[52:53], v11 offset:43008
    ds_read_b64_tr_b16 v[54:55], v11 offset:44032
    buffer_load_dwordx4 a[44:47], v2, s[60:63], s83 offen offset:1024 sc1
    s_waitcnt lgkmcnt(7)
    v_mfma_f32_32x32x16_bf16 v[80:95], v[60:63], v[132:135], v[80:95]
    ds_read_b64_tr_b16 v[56:57], v10 offset:45056
    ds_read_b64_tr_b16 v[58:59], v10 offset:46080
    s_waitcnt lgkmcnt(8)
    v_cmp_gt_u32 vcc, 1, v6
    s_cbranch_vccnz L_SM_p22_spin
L_SM_p22_ok:
    s_waitcnt vmcnt(11)
    v_mfma_f32_32x32x16_bf16 v[64:79], v[40:43], a[0:3], v[64:79]
    ds_read_b64_tr_b16 v[60:61], v11 offset:45056
    ds_read_b64_tr_b16 v[62:63], v11 offset:46080
    s_add_u32 s83, s82, 14336
    buffer_load_dwordx4 a[48:51], v2, s[60:63], s83 offen offset:0 sc1
    s_waitcnt lgkmcnt(6)
    v_mfma_f32_32x32x16_bf16 v[80:95], v[44:47], a[0:3], v[80:95]
    ds_read_b64_tr_b16 v[40:41], v10 offset:47104
    ds_read_b64_tr_b16 v[42:43], v10 offset:48128
    s_waitcnt vmcnt(11)
    v_mfma_f32_32x32x16_bf16 v[64:79], v[48:51], a[4:7], v[64:79]
    ds_read_b64_tr_b16 v[44:45], v11 offset:47104
    ds_read_b64_tr_b16 v[46:47], v11 offset:48128
    buffer_load_dwordx4 a[52:55], v2, s[60:63], s83 offen offset:1024 sc1
    s_waitcnt lgkmcnt(6)
    v_mfma_f32_32x32x16_bf16 v[80:95], v[52:55], a[4:7], v[80:95]
    ds_read_b64_tr_b16 v[48:49], v10 offset:49152
    ds_read_b64_tr_b16 v[50:51], v10 offset:50176
    s_waitcnt vmcnt(11)
    v_mfma_f32_32x32x16_bf16 v[64:79], v[56:59], a[8:11], v[64:79]
    ds_read_b64_tr_b16 v[52:53], v11 offset:49152
    ds_read_b64_tr_b16 v[54:55], v11 offset:50176
    s_add_u32 s83, s82, 30720
    buffer_load_dwordx4 a[56:59], v2, s[60:63], s83 offen offset:0 sc1
    s_waitcnt lgkmcnt(6)
    v_mfma_f32_32x32x16_bf16 v[80:95], v[60:63], a[8:11], v[80:95]
    ds_read_b64_tr_b16 v[56:57], v10 offset:51200
    ds_read_b64_tr_b16 v[58:59], v10 offset:52224
    s_waitcnt vmcnt(11)
    v_mfma_f32_32x32x16_bf16 v[64:79], v[40:43], a[12:15], v[64:79]
    ds_read_b64_tr_b16 v[60:61], v11 offset:51200
    ds_read_b64_tr_b16 v[62:63], v11 offset:52224
    buffer_load_dwordx4 a[60:63], v2, s[60:63], s83 offen offset:1024 sc1
    s_waitcnt lgkmcnt(6)
    v_mfma_f32_32x32x16_bf16 v[80:95], v[44:47], a[12:15], v[80:95]
    ds_read_b64_tr_b16 v[40:41], v10 offset:53248
    ds_read_b64_tr_b16 v[42:43], v10 offset:54272
    s_waitcnt vmcnt(11)
    v_mfma_f32_32x32x16_bf16 v[64:79], v[48:51], a[16:19], v[64:79]
    ds_read_b64_tr_b16 v[44:45], v11 offset:53248
    ds_read_b64_tr_b16 v[46:47], v11 offset:54272
    s_add_u32 s83, s82, 47104
    buffer_load_dwordx4 a[64:67], v2, s[60:63], s83 offen offset:0 sc1
    s_waitcnt lgkmcnt(6)
    v_mfma_f32_32x32x16_bf16 v[80:95], v[52:55], a[16:19], v[80:95]
    ds_read_b64_tr_b16 v[48:49], v10 offset:55296
    ds_read_b64_tr_b16 v[50:51], v10 offset:56320
    s_waitcnt vmcnt(11)
    v_mfma_f32_32x32x16_bf16 v[64:79], v[56:59], a[20:23], v[64:79]
    ds_read_b64_tr_b16 v[52:53], v11 offset:55296
    ds_read_b64_tr_b16 v[54:55], v11 offset:56320
    buffer_load_dwordx4 a[68:71], v2, s[60:63], s83 offen offset:1024 sc1
    s_waitcnt lgkmcnt(6)
    v_mfma_f32_32x32x16_bf16 v[80:95], v[60:63], a[20:23], v[80:95]
    ds_read_b64_tr_b16 v[56:57], v10 offset:57344
    ds_read_b64_tr_b16 v[58:59], v10 offset:58368
    ds_read_b32 v7, v5 offset:112
    s_waitcnt vmcnt(11)
    v_mfma_f32_32x32x16_bf16 v[64:79], v[40:43], a[24:27], v[64:79]
    ds_read_b64_tr_b16 v[60:61], v11 offset:57344
    ds_read_b64_tr_b16 v[62:63], v11 offset:58368
    s_add_u32 s83, s82, 63488
    buffer_load_dwordx4 a[72:75], v2, s[60:63], s83 offen offset:0 sc1
    s_waitcnt lgkmcnt(7)
    v_mfma_f32_32x32x16_bf16 v[80:95], v[44:47], a[24:27], v[80:95]
    ds_read_b64_tr_b16 v[40:41], v10 offset:59392
    ds_read_b64_tr_b16 v[42:43], v10 offset:60416
    s_waitcnt vmcnt(11)
    v_mfma_f32_32x32x16_bf16 v[64:79], v[48:51], a[28:31], v[64:79]
    ds_read_b64_tr_b16 v[44:45], v11 offset:59392
    ds_read_b64_tr_b16 v[46:47], v11 offset:60416
    buffer_load_dwordx4 a[76:79], v2, s[60:63], s83 offen offset:1024 sc1
    s_waitcnt lgkmcnt(7)
    v_mfma_f32_32x32x16_bf16 v[80:95], v[52:55], a[28:31], v[80:95]
    ds_read_b64_tr_b16 v[48:49], v10 offset:61440
    ds_read_b64_tr_b16 v[50:51], v10 offset:62464
    s_waitcnt vmcnt(11)
    v_mfma_f32_32x32x16_bf16 v[64:79], v[56:59], a[32:35], v[64:79]
    ds_read_b64_tr_b16 v[52:53], v11 offset:61440
    ds_read_b64_tr_b16 v[54:55], v11 offset:62464
    s_add_u32 s83, s82, 79872
    buffer_load_dwordx4 a[80:83], v2, s[60:63], s83 offen offset:0 sc1
    s_waitcnt lgkmcnt(6)
    v_mfma_f32_32x32x16_bf16 v[80:95], v[60:63], a[32:35], v[80:95]
    ds_read_b64_tr_b16 v[56:57], v10 offset:63488
    ds_read_b64_tr_b16 v[58:59], v10 offset:64512
    v_cmp_gt_u32 vcc, 16843009, v7
    s_cbranch_vccnz L_SM_p14_spin
L_SM_p14_ok:
    s_waitcnt vmcnt(11)
    v_mfma_f32_32x32x16_bf16 v[64:79], v[40:43], a[36:39], v[64:79]
    ds_read_b64_tr_b16 v[60:61], v11 offset:63488
    ds_read_b64_tr_b16 v[62:63], v11 offset:64512
    buffer_load_dwordx4 a[84:87], v2, s[60:63], s83 offen offset:1024 sc1
    s_waitcnt lgkmcnt(6)
    v_mfma_f32_32x32x16_bf16 v[80:95], v[44:47], a[36:39], v[80:95]
    ds_read_b64_tr_b16 v[40:41], v12 offset:0
    ds_read_b64_tr_b16 v[42:43], v12 offset:1024
    s_waitcnt vmcnt(11)
    v_mfma_f32_32x32x16_bf16 v[64:79], v[48:51], a[40:43], v[64:79]
    ds_read_b64_tr_b16 v[44:45], v13 offset:0
    ds_read_b64_tr_b16 v[46:47], v13 offset:1024
    s_add_u32 s83, s82, 96256
    buffer_load_dwordx4 a[88:91], v2, s[60:63], s83 offen offset:0 sc1
    s_waitcnt lgkmcnt(6)
    v_mfma_f32_32x32x16_bf16 v[80:95], v[52:55], a[40:43], v[80:95]
    ds_read_b64_tr_b16 v[48:49], v12 offset:2048
    ds_read_b64_tr_b16 v[50:51], v12 offset:3072
    s_waitcnt vmcnt(11)
    v_mfma_f32_32x32x16_bf16 v[64:79], v[56:59], a[44:47], v[64:79]
    ds_read_b64_tr_b16 v[52:53], v13 offset:2048
    ds_read_b64_tr_b16 v[54:55], v13 offset:3072
    buffer_load_dwordx4 a[92:95], v2, s[60:63], s83 offen offset:1024 sc1
    s_waitcnt lgkmcnt(6)
    v_mfma_f32_32x32x16_bf16 v[80:95], v[60:63], a[44:47], v[80:95]
    ds_read_b64_tr_b16 v[56:57], v12 offset:4096
    ds_read_b64_tr_b16 v[58:59], v12 offset:5120
    s_waitcnt vmcnt(11)
    v_mfma_f32_32x32x16_bf16 v[64:79], v[40:43], a[48:51], v[64:79]
    ds_read_b64_tr_b16 v[60:61], v13 offset:4096
    ds_read_b64_tr_b16 v[62:63], v13 offset:5120
    s_waitcnt lgkmcnt(6)
    v_mfma_f32_32x32x16_bf16 v[80:95], v[44:47], a[48:51], v[80:95]
    ds_read_b64_tr_b16 v[40:41], v12 offset:6144
    ds_read_b64_tr_b16 v[42:43], v12 offset:7168
    s_waitcnt vmcnt(10)
    v_mfma_f32_32x32x16_bf16 v[64:79], v[48:51], a[52:55], v[64:79]
    ds_read_b64_tr_b16 v[44:45], v13 offset:6144
    ds_read_b64_tr_b16 v[46:47], v13 offset:7168
    s_waitcnt lgkmcnt(6)
    v_mfma_f32_32x32x16_bf16 v[80:95], v[52:55], a[52:55], v[80:95]
    ds_read_b64_tr_b16 v[48:49], v12 offset:8192
    ds_read_b64_tr_b16 v[50:51], v12 offset:9216
    s_waitcnt vmcnt(9)
    v_mfma_f32_32x32x16_bf16 v[64:79], v[56:59], a[56:59], v[64:79]
    ds_read_b64_tr_b16 v[52:53], v13 offset:8192
    ds_read_b64_tr_b16 v[54:55], v13 offset:9216
    ds_read_b32 v7, v5 offset:80
    s_waitcnt lgkmcnt(7)
    v_mfma_f32_32x32x16_bf16 v[80:95], v[60:63], a[56:59], v[80:95]
    ds_read_b64_tr_b16 v[56:57], v12 offset:10240
    ds_read_b64_tr_b16 v[58:59], v12 offset:11264
    s_waitcnt vmcnt(8)
    v_mfma_f32_32x32x16_bf16 v[64:79], v[40:43], a[60:63], v[64:79]
    ds_read_b64_tr_b16 v[60:61], v13 offset:10240
    ds_read_b64_tr_b16 v[62:63], v13 offset:11264
    s_waitcnt lgkmcnt(7)
    v_mfma_f32_32x32x16_bf16 v[80:95], v[44:47], a[60:63], v[80:95]
    ds_read_b64_tr_b16 v[40:41], v12 offset:12288
    ds_read_b64_tr_b16 v[42:43], v12 offset:13312
    s_waitcnt vmcnt(7)
    v_mfma_f32_32x32x16_bf16 v[64:79], v[48:51], a[64:67], v[64:79]
    ds_read_b64_tr_b16 v[44:45], v12 offset:14336
    ds_read_b64_tr_b16 v[46:47], v12 offset:15360
    s_waitcnt lgkmcnt(6)
    v_mfma_f32_32x32x16_bf16 v[80:95], v[52:55], a[64:67], v[80:95]
    ds_read_b64_tr_b16 v[48:49], v12 offset:16384
    ds_read_b64_tr_b16 v[50:51], v12 offset:17408
    s_waitcnt vmcnt(6)
    v_mfma_f32_32x32x16_bf16 v[64:79], v[56:59], a[68:71], v[64:79]
    ds_read_b64_tr_b16 v[52:53], v12 offset:18432
    ds_read_b64_tr_b16 v[54:55], v12 offset:19456
    v_cmp_gt_u32 vcc, 16843009, v7
    s_cbranch_vccnz L_SM_p15_spin
L_SM_p15_ok:
    s_waitcnt lgkmcnt(6)
    v_mfma_f32_32x32x16_bf16 v[80:95], v[60:63], a[68:71], v[80:95]
    ds_read_b64_tr_b16 v[56:57], v12 offset:20480
    ds_read_b64_tr_b16 v[58:59], v12 offset:21504
    s_waitcnt vmcnt(5)
    v_mfma_f32_32x32x16_bf16 v[64:79], v[40:43], a[72:75], v[64:79]
    ds_read_b64_tr_b16 v[60:61], v12 offset:22528
    ds_read_b64_tr_b16 v[62:63], v12 offset:23552
    s_waitcnt vmcnt(4) lgkmcnt(6)
    v_mfma_f32_32x32x16_bf16 v[64:79], v[44:47], a[76:79], v[64:79]
    ds_read_b64_tr_b16 v[40:41], v13 offset:12288
    ds_read_b64_tr_b16 v[42:43], v13 offset:13312
    s_waitcnt vmcnt(3)
    v_mfma_f32_32x32x16_bf16 v[64:79], v[48:51], a[80:83], v[64:79]
    ds_read_b64_tr_b16 v[44:45], v13 offset:14336
    ds_read_b64_tr_b16 v[46:47], v13 offset:15360
    s_waitcnt vmcnt(2) lgkmcnt(6)
    v_mfma_f32_32x32x16_bf16 v[64:79], v[52:55], a[84:87], v[64:79]
    ds_read_b64_tr_b16 v[48:49], v13 offset:16384
    ds_read_b64_tr_b16 v[50:51], v13 offset:17408
    s_waitcnt vmcnt(1)
    v_mfma_f32_32x32x16_bf16 v[64:79], v[56:59], a[88:91], v[64:79]
    ds_read_b64_tr_b16 v[52:53], v13 offset:18432
    ds_read_b64_tr_b16 v[54:55], v13 offset:19456
    s_waitcnt vmcnt(0) lgkmcnt(6)
    v_mfma_f32_32x32x16_bf16 v[64:79], v[60:63], a[92:95], v[64:79]
    ds_read_b64_tr_b16 v[56:57], v13 offset:20480
    ds_read_b64_tr_b16 v[58:59], v13 offset:21504
    v_mfma_f32_32x32x16_bf16 v[80:95], v[40:43], a[72:75], v[80:95]
    ds_read_b64_tr_b16 v[60:61], v13 offset:22528
    ds_read_b64_tr_b16 v[62:63], v13 offset:23552
    s_waitcnt lgkmcnt(6)
    v_mfma_f32_32x32x16_bf16 v[80:95], v[44:47], a[76:79], v[80:95]
    v_mfma_f32_32x32x16_bf16 v[80:95], v[48:51], a[80:83], v[80:95]
    s_nop 3
    v_cvt_pk_bf16_f32 v96, v64, v65
    v_cvt_pk_bf16_f32 v97, v66, v67
    v_cvt_pk_bf16_f32 v98, v68, v69
    v_cvt_pk_bf16_f32 v99, v70, v71
    v_cvt_pk_bf16_f32 v100, v72, v73
    v_cvt_pk_bf16_f32 v101, v74, v75
    s_waitcnt lgkmcnt(2)
    v_mfma_f32_32x32x16_bf16 v[80:95], v[52:55], a[84:87], v[80:95]
    v_cvt_pk_bf16_f32 v102, v76, v77
    v_cvt_pk_bf16_f32 v103, v78, v79
    v_permlane32_swap_b32 v96, v98
    v_permlane32_swap_b32 v97, v99
    v_permlane32_swap_b32 v100, v102
    v_permlane32_swap_b32 v101, v103
    v_mfma_f32_32x32x16_bf16 v[80:95], v[56:59], a[88:91], v[80:95]
    ds_write_b128 v22, v[96:99] offset:0
    s_waitcnt lgkmcnt(1)
    v_mfma_f32_32x32x16_bf16 v[80:95], v[60:63], a[92:95], v[80:95]
    ds_write_b128 v22, v[100:103] offset:32
    s_nop 10
    v_cvt_pk_bf16_f32 v104, v80, v81
    v_cvt_pk_bf16_f32 v105, v82, v83
    v_cvt_pk_bf16_f32 v106, v84, v85
    v_cvt_pk_bf16_f32 v107, v86, v87
    v_cvt_pk_bf16_f32 v108, v88, v89
    v_cvt_pk_bf16_f32 v109, v90, v91
    v_cvt_pk_bf16_f32 v110, v92, v93
    v_cvt_pk_bf16_f32 v111, v94, v95
    v_permlane32_swap_b32 v104, v106
    v_permlane32_swap_b32 v105, v107
    v_permlane32_swap_b32 v108, v110
    v_permlane32_swap_b32 v109, v111
    ds_write_b128 v22, v[104:107] offset:64
    ds_write_b128 v22, v[108:111] offset:96
    ds_read_b128 v[112:115], v23 offset:0
    ds_read_b128 v[116:119], v23 offset:1152
    ds_read_b128 v[120:123], v23 offset:2304
    ds_read_b128 v[124:127], v23 offset:3456
    s_waitcnt lgkmcnt(3)
    buffer_store_dwordx4 v[112:115], v21, s[64:67], s80 offen
    s_add_u32 s80, s80, 10240
    s_waitcnt lgkmcnt(2)
    buffer_store_dwordx4 v[116:119], v21, s[64:67], s80 offen
    s_add_u32 s80, s80, 10240
    s_waitcnt lgkmcnt(1)
    buffer_store_dwordx4 v[120:123], v21, s[64:67], s80 offen
    s_add_u32 s80, s80, 10240
    s_waitcnt lgkmcnt(0)
    buffer_store_dwordx4 v[124:127], v21, s[64:67], s80 offen
    s_endpgm
L_SM_p1_spin:
    s_mov_b32 s81, 0
L_SM_p1_chk:
    s_sleep 2
    buffer_load_dword v8, v130, s[68:71], 0 offen offset:0 sc1
    s_add_u32 s81, s81, 1
    s_waitcnt vmcnt(0)
    v_cmp_gt_u32 vcc, 1, v8
    s_cmp_gt_u32 s81, 0x10000
    s_cbranch_scc1 L_SM_p1_ok
    s_cbranch_vccnz L_SM_p1_chk
    s_branch L_SM_p1_ok
L_SM_p2_spin:
    s_mov_b32 s81, 0
L_SM_p2_chk:
    s_sleep 1
    ds_read_b32 v6, v5 offset:0
    s_add_u32 s81, s81, 1
    s_waitcnt lgkmcnt(0)
    v_cmp_gt_u32 vcc, 4, v6
    s_cmp_gt_u32 s81, 0x10000
    s_cbranch_scc1 L_SM_p2_ok
    s_cbranch_vccnz L_SM_p2_chk
    s_branch L_SM_p2_ok
L_SM_p3_spin:
    s_mov_b32 s81, 0
L_SM_p3_chk:
    s_sleep 8
    s_mov_b32 exec_hi, 0x0
    v_mov_b32 v6, 0
    buffer_atomic_add v6, v9, s[60:63], s45 offen offset:0 sc0 sc1
    s_mov_b32 exec_hi, -1
    s_add_u32 s81, s81, 1
    s_waitcnt vmcnt(0)
    v_cmp_gt_u32 vcc, 1, v6
    s_cmp_gt_u32 s81, 0x10000
    s_cbranch_scc1 L_SM_p3_ok
    s_lshl_b64 vcc, vcc, 32
    s_cbranch_scc1 L_SM_p3_chk
    s_branch L_SM_p3_ok
L_SM_p4_spin:
    s_mov_b32 s81, 0
L_SM_p4_chk:
    s_sleep 1
    ds_read_b32 v7, v5 offset:8
    s_add_u32 s81, s81, 1
    s_waitcnt lgkmcnt(0)
    v_cmp_gt_u32 vcc, 4, v7
    s_cmp_gt_u32 s81, 0x10000
    s_cbranch_scc1 L_SM_p4_ok
    s_cbranch_vccnz L_SM_p4_chk
    s_branch L_SM_p4_ok
L_SM_p5_spin:
    s_mov_b32 s81, 0
L_SM_p5_chk:
    s_sleep 1
    ds_read_b32 v7, v5 offset:12
    s_add_u32 s81, s81, 1
    s_waitcnt lgkmcnt(0)
    v_cmp_gt_u32 vcc, 4, v7
    s_cmp_gt_u32 s81, 0x10000
    s_cbranch_scc1 L_SM_p5_ok
    s_cbranch_vccnz L_SM_p5_chk
    s_branch L_SM_p5_ok
L_SM_p6_spin:
    s_mov_b32 s81, 0
L_SM_p6_chk:
    s_sleep 1
    ds_read_b32 v7, v5 offset:16
    s_add_u32 s81, s81, 1
    s_waitcnt lgkmcnt(0)
    v_cmp_gt_u32 vcc, 4, v7
    s_cmp_gt_u32 s81, 0x10000
    s_cbranch_scc1 L_SM_p6_ok
    s_cbranch_vccnz L_SM_p6_chk
    s_branch L_SM_p6_ok
L_SM_p7_spin:
    s_mov_b32 s81, 0
L_SM_p7_chk:
    s_sleep 2
    s_mov_b32 exec_lo, 0x3f3f3f3f
    s_mov_b32 exec_hi, 0x3f3f3f3f
    v_mov_b32 v9, 0
    buffer_atomic_add v9, v18, s[60:63], s46 offen offset:0 sc0 sc1
    s_mov_b64 exec, -1
    s_add_u32 s81, s81, 1
    s_waitcnt vmcnt(0)
    v_cmp_gt_u32 vcc, 1, v9
    s_cmp_gt_u32 s81, 0x10000
    s_cbranch_scc1 L_SM_p7_ok
    s_lshl_b64 vcc, vcc, 32
    s_cbranch_scc1 L_SM_p7_chk
    s_branch L_SM_p7_ok
L_SM_p8_spin:
    s_mov_b32 s81, 0
L_SM_p8_chk:
    s_sleep 2
    s_mov_b32 exec_lo, 0x3f3f3f3f
    s_mov_b32 exec_hi, 0x3f3f3f3f
    v_mov_b32 v9, 0
    buffer_atomic_add v9, v18, s[60:63], s46 offen offset:0 sc0 sc1
    s_mov_b64 exec, -1
    s_add_u32 s81, s81, 1
    s_waitcnt vmcnt(0)
    v_cmp_gt_u32 vcc, 1, v9
    s_cmp_gt_u32 s81, 0x10000
    s_cbranch_scc1 L_SM_p8_ok
    s_cbranch_vccnz L_SM_p8_chk
    s_branch L_SM_p8_ok
L_SM_p9_spin:
    s_mov_b32 s81, 0
L_SM_p9_chk:
    s_sleep 1
    ds_read_b32 v7, v5 offset:32
    s_add_u32 s81, s81, 1
    s_waitcnt lgkmcnt(0)
    v_cmp_gt_u32 vcc, 1, v7
    s_cmp_gt_u32 s81, 0x10000
    s_cbranch_scc1 L_SM_p9_ok
    s_cbranch_vccnz L_SM_p9_chk
    s_branch L_SM_p9_ok
L_SM_p10_spin:
    s_mov_b32 s81, 0
L_SM_p10_chk:
    s_sleep 1
    ds_read_b32 v7, v5 offset:36
    s_add_u32 s81, s81, 1
    s_waitcnt lgkmcnt(0)
    v_cmp_gt_u32 vcc, 1, v7
    s_cmp_gt_u32 s81, 0x10000
    s_cbranch_scc1 L_SM_p10_ok
    s_cbranch_vccnz L_SM_p10_chk
    s_branch L_SM_p10_ok
L_SM_p11_spin:
    s_mov_b32 s81, 0
L_SM_p11_chk:
    s_sleep 2
    s_mov_b32 exec_lo, 0x3f3f3f3f
    s_mov_b32 exec_hi, 0x0
    v_mov_b32 v9, 0
    buffer_atomic_add v9, v18, s[60:63], s46 offen offset:512 sc0 sc1
    s_mov_b64 exec, -1
    s_add_u32 s81, s81, 1
    s_waitcnt vmcnt(0)
    v_cmp_gt_u32 vcc, 1, v9
    s_cmp_gt_u32 s81, 0x10000
    s_cbranch_scc1 L_SM_p11_ok
    s_lshl_b64 vcc, vcc, 32
    s_cbranch_scc1 L_SM_p11_chk
    s_branch L_SM_p11_ok
L_SM_p12_spin:
    s_mov_b32 s81, 0
L_SM_p12_chk:
    s_sleep 1
    ds_read_b32 v7, v5 offset:104
    s_add_u32 s81, s81, 1
    s_waitcnt lgkmcnt(0)
    v_cmp_gt_u32 vcc, 16843009, v7
    s_cmp_gt_u32 s81, 0x10000
    s_cbranch_scc1 L_SM_p12_ok
    s_cbranch_vccnz L_SM_p12_chk
    s_branch L_SM_p12_ok
L_SM_p13_spin:
    s_mov_b32 s81, 0
L_SM_p13_chk:
    s_sleep 1
    ds_read_b32 v7, v5 offset:108
    s_add_u32 s81, s81, 1
    s_waitcnt lgkmcnt(0)
    v_cmp_gt_u32 vcc, 16843009, v7
    s_cmp_gt_u32 s81, 0x10000
    s_cbranch_scc1 L_SM_p13_ok
    s_cbranch_vccnz L_SM_p13_chk
    s_branch L_SM_p13_ok
L_SM_p14_spin:
    s_mov_b32 s81, 0
L_SM_p14_chk:
    s_sleep 1
    ds_read_b32 v7, v5 offset:112
    s_add_u32 s81, s81, 1
    s_waitcnt lgkmcnt(0)
    v_cmp_gt_u32 vcc, 16843009, v7
    s_cmp_gt_u32 s81, 0x10000
    s_cbranch_scc1 L_SM_p14_ok
    s_cbranch_vccnz L_SM_p14_chk
    s_branch L_SM_p14_ok
L_SM_p15_spin:
    s_mov_b32 s81, 0
L_SM_p15_chk:
    s_sleep 1
    ds_read_b32 v7, v5 offset:80
    s_add_u32 s81, s81, 1
    s_waitcnt lgkmcnt(0)
    v_cmp_gt_u32 vcc, 16843009, v7
    s_cmp_gt_u32 s81, 0x10000
    s_cbranch_scc1 L_SM_p15_ok
    s_cbranch_vccnz L_SM_p15_chk
    s_branch L_SM_p15_ok
L_SM_p16_spin:
    s_mov_b32 s81, 0
L_SM_p16_chk:
    s_sleep 1
    ds_read_b32 v6, v5 offset:40
    s_add_u32 s81, s81, 1
    s_waitcnt lgkmcnt(0)
    v_cmp_gt_u32 vcc, 1, v6
    s_cmp_gt_u32 s81, 0x10000
    s_cbranch_scc1 L_SM_p16_ok
    s_cbranch_vccnz L_SM_p16_chk
    s_branch L_SM_p16_ok
L_SM_p17_spin:
    s_mov_b32 s81, 0
L_SM_p17_chk:
    s_sleep 1
    ds_read_b32 v6, v5 offset:44
    s_add_u32 s81, s81, 1
    s_waitcnt lgkmcnt(0)
    v_cmp_gt_u32 vcc, 1, v6
    s_cmp_gt_u32 s81, 0x10000
    s_cbranch_scc1 L_SM_p17_ok
    s_cbranch_vccnz L_SM_p17_chk
    s_branch L_SM_p17_ok
L_SM_p18_spin:
    s_mov_b32 s81, 0
L_SM_p18_chk:
    s_sleep 1
    ds_read_b32 v6, v5 offset:48
    s_add_u32 s81, s81, 1
    s_waitcnt lgkmcnt(0)
    v_cmp_gt_u32 vcc, 1, v6
    s_cmp_gt_u32 s81, 0x10000
    s_cbranch_scc1 L_SM_p18_ok
    s_cbranch_vccnz L_SM_p18_chk
    s_branch L_SM_p18_ok
L_SM_p19_spin:
    s_mov_b32 s81, 0
L_SM_p19_chk:
    s_sleep 1
    ds_read_b32 v6, v5 offset:52
    s_add_u32 s81, s81, 1
    s_waitcnt lgkmcnt(0)
    v_cmp_gt_u32 vcc, 1, v6
    s_cmp_gt_u32 s81, 0x10000
    s_cbranch_scc1 L_SM_p19_ok
    s_cbranch_vccnz L_SM_p19_chk
    s_branch L_SM_p19_ok
L_SM_p20_spin:
    s_mov_b32 s81, 0
L_SM_p20_chk:
    s_sleep 1
    ds_read_b32 v7, v5 offset:116
    s_add_u32 s81, s81, 1
    s_waitcnt lgkmcnt(0)
    v_cmp_gt_u32 vcc, 1, v7
    s_cmp_gt_u32 s81, 0x10000
    s_cbranch_scc1 L_SM_p20_ok
    s_cbranch_vccnz L_SM_p20_chk
    s_branch L_SM_p20_ok
L_SM_p21_spin:
    s_mov_b32 s81, 0
L_SM_p21_chk:
    ds_read_b32 v6, v5 offset:56
    s_add_u32 s81, s81, 1
    s_waitcnt lgkmcnt(0)
    v_cmp_gt_u32 vcc, 1, v6
    s_cmp_gt_u32 s81, 0x10000
    s_cbranch_scc1 L_SM_p21_ok
    s_cbranch_vccnz L_SM_p21_chk
    s_branch L_SM_p21_ok
L_SM_p22_spin:
    s_mov_b32 s81, 0
L_SM_p22_chk:
    ds_read_b32 v6, v5 offset:60
    s_add_u32 s81, s81, 1
    s_waitcnt lgkmcnt(0)
    v_cmp_gt_u32 vcc, 1, v6
    s_cmp_gt_u32 s81, 0x10000
    s_cbranch_scc1 L_SM_p22_ok
    s_cbranch_vccnz L_SM_p22_chk
    s_branch L_SM_p22_ok
.p2align 12
L_SC1:
L_SC_hop0:
    s_cbranch_execz L_SC_ret
    s_nop 0
    s_waitcnt vmcnt(19)
    v_lshlrev_b32 v60, 16, v48
    v_and_b32 v61, s12, v48
    v_pk_mul_f32 v[82:83], v[60:61], v[60:61]
    v_lshlrev_b32 v62, 16, v49
    v_and_b32 v63, s12, v49
    v_pk_add_f32 v[80:81], v[60:61], v[62:63]
    v_pk_fma_f32 v[82:83], v[62:63], v[62:63], v[82:83]
    s_waitcnt vmcnt(18)
    v_lshlrev_b32 v64, 16, v50
    v_and_b32 v65, s12, v50
    v_pk_add_f32 v[80:81], v[80:81], v[64:65]
    v_pk_fma_f32 v[82:83], v[64:65], v[64:65], v[82:83]
    v_lshlrev_b32 v66, 16, v51
    v_and_b32 v67, s12, v51
    v_pk_add_f32 v[80:81], v[80:81], v[66:67]
    v_pk_fma_f32 v[82:83], v[66:67], v[66:67], v[82:83]
    s_waitcnt vmcnt(17)
    v_lshlrev_b32 v68, 16, v52
    v_and_b32 v69, s12, v52
    v_pk_add_f32 v[80:81], v[80:81], v[68:69]
    v_pk_fma_f32 v[82:83], v[68:69], v[68:69], v[82:83]
    v_lshlrev_b32 v70, 16, v53
    v_and_b32 v71, s12, v53
    v_pk_add_f32 v[80:81], v[80:81], v[70:71]
    v_pk_fma_f32 v[82:83], v[70:71], v[70:71], v[82:83]
    s_waitcnt vmcnt(16)
    v_lshlrev_b32 v72, 16, v54
    v_and_b32 v73, s12, v54
    v_pk_add_f32 v[80:81], v[80:81], v[72:73]
    v_pk_fma_f32 v[82:83], v[72:73], v[72:73], v[82:83]
    v_lshlrev_b32 v74, 16, v55
    v_and_b32 v75, s12, v55
    v_pk_add_f32 v[80:81], v[80:81], v[74:75]
    v_pk_fma_f32 v[82:83], v[74:75], v[74:75], v[82:83]
    s_waitcnt vmcnt(15)
    v_lshlrev_b32 v76, 16, v56
    v_and_b32 v77, s12, v56
    v_pk_add_f32 v[80:81], v[80:81], v[76:77]
    v_pk_fma_f32 v[82:83], v[76:77], v[76:77], v[82:83]
    v_lshlrev_b32 v78, 16, v57
    v_and_b32 v79, s12, v57
    v_pk_add_f32 v[80:81], v[80:81], v[78:79]
    v_pk_fma_f32 v[82:83], v[78:79], v[78:79], v[82:83]
    v_add_f32 v80, v80, v81
    v_add_f32 v82, v82, v83
    s_nop 0
    v_add_f32_dpp v80, v80, v80 quad_perm:[1,0,3,2] row_mask:0xf bank_mask:0xf
    v_add_f32_dpp v82, v82, v82 quad_perm:[1,0,3,2] row_mask:0xf bank_mask:0xf
    s_nop 0
    v_add_f32_dpp v80, v80, v80 quad_perm:[2,3,0,1] row_mask:0xf bank_mask:0xf
    v_add_f32_dpp v82, v82, v82 quad_perm:[2,3,0,1] row_mask:0xf bank_mask:0xf
    s_nop 0
    v_add_f32_dpp v80, v80, v80 row_half_mirror row_mask:0xf bank_mask:0xf
    v_add_f32_dpp v82, v82, v82 row_half_mirror row_mask:0xf bank_mask:0xf
    s_nop 0
    v_add_f32_dpp v80, v80, v80 row_mirror row_mask:0xf bank_mask:0xf
    v_add_f32_dpp v82, v82, v82 row_mirror row_mask:0xf bank_mask:0xf
    v_mov_b32 v81, v80
    v_mov_b32 v83, v82
    s_nop 0
    v_permlane16_swap_b32 v80, v81
    v_permlane16_swap_b32 v82, v83
    v_add_f32 v80, v80, v81
    v_add_f32 v82, v82, v83
    v_mul_f32 v80, 0xbacccccd, v80
    v_mul_f32 v82, 0x3acccccd, v82
    v_fma_f32 v82, -v80, v80, v82
    v_max_f32 v82, 0, v82
    v_add_f32 v86, 0x3727c5ac, v82
    v_rsq_f32 v84, v86
    s_nop 0
    v_mul_f32 v85, v84, v80
    v_pk_fma_f32 v[86:87], v[60:61], v[84:85], v[84:85] op_sel:[0,0,1] op_sel_hi:[1,0,1]
    v_cvt_pk_bf16_f32 v48, v86, v87
    v_pk_fma_f32 v[88:89], v[62:63], v[84:85], v[84:85] op_sel:[0,0,1] op_sel_hi:[1,0,1]
    v_cvt_pk_bf16_f32 v49, v88, v89
    v_pk_fma_f32 v[86:87], v[64:65], v[84:85], v[84:85] op_sel:[0,0,1] op_sel_hi:[1,0,1]
    v_cvt_pk_bf16_f32 v50, v86, v87
    v_pk_fma_f32 v[88:89], v[66:67], v[84:85], v[84:85] op_sel:[0,0,1] op_sel_hi:[1,0,1]
    v_cvt_pk_bf16_f32 v51, v88, v89
    v_pk_fma_f32 v[86:87], v[68:69], v[84:85], v[84:85] op_sel:[0,0,1] op_sel_hi:[1,0,1]
    v_cvt_pk_bf16_f32 v52, v86, v87
    v_pk_fma_f32 v[88:89], v[70:71], v[84:85], v[84:85] op_sel:[0,0,1] op_sel_hi:[1,0,1]
    v_cvt_pk_bf16_f32 v53, v88, v89
    v_pk_fma_f32 v[86:87], v[72:73], v[84:85], v[84:85] op_sel:[0,0,1] op_sel_hi:[1,0,1]
    v_cvt_pk_bf16_f32 v54, v86, v87
    v_pk_fma_f32 v[88:89], v[74:75], v[84:85], v[84:85] op_sel:[0,0,1] op_sel_hi:[1,0,1]
    v_cvt_pk_bf16_f32 v55, v88, v89
    v_pk_fma_f32 v[86:87], v[76:77], v[84:85], v[84:85] op_sel:[0,0,1] op_sel_hi:[1,0,1]
    v_cvt_pk_bf16_f32 v56, v86, v87
    v_pk_fma_f32 v[88:89], v[78:79], v[84:85], v[84:85] op_sel:[0,0,1] op_sel_hi:[1,0,1]
    v_cvt_pk_bf16_f32 v57, v88, v89
    v_mul_f32 v86, v84, v84
    v_fmaak_f32 v86, v86, v82, 0x3727c5ac
    v_sqrt_f32 v86, v86
    ds_write_b64 v58, v[48:49] offset:0
    ds_write_b64 v58, v[50:51] offset:256
    ds_write_b64 v58, v[52:53] offset:512
    ds_write_b64 v58, v[54:55] offset:768
    ds_write_b64 v58, v[56:57] offset:1024
    ds_write_b32 v59, v86
    s_waitcnt lgkmcnt(0)
    s_barrier
    s_setprio 1
    s_mov_b32 s62, 268435456
    s_mov_b32 s63, 0x20000
    s_mov_b32 s74, 1966080
    s_mov_b32 s75, 0x20000
    s_mov_b64 s[60:61], s[48:49]
    s_mov_b64 s[72:73], s[40:41]
    s_mul_i32 s76, s3, 10144
    v_mul_i32_i24 v100, 272, v1
    v_lshrrev_b32 v60, 5, v1
    s_mov_b32 s15, -8688
    v_mad_i32_i24 v100, v60, s15, v100
    v_add_u32_e64 v100, s76, v100
    v_mul_i32_i24 v101, 504, v60
    v_mad_i32_i24 v101, v1, -16, v101
    v_add_u32 v101, 4728, v101
    v_add_u32_e64 v101, s76, v101
    v_mad_i32_i24 v102, v1, -16, s76
    v_add_u32 v102, 4208, v102
    v_lshl_add_u32 v103, v1, 2, s76
    v_add_u32 v103, 4728, v103
    v_lshl_add_u32 v104, v1, 1, s76
    v_lshl_add_u32 v104, v60, 7, v104
    v_add_u32 v104, 5238, v104
    v_lshrrev_b32_e64 v61, 4, v1
    v_mul_i32_i24 v109, -160, v61
    v_lshl_add_u32 v109, v1, 3, v109
    v_add_u32 v109, 4832, v109
    v_add_u32_e64 v109, s76, v109
    v_mul_i32_i24 v110, -80, v61
    v_lshl_add_u32 v110, v1, 2, v110
    v_add_u32 v110, 5228, v110
    v_add_u32 v110, s76, v110
    v_min_u32 v62, 61, v1
    v_lshl_add_u32 v108, v62, 4, s76
    v_mov_b32 v62, 4992
    v_cmp_gt_u32 vcc, 32, v1
    v_mov_b32 v63, 4848
    s_nop 0
    v_cndmask_b32 v62, v62, v63, vcc
    v_cmp_gt_u32 vcc, 16, v1
    v_mov_b32 v63, 4672
    s_nop 0
    v_cndmask_b32 v62, v62, v63, vcc
    v_cmp_gt_u32 vcc, 4, v1
    v_mov_b32 v63, 3648
    s_nop 0
    v_cndmask_b32 v62, v62, v63, vcc
    v_add_u32 v108, v62, v108
    v_add_u32 v20, 4096, v2
    v_mul_u32_u24 v64, 57, v1
    v_lshrrev_b32 v64, 10, v64
    v_lshrrev_b32_e64 v65, 1, v64
    v_mul_i32_i24 v105, -288, v64
    v_lshl_add_u32 v105, v1, 4, v105
    v_mad_i32_i24 v105, v65, -4, v105
    v_add_u32 v105, 3652, v105
    v_add_u32 v105, s76, v105
    v_mul_i32_i24 v106, 928, v64
    v_lshl_add_u32 v106, v1, 4, v106
    v_add_u32 v106, s76, v106
    v_lshl_add_u32 v107, v64, 4, 16
    v_mul_i32_i24 v15, 1216, v1
    v_lshrrev_b32_e64 v66, 2, v1
    s_mov_b32 s15, -4872
    v_mad_i32_i24 v15, v66, s15, v15
    v_mad_i32_i24 v15, v61, 48, v15
    v_add_u32 v15, 24, v15
    v_add_u32 v15, s76, v15
    v_mul_i32_i24 v32, -496, v61
    v_lshl_add_u32 v32, v1, 5, v32
    v_add_u32 v32, 5504, v32
    v_add_u32_e64 v32, s76, v32
    v_mul_i32_i24 v14, -960, v60
    v_lshl_add_u32 v14, v1, 4, v14
    v_lshl_add_u32 v14, v66, 6, v14
    v_lshrrev_b32_e64 v67, 6, v0
    v_lshl_add_u32 v14, v67, 12, v14
    s_mov_b32 s15, 40704
    v_lshl_add_u32 v11, v67, 0, s15
    v_and_b32 v68, 4, v66
    v_xor_b32 v68, v68, v1
    v_lshrrev_b32_e64 v69, 3, v0
    v_mul_i32_i24 v12, 1152, v69
    v_lshl_add_u32 v12, v67, 10, v12
    v_lshl_add_u32 v12, v68, 4, v12
    v_mul_i32_i24 v13, 3840, v61
    v_lshl_add_u32 v13, v1, 4, v13
    v_mul_i32_i24 v33, 112, v66
    v_lshl_add_u32 v33, v1, 2, v33
    s_lshl_b32 s14, s11, 5
    s_add_u32 s14, s14, s3
    s_lshl_b32 s14, s14, 2
    s_add_u32 s49, s14, 524288
    s_lshl_b32 s77, s3, 10
    s_lshl_b32 s78, s10, 7
    s_lshl_b32 s80, s11, 14
    s_add_u32 s80, s80, 6291456
    s_lshl_b32 s14, s10, 11
    s_add_u32 s47, s14, 524288
    s_lshl_b32 s82, s10, 18
    s_lshl_b32 s14, s7, 8
    s_add_u32 s82, s82, s14
    s_add_u32 s82, s82, 6291456
    s_mov_b32 m0, s76
    s_waitcnt vmcnt(14)
    v_lshlrev_b32 v128, 16, v128
    v_mul_f32 v128, 0x3fb8aa3b, v128
    v_exp_f32 v128, v128
    s_nop 0
    v_cvt_pk_bf16_f32 v128, 0, v128
    v_mul_f32 v129, 0x3fb8aa3b, v128
    v_mul_f32 v130, 0x3e22f983, v128
    s_waitcnt vmcnt(13)
    v_lshlrev_b32 v54, 16, v34
    s_waitcnt vmcnt(12)
    v_lshlrev_b32 v55, 16, v35
    s_waitcnt vmcnt(11)
    v_lshlrev_b32 v50, 16, v36
    s_waitcnt vmcnt(10)
    v_lshlrev_b32 v51, 16, v37
    s_waitcnt vmcnt(9)
    v_lshlrev_b32 v52, 16, v38
    s_waitcnt vmcnt(8)
    v_lshlrev_b32 v53, 16, v39
    v_mul_f32 v54, v54, v129
    v_mul_f32 v55, v55, v130
    v_mul_f32 v56, 0x41000000, v54
    v_mul_f32 v57, 0x41000000, v55
    v_fract_f32 v55, v55
    v_fract_f32 v57, v57
    v_exp_f32 v59, v56
    v_cos_f32 v48, v57
    v_sin_f32 v49, v57
    v_exp_f32 v58, v54
    v_cos_f32 v46, v55
    v_sin_f32 v47, v55
    v_mul_f32 v48, v48, v59
    v_mul_f32 v49, v49, v59
    v_mul_f32 v46, v46, v58
    v_mul_f32 v47, v47, v58
    v_mul_f32 v50, v50, v128
    v_mul_f32 v51, v51, v128
    v_cvt_pk_bf16_f32 v60, 1.0, 0
    v_cvt_pk_bf16_f32 v61, v48, v49
    v_pk_mul_f32 v[68:69], v[48:49], v[48:49] op_sel_hi:[1,0]
    v_pk_fma_f32 v[68:69], v[48:49], v[48:49], v[68:69] op_sel:[1,1,0] op_sel_hi:[0,1,1] neg_lo:[1,0,0]
    v_cvt_pk_bf16_f32 v62, v68, v69
    v_pk_mul_f32 v[70:71], v[68:69], v[48:49] op_sel_hi:[1,0]
    v_pk_fma_f32 v[70:71], v[68:69], v[48:49], v[70:71] op_sel:[1,1,0] op_sel_hi:[0,1,1] neg_lo:[1,0,0]
    v_cvt_pk_bf16_f32 v63, v70, v71
    v_pk_mul_f32 v[68:69], v[70:71], v[48:49] op_sel_hi:[1,0]
    v_pk_fma_f32 v[68:69], v[70:71], v[48:49], v[68:69] op_sel:[1,1,0] op_sel_hi:[0,1,1] neg_lo:[1,0,0]
    v_cvt_pk_bf16_f32 v64, v68, v69
    v_pk_mul_f32 v[70:71], v[68:69], v[48:49] op_sel_hi:[1,0]
    v_pk_fma_f32 v[70:71], v[68:69], v[48:49], v[70:71] op_sel:[1,1,0] op_sel_hi:[0,1,1] neg_lo:[1,0,0]
    v_cvt_pk_bf16_f32 v65, v70, v71
    v_pk_mul_f32 v[68:69], v[70:71], v[48:49] op_sel_hi:[1,0]
    v_pk_fma_f32 v[68:69], v[70:71], v[48:49], v[68:69] op_sel:[1,1,0] op_sel_hi:[0,1,1] neg_lo:[1,0,0]
    v_cvt_pk_bf16_f32 v66, v68, v69
    v_pk_mul_f32 v[70:71], v[68:69], v[48:49] op_sel_hi:[1,0]
    v_pk_fma_f32 v[70:71], v[68:69], v[48:49], v[70:71] op_sel:[1,1,0] op_sel_hi:[0,1,1] neg_lo:[1,0,0]
    v_cvt_pk_bf16_f32 v67, v70, v71
    ds_write_addtid_b32 v60 offset:0
    ds_write_addtid_b32 v61 offset:272
    ds_write_addtid_b32 v62 offset:544
    ds_write_addtid_b32 v63 offset:816
    ds_write_addtid_b32 v64 offset:1088
    ds_write_addtid_b32 v65 offset:1360
    ds_write_addtid_b32 v66 offset:1632
    ds_write_addtid_b32 v67 offset:1904
    v_pk_mul_f32 v[68:69], v[70:71], v[48:49] op_sel_hi:[1,0]
    v_pk_fma_f32 v[68:69], v[70:71], v[48:49], v[68:69] op_sel:[1,1,0] op_sel_hi:[0,1,1] neg_lo:[1,0,0]
    v_cvt_pk_bf16_f32 v60, v68, v69
    v_pk_mul_f32 v[70:71], v[68:69], v[48:49] op_sel_hi:[1,0]
    v_pk_fma_f32 v[70:71], v[68:69], v[48:49], v[70:71] op_sel:[1,1,0] op_sel_hi:[0,1,1] neg_lo:[1,0,0]
    v_cvt_pk_bf16_f32 v61, v70, v71
    v_pk_mul_f32 v[68:69], v[70:71], v[48:49] op_sel_hi:[1,0]
    v_pk_fma_f32 v[68:69], v[70:71], v[48:49], v[68:69] op_sel:[1,1,0] op_sel_hi:[0,1,1] neg_lo:[1,0,0]
    v_cvt_pk_bf16_f32 v62, v68, v69
    v_pk_mul_f32 v[70:71], v[68:69], v[48:49] op_sel_hi:[1,0]
    v_pk_fma_f32 v[70:71], v[68:69], v[48:49], v[70:71] op_sel:[1,1,0] op_sel_hi:[0,1,1] neg_lo:[1,0,0]
    v_cvt_pk_bf16_f32 v63, v70, v71
    v_pk_mul_f32 v[68:69], v[70:71], v[48:49] op_sel_hi:[1,0]
    v_pk_fma_f32 v[68:69], v[70:71], v[48:49], v[68:69] op_sel:[1,1,0] op_sel_hi:[0,1,1] neg_lo:[1,0,0]
    v_cvt_pk_bf16_f32 v64, v68, v69
    v_pk_mul_f32 v[70:71], v[68:69], v[48:49] op_sel_hi:[1,0]
    v_pk_fma_f32 v[70:71], v[68:69], v[48:49], v[70:71] op_sel:[1,1,0] op_sel_hi:[0,1,1] neg_lo:[1,0,0]
    v_cvt_pk_bf16_f32 v65, v70, v71
    v_pk_mul_f32 v[68:69], v[70:71], v[48:49] op_sel_hi:[1,0]
    v_pk_fma_f32 v[68:69], v[70:71], v[48:49], v[68:69] op_sel:[1,1,0] op_sel_hi:[0,1,1] neg_lo:[1,0,0]
    v_cvt_pk_bf16_f32 v66, v68, v69
    v_pk_mul_f32 v[70:71], v[68:69], v[48:49] op_sel_hi:[1,0]
    v_pk_fma_f32 v[70:71], v[68:69], v[48:49], v[70:71] op_sel:[1,1,0] op_sel_hi:[0,1,1] neg_lo:[1,0,0]
    v_cvt_pk_bf16_f32 v67, v70, v71
    ds_write_addtid_b32 v60 offset:2176
    ds_write_addtid_b32 v61 offset:2448
    ds_write_addtid_b32 v62 offset:2720
    ds_write_addtid_b32 v63 offset:2992
    ds_write_addtid_b32 v64 offset:3264
    ds_write_addtid_b32 v65 offset:3536
    ds_write_addtid_b32 v66 offset:3808
    ds_write_addtid_b32 v67 offset:4080
    v_pk_mul_f32 v[68:69], v[70:71], v[48:49] op_sel_hi:[1,0]
    v_pk_fma_f32 v[68:69], v[70:71], v[48:49], v[68:69] op_sel:[1,1,0] op_sel_hi:[0,1,1] neg_lo:[1,0,0]
    v_cvt_pk_bf16_f32 v60, v68, v69
    v_pk_mul_f32 v[70:71], v[68:69], v[48:49] op_sel_hi:[1,0]
    v_pk_fma_f32 v[70:71], v[68:69], v[48:49], v[70:71] op_sel:[1,1,0] op_sel_hi:[0,1,1] neg_lo:[1,0,0]
    v_cvt_pk_bf16_f32 v61, v70, v71
    v_pk_mul_f32 v[68:69], v[70:71], v[48:49] op_sel_hi:[1,0]
    v_pk_fma_f32 v[68:69], v[70:71], v[48:49], v[68:69] op_sel:[1,1,0] op_sel_hi:[0,1,1] neg_lo:[1,0,0]
    v_cvt_pk_bf16_f32 v62, v68, v69
    v_pk_mul_f32 v[70:71], v[68:69], v[48:49] op_sel_hi:[1,0]
    v_pk_fma_f32 v[70:71], v[68:69], v[48:49], v[70:71] op_sel:[1,1,0] op_sel_hi:[0,1,1] neg_lo:[1,0,0]
    v_cvt_pk_bf16_f32 v63, v70, v71
    v_pk_mul_f32 v[68:69], v[70:71], v[48:49] op_sel_hi:[1,0]
    v_pk_fma_f32 v[68:69], v[70:71], v[48:49], v[68:69] op_sel:[1,1,0] op_sel_hi:[0,1,1] neg_lo:[1,0,0]
    v_cvt_pk_bf16_f32 v64, v68, v69
    v_pk_mul_f32 v[70:71], v[68:69], v[48:49] op_sel_hi:[1,0]
    v_pk_fma_f32 v[70:71], v[68:69], v[48:49], v[70:71] op_sel:[1,1,0] op_sel_hi:[0,1,1] neg_lo:[1,0,0]
    v_cvt_pk_bf16_f32 v65, v70, v71
    v_pk_mul_f32 v[68:69], v[70:71], v[48:49] op_sel_hi:[1,0]
    v_pk_fma_f32 v[68:69], v[70:71], v[48:49], v[68:69] op_sel:[1,1,0] op_sel_hi:[0,1,1] neg_lo:[1,0,0]
    v_cvt_pk_bf16_f32 v66, v68, v69
    v_pk_mul_f32 v[70:71], v[68:69], v[48:49] op_sel_hi:[1,0]
    v_pk_fma_f32 v[70:71], v[68:69], v[48:49], v[70:71] op_sel:[1,1,0] op_sel_hi:[0,1,1] neg_lo:[1,0,0]
    v_cvt_pk_bf16_f32 v67, v70, v71
    ds_write_addtid_b32 v60 offset:4352
    ds_write_addtid_b32 v61 offset:4624
    ds_write_addtid_b32 v62 offset:4896
    ds_write_addtid_b32 v63 offset:5168
    ds_write_addtid_b32 v64 offset:5440
    ds_write_addtid_b32 v65 offset:5712
    ds_write_addtid_b32 v66 offset:5984
    ds_write_addtid_b32 v67 offset:6256
    v_pk_mul_f32 v[68:69], v[70:71], v[48:49] op_sel_hi:[1,0]
    v_pk_fma_f32 v[68:69], v[70:71], v[48:49], v[68:69] op_sel:[1,1,0] op_sel_hi:[0,1,1] neg_lo:[1,0,0]
    v_cvt_pk_bf16_f32 v60, v68, v69
    v_pk_mul_f32 v[70:71], v[68:69], v[48:49] op_sel_hi:[1,0]
    v_pk_fma_f32 v[70:71], v[68:69], v[48:49], v[70:71] op_sel:[1,1,0] op_sel_hi:[0,1,1] neg_lo:[1,0,0]
    v_cvt_pk_bf16_f32 v61, v70, v71
    v_pk_mul_f32 v[68:69], v[70:71], v[48:49] op_sel_hi:[1,0]
    v_pk_fma_f32 v[68:69], v[70:71], v[48:49], v[68:69] op_sel:[1,1,0] op_sel_hi:[0,1,1] neg_lo:[1,0,0]
    v_cvt_pk_bf16_f32 v62, v68, v69
    v_pk_mul_f32 v[70:71], v[68:69], v[48:49] op_sel_hi:[1,0]
    v_pk_fma_f32 v[70:71], v[68:69], v[48:49], v[70:71] op_sel:[1,1,0] op_sel_hi:[0,1,1] neg_lo:[1,0,0]
    v_cvt_pk_bf16_f32 v63, v70, v71
    v_pk_mul_f32 v[68:69], v[70:71], v[48:49] op_sel_hi:[1,0]
    v_pk_fma_f32 v[68:69], v[70:71], v[48:49], v[68:69] op_sel:[1,1,0] op_sel_hi:[0,1,1] neg_lo:[1,0,0]
    v_cvt_pk_bf16_f32 v64, v68, v69
    v_pk_mul_f32 v[70:71], v[68:69], v[48:49] op_sel_hi:[1,0]
    v_pk_fma_f32 v[70:71], v[68:69], v[48:49], v[70:71] op_sel:[1,1,0] op_sel_hi:[0,1,1] neg_lo:[1,0,0]
    v_cvt_pk_bf16_f32 v65, v70, v71
    v_pk_mul_f32 v[68:69], v[70:71], v[48:49] op_sel_hi:[1,0]
    v_pk_fma_f32 v[68:69], v[70:71], v[48:49], v[68:69] op_sel:[1,1,0] op_sel_hi:[0,1,1] neg_lo:[1,0,0]
    v_cvt_pk_bf16_f32 v66, v68, v69
    v_pk_mul_f32 v[70:71], v[68:69], v[48:49] op_sel_hi:[1,0]
    v_pk_fma_f32 v[70:71], v[68:69], v[48:49], v[70:71] op_sel:[1,1,0] op_sel_hi:[0,1,1] neg_lo:[1,0,0]
    v_cvt_pk_bf16_f32 v67, v70, v71
    ds_write_addtid_b32 v60 offset:6528
    ds_write_addtid_b32 v61 offset:6800
    ds_write_addtid_b32 v62 offset:7072
    ds_write_addtid_b32 v63 offset:7344
    ds_write_addtid_b32 v64 offset:7616
    ds_write_addtid_b32 v65 offset:7888
    ds_write_addtid_b32 v66 offset:8160
    ds_write_addtid_b32 v67 offset:8432
    ds_read_b128 a[0:3], v100 offset:0
    ds_read_b128 a[4:7], v100 offset:32
    ds_read_b128 a[8:11], v100 offset:64
    ds_read_b128 a[12:15], v100 offset:96
    ds_read_b128 a[16:19], v100 offset:128
    ds_read_b128 a[20:23], v100 offset:160
    ds_read_b128 a[24:27], v100 offset:192
    ds_read_b128 a[28:31], v100 offset:224
    v_pk_mul_f32 v[72:73], v[70:71], v[48:49] op_sel_hi:[1,0]
    v_pk_fma_f32 v[72:73], v[70:71], v[48:49], v[72:73] op_sel:[1,1,0] op_sel_hi:[0,1,1] neg_lo:[1,0,0]
    v_pk_mul_f32 v[74:75], v[52:53], v[50:51] op_sel_hi:[1,0]
    v_pk_fma_f32 v[74:75], v[52:53], v[50:51], v[74:75] op_sel:[1,1,0] op_sel_hi:[0,1,1] neg_lo:[1,0,0]
    v_cvt_pk_bf16_f32 v60, v74, -v75
    v_pk_mul_f32 v[76:77], v[74:75], v[46:47] op_sel_hi:[1,0]
    v_pk_fma_f32 v[76:77], v[74:75], v[46:47], v[76:77] op_sel:[1,1,0] op_sel_hi:[0,1,1] neg_lo:[1,0,0]
    v_cvt_pk_bf16_f32 v61, v76, -v77
    v_pk_mul_f32 v[78:79], v[76:77], v[46:47] op_sel_hi:[1,0]
    v_pk_fma_f32 v[78:79], v[76:77], v[46:47], v[78:79] op_sel:[1,1,0] op_sel_hi:[0,1,1] neg_lo:[1,0,0]
    v_cvt_pk_bf16_f32 v62, v78, -v79
    v_pk_mul_f32 v[80:81], v[78:79], v[46:47] op_sel_hi:[1,0]
    v_pk_fma_f32 v[80:81], v[78:79], v[46:47], v[80:81] op_sel:[1,1,0] op_sel_hi:[0,1,1] neg_lo:[1,0,0]
    v_cvt_pk_bf16_f32 v63, v80, -v81
    v_pk_mul_f32 v[82:83], v[80:81], v[46:47] op_sel_hi:[1,0]
    v_pk_fma_f32 v[82:83], v[80:81], v[46:47], v[82:83] op_sel:[1,1,0] op_sel_hi:[0,1,1] neg_lo:[1,0,0]
    v_cvt_pk_bf16_f32 v64, v82, -v83
    v_pk_mul_f32 v[84:85], v[82:83], v[46:47] op_sel_hi:[1,0]
    v_pk_fma_f32 v[84:85], v[82:83], v[46:47], v[84:85] op_sel:[1,1,0] op_sel_hi:[0,1,1] neg_lo:[1,0,0]
    v_cvt_pk_bf16_f32 v65, v84, -v85
    v_pk_mul_f32 v[86:87], v[84:85], v[46:47] op_sel_hi:[1,0]
    v_pk_fma_f32 v[86:87], v[84:85], v[46:47], v[86:87] op_sel:[1,1,0] op_sel_hi:[0,1,1] neg_lo:[1,0,0]
    v_cvt_pk_bf16_f32 v66, v86, -v87
    v_pk_mul_f32 v[88:89], v[86:87], v[46:47] op_sel_hi:[1,0]
    v_pk_fma_f32 v[88:89], v[86:87], v[46:47], v[88:89] op_sel:[1,1,0] op_sel_hi:[0,1,1] neg_lo:[1,0,0]
    v_cvt_pk_bf16_f32 v67, v88, -v89
    ds_write_addtid_b32 v60 offset:0
    ds_write_addtid_b32 v61 offset:272
    ds_write_addtid_b32 v62 offset:544
    ds_write_addtid_b32 v63 offset:816
    ds_write_addtid_b32 v64 offset:1088
    ds_write_addtid_b32 v65 offset:1360
    ds_write_addtid_b32 v66 offset:1632
    ds_write_addtid_b32 v67 offset:1904
    v_pk_mul_f32 v[76:77], v[74:75], v[72:73] op_sel_hi:[1,0]
    v_pk_fma_f32 v[76:77], v[74:75], v[72:73], v[76:77] op_sel:[1,1,0] op_sel_hi:[0,1,1] neg_lo:[1,0,0]
    v_cvt_pk_bf16_f32 v60, v76, -v77
    v_pk_mul_f32 v[80:81], v[78:79], v[72:73] op_sel_hi:[1,0]
    v_pk_fma_f32 v[80:81], v[78:79], v[72:73], v[80:81] op_sel:[1,1,0] op_sel_hi:[0,1,1] neg_lo:[1,0,0]
    v_cvt_pk_bf16_f32 v61, v80, -v81
    v_pk_mul_f32 v[84:85], v[82:83], v[72:73] op_sel_hi:[1,0]
    v_pk_fma_f32 v[84:85], v[82:83], v[72:73], v[84:85] op_sel:[1,1,0] op_sel_hi:[0,1,1] neg_lo:[1,0,0]
    v_cvt_pk_bf16_f32 v62, v84, -v85
    v_pk_mul_f32 v[88:89], v[86:87], v[72:73] op_sel_hi:[1,0]
    v_pk_fma_f32 v[88:89], v[86:87], v[72:73], v[88:89] op_sel:[1,1,0] op_sel_hi:[0,1,1] neg_lo:[1,0,0]
    v_cvt_pk_bf16_f32 v63, v88, -v89
    v_pk_mul_f32 v[74:75], v[76:77], v[72:73] op_sel_hi:[1,0]
    v_pk_fma_f32 v[74:75], v[76:77], v[72:73], v[74:75] op_sel:[1,1,0] op_sel_hi:[0,1,1] neg_lo:[1,0,0]
    v_cvt_pk_bf16_f32 v64, v74, -v75
    v_pk_mul_f32 v[78:79], v[84:85], v[72:73] op_sel_hi:[1,0]
    v_pk_fma_f32 v[78:79], v[84:85], v[72:73], v[78:79] op_sel:[1,1,0] op_sel_hi:[0,1,1] neg_lo:[1,0,0]
    v_cvt_pk_bf16_f32 v65, v78, -v79
    v_pk_mul_f32 v[80:81], v[74:75], v[72:73] op_sel_hi:[1,0]
    v_pk_fma_f32 v[80:81], v[74:75], v[72:73], v[80:81] op_sel:[1,1,0] op_sel_hi:[0,1,1] neg_lo:[1,0,0]
    v_cvt_pk_bf16_f32 v66, v80, -v81
    v_pk_mul_f32 v[82:83], v[78:79], v[72:73] op_sel_hi:[1,0]
    v_pk_fma_f32 v[82:83], v[78:79], v[72:73], v[82:83] op_sel:[1,1,0] op_sel_hi:[0,1,1] neg_lo:[1,0,0]
    v_cvt_pk_bf16_f32 v67, v82, -v83
    ds_write_addtid_b32 v60 offset:2176
    ds_write_addtid_b32 v61 offset:2448
    ds_write_addtid_b32 v62 offset:2720
    ds_write_addtid_b32 v63 offset:2992
    ds_write_addtid_b32 v64 offset:3264
    ds_write_addtid_b32 v65 offset:3536
    ds_write_addtid_b32 v66 offset:3808
    ds_write_addtid_b32 v67 offset:4080
    v_pk_mul_f32 v[86:87], v[76:77], v[48:49] op_sel_hi:[1,0]
    v_pk_fma_f32 v[86:87], v[76:77], v[48:49], v[86:87] op_sel:[1,1,0] op_sel_hi:[0,1,1] neg_lo:[1,0,0]
    v_cvt_pk_bf16_f32 v60, v86, -v87
    v_pk_mul_f32 v[88:89], v[80:81], v[72:73] op_sel_hi:[1,0]
    v_pk_fma_f32 v[88:89], v[80:81], v[72:73], v[88:89] op_sel:[1,1,0] op_sel_hi:[0,1,1] neg_lo:[1,0,0]
    v_cvt_pk_bf16_f32 v61, v88, -v89
    v_pk_mul_f32 v[84:85], v[88:89], v[72:73] op_sel_hi:[1,0]
    v_pk_fma_f32 v[84:85], v[88:89], v[72:73], v[84:85] op_sel:[1,1,0] op_sel_hi:[0,1,1] neg_lo:[1,0,0]
    v_cvt_pk_bf16_f32 v62, v84, -v85
    v_pk_mul_f32 v[78:79], v[84:85], v[72:73] op_sel_hi:[1,0]
    v_pk_fma_f32 v[78:79], v[84:85], v[72:73], v[78:79] op_sel:[1,1,0] op_sel_hi:[0,1,1] neg_lo:[1,0,0]
    v_cvt_pk_bf16_f32 v63, v78, -v79
    v_pk_mul_f32 v[82:83], v[74:75], v[48:49] op_sel_hi:[1,0]
    v_pk_fma_f32 v[82:83], v[74:75], v[48:49], v[82:83] op_sel:[1,1,0] op_sel_hi:[0,1,1] neg_lo:[1,0,0]
    v_cvt_pk_bf16_f32 v64, v82, -v83
    v_pk_mul_f32 v[76:77], v[78:79], v[72:73] op_sel_hi:[1,0]
    v_pk_fma_f32 v[76:77], v[78:79], v[72:73], v[76:77] op_sel:[1,1,0] op_sel_hi:[0,1,1] neg_lo:[1,0,0]
    v_cvt_pk_bf16_f32 v65, v76, -v77
    v_pk_mul_f32 v[86:87], v[76:77], v[72:73] op_sel_hi:[1,0]
    v_pk_fma_f32 v[86:87], v[76:77], v[72:73], v[86:87] op_sel:[1,1,0] op_sel_hi:[0,1,1] neg_lo:[1,0,0]
    v_cvt_pk_bf16_f32 v66, v86, -v87
    v_pk_mul_f32 v[88:89], v[80:81], v[48:49] op_sel_hi:[1,0]
    v_pk_fma_f32 v[88:89], v[80:81], v[48:49], v[88:89] op_sel:[1,1,0] op_sel_hi:[0,1,1] neg_lo:[1,0,0]
    v_cvt_pk_bf16_f32 v67, v88, -v89
    ds_write_addtid_b32 v60 offset:4352
    ds_write_addtid_b32 v61 offset:4624
    ds_write_addtid_b32 v62 offset:4896
    ds_write_addtid_b32 v63 offset:5168
    ds_write_addtid_b32 v64 offset:5440
    ds_write_addtid_b32 v65 offset:5712
    ds_write_addtid_b32 v66 offset:5984
    ds_write_addtid_b32 v67 offset:6256
    ds_read_b128 a[32:35], v100 offset:0
    ds_read_b128 a[36:39], v100 offset:32
    ds_read_b128 a[40:43], v100 offset:64
    ds_read_b128 a[44:47], v100 offset:96
    ds_read_b128 a[48:51], v100 offset:128
    ds_read_b128 a[52:55], v100 offset:160
    ds_read_b128 a[56:59], v100 offset:192
    ds_read_b128 a[60:63], v100 offset:224
    global_load_dwordx4 a[96:99], v20, s[50:51] offset:-4096
    global_load_dwordx4 a[100:103], v20, s[50:51] offset:-3072
    global_load_dwordx4 a[104:107], v20, s[50:51] offset:-2048
    global_load_dwordx4 a[108:111], v20, s[50:51] offset:-1024
    global_load_dwordx4 a[112:115], v20, s[50:51] offset:0
    global_load_dwordx4 a[116:119], v20, s[50:51] offset:1024
    global_load_dwordx4 v[16:19], v20, s[50:51] offset:2048
    v_and_b32 v54, 0xffff0000, v34
    v_and_b32 v55, 0xffff0000, v35
    v_and_b32 v50, 0xffff0000, v36
    v_and_b32 v51, 0xffff0000, v37
    v_and_b32 v52, 0xffff0000, v38
    v_and_b32 v53, 0xffff0000, v39
    v_mul_f32 v54, v54, v129
    v_mul_f32 v55, v55, v130
    v_mul_f32 v56, 0x41000000, v54
    v_mul_f32 v57, 0x41000000, v55
    v_fract_f32 v55, v55
    v_fract_f32 v57, v57
    v_exp_f32 v59, v56
    v_cos_f32 v48, v57
    v_sin_f32 v49, v57
    v_exp_f32 v58, v54
    v_cos_f32 v46, v55
    v_sin_f32 v47, v55
    v_mul_f32 v48, v48, v59
    v_mul_f32 v49, v49, v59
    v_mul_f32 v46, v46, v58
    v_mul_f32 v47, v47, v58
    v_mul_f32 v50, v50, v128
    v_mul_f32 v51, v51, v128
    v_cvt_pk_bf16_f32 v60, 1.0, 0
    v_cvt_pk_bf16_f32 v61, v48, v49
    v_pk_mul_f32 v[68:69], v[48:49], v[48:49] op_sel_hi:[1,0]
    v_pk_fma_f32 v[68:69], v[48:49], v[48:49], v[68:69] op_sel:[1,1,0] op_sel_hi:[0,1,1] neg_lo:[1,0,0]
    v_cvt_pk_bf16_f32 v62, v68, v69
    v_pk_mul_f32 v[70:71], v[68:69], v[48:49] op_sel_hi:[1,0]
    v_pk_fma_f32 v[70:71], v[68:69], v[48:49], v[70:71] op_sel:[1,1,0] op_sel_hi:[0,1,1] neg_lo:[1,0,0]
    v_cvt_pk_bf16_f32 v63, v70, v71
    v_pk_mul_f32 v[68:69], v[70:71], v[48:49] op_sel_hi:[1,0]
    v_pk_fma_f32 v[68:69], v[70:71], v[48:49], v[68:69] op_sel:[1,1,0] op_sel_hi:[0,1,1] neg_lo:[1,0,0]
    v_cvt_pk_bf16_f32 v64, v68, v69
    v_pk_mul_f32 v[70:71], v[68:69], v[48:49] op_sel_hi:[1,0]
    v_pk_fma_f32 v[70:71], v[68:69], v[48:49], v[70:71] op_sel:[1,1,0] op_sel_hi:[0,1,1] neg_lo:[1,0,0]
    v_cvt_pk_bf16_f32 v65, v70, v71
    v_pk_mul_f32 v[68:69], v[70:71], v[48:49] op_sel_hi:[1,0]
    v_pk_fma_f32 v[68:69], v[70:71], v[48:49], v[68:69] op_sel:[1,1,0] op_sel_hi:[0,1,1] neg_lo:[1,0,0]
    v_cvt_pk_bf16_f32 v66, v68, v69
    v_pk_mul_f32 v[70:71], v[68:69], v[48:49] op_sel_hi:[1,0]
    v_pk_fma_f32 v[70:71], v[68:69], v[48:49], v[70:71] op_sel:[1,1,0] op_sel_hi:[0,1,1] neg_lo:[1,0,0]
    s_waitcnt lgkmcnt(0)
    s_nop 0
    v_mfma_f32_32x32x16_bf16 v[112:127], a[32:35], a[0:3], 0
    v_mfma_f32_32x32x16_bf16 v[112:127], a[36:39], a[4:7], v[112:127]
    v_cvt_pk_bf16_f32 v67, v70, v71
    ds_write_addtid_b32 v60 offset:0
    ds_write_addtid_b32 v61 offset:272
    ds_write_addtid_b32 v62 offset:544
    ds_write_addtid_b32 v63 offset:816
    ds_write_addtid_b32 v64 offset:1088
    ds_write_addtid_b32 v65 offset:1360
    ds_write_addtid_b32 v66 offset:1632
    ds_write_addtid_b32 v67 offset:1904
    v_pk_mul_f32 v[68:69], v[70:71], v[48:49] op_sel_hi:[1,0]
    v_pk_fma_f32 v[68:69], v[70:71], v[48:49], v[68:69] op_sel:[1,1,0] op_sel_hi:[0,1,1] neg_lo:[1,0,0]
    v_cvt_pk_bf16_f32 v60, v68, v69
    v_pk_mul_f32 v[70:71], v[68:69], v[48:49] op_sel_hi:[1,0]
    v_pk_fma_f32 v[70:71], v[68:69], v[48:49], v[70:71] op_sel:[1,1,0] op_sel_hi:[0,1,1] neg_lo:[1,0,0]
    v_cvt_pk_bf16_f32 v61, v70, v71
    v_pk_mul_f32 v[68:69], v[70:71], v[48:49] op_sel_hi:[1,0]
    v_pk_fma_f32 v[68:69], v[70:71], v[48:49], v[68:69] op_sel:[1,1,0] op_sel_hi:[0,1,1] neg_lo:[1,0,0]
    v_cvt_pk_bf16_f32 v62, v68, v69
    v_pk_mul_f32 v[70:71], v[68:69], v[48:49] op_sel_hi:[1,0]
    v_pk_fma_f32 v[70:71], v[68:69], v[48:49], v[70:71] op_sel:[1,1,0] op_sel_hi:[0,1,1] neg_lo:[1,0,0]
    v_cvt_pk_bf16_f32 v63, v70, v71
    v_pk_mul_f32 v[68:69], v[70:71], v[48:49] op_sel_hi:[1,0]
    v_pk_fma_f32 v[68:69], v[70:71], v[48:49], v[68:69] op_sel:[1,1,0] op_sel_hi:[0,1,1] neg_lo:[1,0,0]
    v_cvt_pk_bf16_f32 v64, v68, v69
    v_pk_mul_f32 v[70:71], v[68:69], v[48:49] op_sel_hi:[1,0]
    v_pk_fma_f32 v[70:71], v[68:69], v[48:49], v[70:71] op_sel:[1,1,0] op_sel_hi:[0,1,1] neg_lo:[1,0,0]
    v_cvt_pk_bf16_f32 v65, v70, v71
    v_pk_mul_f32 v[68:69], v[70:71], v[48:49] op_sel_hi:[1,0]
    v_pk_fma_f32 v[68:69], v[70:71], v[48:49], v[68:69] op_sel:[1,1,0] op_sel_hi:[0,1,1] neg_lo:[1,0,0]
    v_cvt_pk_bf16_f32 v66, v68, v69
    v_pk_mul_f32 v[70:71], v[68:69], v[48:49] op_sel_hi:[1,0]
    v_pk_fma_f32 v[70:71], v[68:69], v[48:49], v[70:71] op_sel:[1,1,0] op_sel_hi:[0,1,1] neg_lo:[1,0,0]
    v_mfma_f32_32x32x16_bf16 v[112:127], a[40:43], a[8:11], v[112:127]
    v_mfma_f32_32x32x16_bf16 v[112:127], a[44:47], a[12:15], v[112:127]
    v_cvt_pk_bf16_f32 v67, v70, v71
    ds_write_addtid_b32 v60 offset:2176
    ds_write_addtid_b32 v61 offset:2448
    ds_write_addtid_b32 v62 offset:2720
L_SC_hop1:
    s_cbranch_execz L_SC_ret
    s_nop 0
    ds_write_addtid_b32 v63 offset:2992
    ds_write_addtid_b32 v64 offset:3264
    ds_write_addtid_b32 v65 offset:3536
    ds_write_addtid_b32 v66 offset:3808
    ds_write_addtid_b32 v67 offset:4080
    v_pk_mul_f32 v[68:69], v[70:71], v[48:49] op_sel_hi:[1,0]
    v_pk_fma_f32 v[68:69], v[70:71], v[48:49], v[68:69] op_sel:[1,1,0] op_sel_hi:[0,1,1] neg_lo:[1,0,0]
    v_cvt_pk_bf16_f32 v60, v68, v69
    v_pk_mul_f32 v[70:71], v[68:69], v[48:49] op_sel_hi:[1,0]
    v_pk_fma_f32 v[70:71], v[68:69], v[48:49], v[70:71] op_sel:[1,1,0] op_sel_hi:[0,1,1] neg_lo:[1,0,0]
    v_cvt_pk_bf16_f32 v61, v70, v71
    v_pk_mul_f32 v[68:69], v[70:71], v[48:49] op_sel_hi:[1,0]
    v_pk_fma_f32 v[68:69], v[70:71], v[48:49], v[68:69] op_sel:[1,1,0] op_sel_hi:[0,1,1] neg_lo:[1,0,0]
    v_cvt_pk_bf16_f32 v62, v68, v69
    v_pk_mul_f32 v[70:71], v[68:69], v[48:49] op_sel_hi:[1,0]
    v_pk_fma_f32 v[70:71], v[68:69], v[48:49], v[70:71] op_sel:[1,1,0] op_sel_hi:[0,1,1] neg_lo:[1,0,0]
    v_cvt_pk_bf16_f32 v63, v70, v71
    v_pk_mul_f32 v[68:69], v[70:71], v[48:49] op_sel_hi:[1,0]
    v_pk_fma_f32 v[68:69], v[70:71], v[48:49], v[68:69] op_sel:[1,1,0] op_sel_hi:[0,1,1] neg_lo:[1,0,0]
    v_cvt_pk_bf16_f32 v64, v68, v69
    v_pk_mul_f32 v[70:71], v[68:69], v[48:49] op_sel_hi:[1,0]
    v_pk_fma_f32 v[70:71], v[68:69], v[48:49], v[70:71] op_sel:[1,1,0] op_sel_hi:[0,1,1] neg_lo:[1,0,0]
    v_cvt_pk_bf16_f32 v65, v70, v71
    v_pk_mul_f32 v[68:69], v[70:71], v[48:49] op_sel_hi:[1,0]
    v_pk_fma_f32 v[68:69], v[70:71], v[48:49], v[68:69] op_sel:[1,1,0] op_sel_hi:[0,1,1] neg_lo:[1,0,0]
    v_cvt_pk_bf16_f32 v66, v68, v69
    v_pk_mul_f32 v[70:71], v[68:69], v[48:49] op_sel_hi:[1,0]
    v_pk_fma_f32 v[70:71], v[68:69], v[48:49], v[70:71] op_sel:[1,1,0] op_sel_hi:[0,1,1] neg_lo:[1,0,0]
    v_mfma_f32_32x32x16_bf16 v[112:127], a[48:51], a[16:19], v[112:127]
    v_mfma_f32_32x32x16_bf16 v[112:127], a[52:55], a[20:23], v[112:127]
    v_cvt_pk_bf16_f32 v67, v70, v71
    ds_write_addtid_b32 v60 offset:4352
    ds_write_addtid_b32 v61 offset:4624
    ds_write_addtid_b32 v62 offset:4896
    ds_write_addtid_b32 v63 offset:5168
    ds_write_addtid_b32 v64 offset:5440
    ds_write_addtid_b32 v65 offset:5712
    ds_write_addtid_b32 v66 offset:5984
    ds_write_addtid_b32 v67 offset:6256
    v_pk_mul_f32 v[68:69], v[70:71], v[48:49] op_sel_hi:[1,0]
    v_pk_fma_f32 v[68:69], v[70:71], v[48:49], v[68:69] op_sel:[1,1,0] op_sel_hi:[0,1,1] neg_lo:[1,0,0]
    v_cvt_pk_bf16_f32 v60, v68, v69
    v_pk_mul_f32 v[70:71], v[68:69], v[48:49] op_sel_hi:[1,0]
    v_pk_fma_f32 v[70:71], v[68:69], v[48:49], v[70:71] op_sel:[1,1,0] op_sel_hi:[0,1,1] neg_lo:[1,0,0]
    v_cvt_pk_bf16_f32 v61, v70, v71
    v_pk_mul_f32 v[68:69], v[70:71], v[48:49] op_sel_hi:[1,0]
    v_pk_fma_f32 v[68:69], v[70:71], v[48:49], v[68:69] op_sel:[1,1,0] op_sel_hi:[0,1,1] neg_lo:[1,0,0]
    v_cvt_pk_bf16_f32 v62, v68, v69
    v_pk_mul_f32 v[70:71], v[68:69], v[48:49] op_sel_hi:[1,0]
    v_pk_fma_f32 v[70:71], v[68:69], v[48:49], v[70:71] op_sel:[1,1,0] op_sel_hi:[0,1,1] neg_lo:[1,0,0]
    v_cvt_pk_bf16_f32 v63, v70, v71
    v_pk_mul_f32 v[68:69], v[70:71], v[48:49] op_sel_hi:[1,0]
    v_pk_fma_f32 v[68:69], v[70:71], v[48:49], v[68:69] op_sel:[1,1,0] op_sel_hi:[0,1,1] neg_lo:[1,0,0]
    v_cvt_pk_bf16_f32 v64, v68, v69
    v_pk_mul_f32 v[70:71], v[68:69], v[48:49] op_sel_hi:[1,0]
    v_pk_fma_f32 v[70:71], v[68:69], v[48:49], v[70:71] op_sel:[1,1,0] op_sel_hi:[0,1,1] neg_lo:[1,0,0]
    v_cvt_pk_bf16_f32 v65, v70, v71
    v_pk_mul_f32 v[68:69], v[70:71], v[48:49] op_sel_hi:[1,0]
    v_pk_fma_f32 v[68:69], v[70:71], v[48:49], v[68:69] op_sel:[1,1,0] op_sel_hi:[0,1,1] neg_lo:[1,0,0]
    v_cvt_pk_bf16_f32 v66, v68, v69
    v_pk_mul_f32 v[70:71], v[68:69], v[48:49] op_sel_hi:[1,0]
    v_pk_fma_f32 v[70:71], v[68:69], v[48:49], v[70:71] op_sel:[1,1,0] op_sel_hi:[0,1,1] neg_lo:[1,0,0]
    v_mfma_f32_32x32x16_bf16 v[112:127], a[56:59], a[24:27], v[112:127]
    v_mfma_f32_32x32x16_bf16 v[112:127], a[60:63], a[28:31], v[112:127]
    v_cvt_pk_bf16_f32 v67, v70, v71
    ds_write_addtid_b32 v60 offset:6528
    ds_write_addtid_b32 v61 offset:6800
    ds_write_addtid_b32 v62 offset:7072
    ds_write_addtid_b32 v63 offset:7344
    ds_write_addtid_b32 v64 offset:7616
    ds_write_addtid_b32 v65 offset:7888
    ds_write_addtid_b32 v66 offset:8160
    ds_write_addtid_b32 v67 offset:8432
    ds_read_b128 a[0:3], v100 offset:0
    ds_read_b128 a[4:7], v100 offset:32
    ds_read_b128 a[8:11], v100 offset:64
    ds_read_b128 a[12:15], v100 offset:96
    ds_read_b128 a[16:19], v100 offset:128
    ds_read_b128 a[20:23], v100 offset:160
    ds_read_b128 a[24:27], v100 offset:192
    ds_read_b128 a[28:31], v100 offset:224
    v_pk_mul_f32 v[72:73], v[70:71], v[48:49] op_sel_hi:[1,0]
    v_pk_fma_f32 v[72:73], v[70:71], v[48:49], v[72:73] op_sel:[1,1,0] op_sel_hi:[0,1,1] neg_lo:[1,0,0]
    v_pk_mul_f32 v[74:75], v[52:53], v[50:51] op_sel_hi:[1,0]
    v_pk_fma_f32 v[74:75], v[52:53], v[50:51], v[74:75] op_sel:[1,1,0] op_sel_hi:[0,1,1] neg_lo:[1,0,0]
    v_cvt_pk_bf16_f32 v60, v74, -v75
    v_pk_mul_f32 v[76:77], v[74:75], v[46:47] op_sel_hi:[1,0]
    v_pk_fma_f32 v[76:77], v[74:75], v[46:47], v[76:77] op_sel:[1,1,0] op_sel_hi:[0,1,1] neg_lo:[1,0,0]
    v_cvt_pk_bf16_f32 v61, v76, -v77
    v_pk_mul_f32 v[78:79], v[76:77], v[46:47] op_sel_hi:[1,0]
    v_pk_fma_f32 v[78:79], v[76:77], v[46:47], v[78:79] op_sel:[1,1,0] op_sel_hi:[0,1,1] neg_lo:[1,0,0]
    v_cvt_pk_bf16_f32 v62, v78, -v79
    v_pk_mul_f32 v[80:81], v[78:79], v[46:47] op_sel_hi:[1,0]
    v_pk_fma_f32 v[80:81], v[78:79], v[46:47], v[80:81] op_sel:[1,1,0] op_sel_hi:[0,1,1] neg_lo:[1,0,0]
    v_cvt_pk_bf16_f32 v63, v80, -v81
    v_pk_mul_f32 v[82:83], v[80:81], v[46:47] op_sel_hi:[1,0]
    v_pk_fma_f32 v[82:83], v[80:81], v[46:47], v[82:83] op_sel:[1,1,0] op_sel_hi:[0,1,1] neg_lo:[1,0,0]
    v_cvt_pk_bf16_f32 v64, v82, -v83
    v_pk_mul_f32 v[84:85], v[82:83], v[46:47] op_sel_hi:[1,0]
    v_pk_fma_f32 v[84:85], v[82:83], v[46:47], v[84:85] op_sel:[1,1,0] op_sel_hi:[0,1,1] neg_lo:[1,0,0]
    v_cvt_pk_bf16_f32 v65, v84, -v85
    v_pk_mul_f32 v[86:87], v[84:85], v[46:47] op_sel_hi:[1,0]
    v_pk_fma_f32 v[86:87], v[84:85], v[46:47], v[86:87] op_sel:[1,1,0] op_sel_hi:[0,1,1] neg_lo:[1,0,0]
    v_cvt_pk_bf16_f32 v66, v86, -v87
    v_pk_mul_f32 v[88:89], v[86:87], v[46:47] op_sel_hi:[1,0]
    v_pk_fma_f32 v[88:89], v[86:87], v[46:47], v[88:89] op_sel:[1,1,0] op_sel_hi:[0,1,1] neg_lo:[1,0,0]
    v_cvt_pk_bf16_f32 v67, v88, -v89
    ds_write_addtid_b32 v60 offset:0
    ds_write_addtid_b32 v61 offset:272
    ds_write_addtid_b32 v62 offset:544
    ds_write_addtid_b32 v63 offset:816
    ds_write_addtid_b32 v64 offset:1088
    ds_write_addtid_b32 v65 offset:1360
    ds_write_addtid_b32 v66 offset:1632
    ds_write_addtid_b32 v67 offset:1904
    v_pk_mul_f32 v[76:77], v[74:75], v[72:73] op_sel_hi:[1,0]
    v_pk_fma_f32 v[76:77], v[74:75], v[72:73], v[76:77] op_sel:[1,1,0] op_sel_hi:[0,1,1] neg_lo:[1,0,0]
    v_cvt_pk_bf16_f32 v60, v76, -v77
    v_pk_mul_f32 v[80:81], v[78:79], v[72:73] op_sel_hi:[1,0]
    v_pk_fma_f32 v[80:81], v[78:79], v[72:73], v[80:81] op_sel:[1,1,0] op_sel_hi:[0,1,1] neg_lo:[1,0,0]
    v_cvt_pk_bf16_f32 v61, v80, -v81
    v_pk_mul_f32 v[84:85], v[82:83], v[72:73] op_sel_hi:[1,0]
    v_pk_fma_f32 v[84:85], v[82:83], v[72:73], v[84:85] op_sel:[1,1,0] op_sel_hi:[0,1,1] neg_lo:[1,0,0]
    v_cvt_pk_bf16_f32 v62, v84, -v85
    v_pk_mul_f32 v[88:89], v[86:87], v[72:73] op_sel_hi:[1,0]
    v_pk_fma_f32 v[88:89], v[86:87], v[72:73], v[88:89] op_sel:[1,1,0] op_sel_hi:[0,1,1] neg_lo:[1,0,0]
    v_cvt_pk_bf16_f32 v63, v88, -v89
    v_pk_mul_f32 v[74:75], v[76:77], v[72:73] op_sel_hi:[1,0]
    v_pk_fma_f32 v[74:75], v[76:77], v[72:73], v[74:75] op_sel:[1,1,0] op_sel_hi:[0,1,1] neg_lo:[1,0,0]
    v_cvt_pk_bf16_f32 v64, v74, -v75
    v_pk_mul_f32 v[78:79], v[84:85], v[72:73] op_sel_hi:[1,0]
    v_pk_fma_f32 v[78:79], v[84:85], v[72:73], v[78:79] op_sel:[1,1,0] op_sel_hi:[0,1,1] neg_lo:[1,0,0]
    v_cvt_pk_bf16_f32 v65, v78, -v79
    v_pk_mul_f32 v[80:81], v[74:75], v[72:73] op_sel_hi:[1,0]
    v_pk_fma_f32 v[80:81], v[74:75], v[72:73], v[80:81] op_sel:[1,1,0] op_sel_hi:[0,1,1] neg_lo:[1,0,0]
    v_cvt_pk_bf16_f32 v66, v80, -v81
    v_pk_mul_f32 v[82:83], v[78:79], v[72:73] op_sel_hi:[1,0]
    v_pk_fma_f32 v[82:83], v[78:79], v[72:73], v[82:83] op_sel:[1,1,0] op_sel_hi:[0,1,1] neg_lo:[1,0,0]
    v_cvt_pk_bf16_f32 v67, v82, -v83
    ds_write_addtid_b32 v60 offset:2176
    ds_write_addtid_b32 v61 offset:2448
    ds_write_addtid_b32 v62 offset:2720
    ds_write_addtid_b32 v63 offset:2992
    ds_write_addtid_b32 v64 offset:3264
    ds_write_addtid_b32 v65 offset:3536
    ds_write_addtid_b32 v66 offset:3808
    ds_write_addtid_b32 v67 offset:4080
    v_pk_mul_f32 v[86:87], v[76:77], v[48:49] op_sel_hi:[1,0]
    v_pk_fma_f32 v[86:87], v[76:77], v[48:49], v[86:87] op_sel:[1,1,0] op_sel_hi:[0,1,1] neg_lo:[1,0,0]
    v_cvt_pk_bf16_f32 v60, v86, -v87
    v_pk_mul_f32 v[88:89], v[80:81], v[72:73] op_sel_hi:[1,0]
    v_pk_fma_f32 v[88:89], v[80:81], v[72:73], v[88:89] op_sel:[1,1,0] op_sel_hi:[0,1,1] neg_lo:[1,0,0]
    v_cvt_pk_bf16_f32 v61, v88, -v89
    v_pk_mul_f32 v[84:85], v[88:89], v[72:73] op_sel_hi:[1,0]
    v_pk_fma_f32 v[84:85], v[88:89], v[72:73], v[84:85] op_sel:[1,1,0] op_sel_hi:[0,1,1] neg_lo:[1,0,0]
    v_cvt_pk_bf16_f32 v62, v84, -v85
    v_pk_mul_f32 v[78:79], v[84:85], v[72:73] op_sel_hi:[1,0]
    v_pk_fma_f32 v[78:79], v[84:85], v[72:73], v[78:79] op_sel:[1,1,0] op_sel_hi:[0,1,1] neg_lo:[1,0,0]
    v_cvt_pk_bf16_f32 v63, v78, -v79
    v_pk_mul_f32 v[82:83], v[74:75], v[48:49] op_sel_hi:[1,0]
    v_pk_fma_f32 v[82:83], v[74:75], v[48:49], v[82:83] op_sel:[1,1,0] op_sel_hi:[0,1,1] neg_lo:[1,0,0]
    v_cvt_pk_bf16_f32 v64, v82, -v83
    v_pk_mul_f32 v[76:77], v[78:79], v[72:73] op_sel_hi:[1,0]
    v_pk_fma_f32 v[76:77], v[78:79], v[72:73], v[76:77] op_sel:[1,1,0] op_sel_hi:[0,1,1] neg_lo:[1,0,0]
    v_cvt_pk_bf16_f32 v65, v76, -v77
    v_pk_mul_f32 v[86:87], v[76:77], v[72:73] op_sel_hi:[1,0]
    v_pk_fma_f32 v[86:87], v[76:77], v[72:73], v[86:87] op_sel:[1,1,0] op_sel_hi:[0,1,1] neg_lo:[1,0,0]
    v_cvt_pk_bf16_f32 v66, v86, -v87
    v_pk_mul_f32 v[88:89], v[80:81], v[48:49] op_sel_hi:[1,0]
    v_pk_fma_f32 v[88:89], v[80:81], v[48:49], v[88:89] op_sel:[1,1,0] op_sel_hi:[0,1,1] neg_lo:[1,0,0]
    v_cvt_pk_bf16_f32 v67, v88, -v89
    ds_write_addtid_b32 v60 offset:4352
    ds_write_addtid_b32 v61 offset:4624
    ds_write_addtid_b32 v62 offset:4896
    ds_write_addtid_b32 v63 offset:5168
    ds_write_addtid_b32 v64 offset:5440
    ds_write_addtid_b32 v65 offset:5712
    ds_write_addtid_b32 v66 offset:5984
    ds_write_addtid_b32 v67 offset:6256
    ds_read_b128 a[32:35], v100 offset:0
    ds_read_b128 a[36:39], v100 offset:32
    ds_read_b128 a[40:43], v100 offset:64
    ds_read_b128 a[44:47], v100 offset:96
    ds_read_b128 a[48:51], v100 offset:128
    ds_read_b128 a[52:55], v100 offset:160
    ds_read_b128 a[56:59], v100 offset:192
    ds_read_b128 a[60:63], v100 offset:224
    s_waitcnt vmcnt(14)
    v_lshlrev_b32 v54, 16, v40
    s_waitcnt vmcnt(13)
    v_lshlrev_b32 v55, 16, v41
    s_waitcnt vmcnt(12)
    v_lshlrev_b32 v50, 16, v42
    s_waitcnt vmcnt(11)
    v_lshlrev_b32 v51, 16, v43
    s_waitcnt vmcnt(10)
    v_lshlrev_b32 v52, 16, v44
    s_waitcnt vmcnt(9)
    v_lshlrev_b32 v53, 16, v45
    v_mul_f32 v54, v54, v129
    v_mul_f32 v55, v55, v130
    v_mul_f32 v56, 0x41000000, v54
    v_mul_f32 v57, 0x41000000, v55
    v_fract_f32 v55, v55
    v_fract_f32 v57, v57
    v_exp_f32 v59, v56
    v_cos_f32 v48, v57
    v_sin_f32 v49, v57
    v_exp_f32 v58, v54
    v_cos_f32 v46, v55
    v_sin_f32 v47, v55
    v_mul_f32 v48, v48, v59
    v_mul_f32 v49, v49, v59
    v_mul_f32 v46, v46, v58
    v_mul_f32 v47, v47, v58
    v_mul_f32 v50, v50, v128
    v_mul_f32 v51, v51, v128
    v_cvt_pk_bf16_f32 v60, 1.0, 0
    v_cvt_pk_bf16_f32 v61, v48, v49
    v_pk_mul_f32 v[68:69], v[48:49], v[48:49] op_sel_hi:[1,0]
    v_pk_fma_f32 v[68:69], v[48:49], v[48:49], v[68:69] op_sel:[1,1,0] op_sel_hi:[0,1,1] neg_lo:[1,0,0]
    v_cvt_pk_bf16_f32 v62, v68, v69
    v_pk_mul_f32 v[70:71], v[68:69], v[48:49] op_sel_hi:[1,0]
    v_pk_fma_f32 v[70:71], v[68:69], v[48:49], v[70:71] op_sel:[1,1,0] op_sel_hi:[0,1,1] neg_lo:[1,0,0]
    v_cvt_pk_bf16_f32 v63, v70, v71
    v_pk_mul_f32 v[68:69], v[70:71], v[48:49] op_sel_hi:[1,0]
    v_pk_fma_f32 v[68:69], v[70:71], v[48:49], v[68:69] op_sel:[1,1,0] op_sel_hi:[0,1,1] neg_lo:[1,0,0]
    v_cvt_pk_bf16_f32 v64, v68, v69
    v_pk_mul_f32 v[70:71], v[68:69], v[48:49] op_sel_hi:[1,0]
    v_pk_fma_f32 v[70:71], v[68:69], v[48:49], v[70:71] op_sel:[1,1,0] op_sel_hi:[0,1,1] neg_lo:[1,0,0]
    v_cvt_pk_bf16_f32 v65, v70, v71
    v_pk_mul_f32 v[68:69], v[70:71], v[48:49] op_sel_hi:[1,0]
    v_pk_fma_f32 v[68:69], v[70:71], v[48:49], v[68:69] op_sel:[1,1,0] op_sel_hi:[0,1,1] neg_lo:[1,0,0]
    v_cvt_pk_bf16_f32 v66, v68, v69
    v_pk_mul_f32 v[70:71], v[68:69], v[48:49] op_sel_hi:[1,0]
    v_pk_fma_f32 v[70:71], v[68:69], v[48:49], v[70:71] op_sel:[1,1,0] op_sel_hi:[0,1,1] neg_lo:[1,0,0]
    s_waitcnt lgkmcnt(0)
    s_nop 0
    v_mfma_f32_32x32x16_bf16 v[112:127], a[32:35], a[0:3], v[112:127]
    v_mfma_f32_32x32x16_bf16 v[112:127], a[36:39], a[4:7], v[112:127]
    v_cvt_pk_bf16_f32 v67, v70, v71
    ds_write_addtid_b32 v60 offset:0
    ds_write_addtid_b32 v61 offset:272
    ds_write_addtid_b32 v62 offset:544
    ds_write_addtid_b32 v63 offset:816
    ds_write_addtid_b32 v64 offset:1088
    ds_write_addtid_b32 v65 offset:1360
    ds_write_addtid_b32 v66 offset:1632
    ds_write_addtid_b32 v67 offset:1904
    v_pk_mul_f32 v[68:69], v[70:71], v[48:49] op_sel_hi:[1,0]
    v_pk_fma_f32 v[68:69], v[70:71], v[48:49], v[68:69] op_sel:[1,1,0] op_sel_hi:[0,1,1] neg_lo:[1,0,0]
    v_cvt_pk_bf16_f32 v60, v68, v69
    v_pk_mul_f32 v[70:71], v[68:69], v[48:49] op_sel_hi:[1,0]
    v_pk_fma_f32 v[70:71], v[68:69], v[48:49], v[70:71] op_sel:[1,1,0] op_sel_hi:[0,1,1] neg_lo:[1,0,0]
    v_cvt_pk_bf16_f32 v61, v70, v71
    v_pk_mul_f32 v[68:69], v[70:71], v[48:49] op_sel_hi:[1,0]
    v_pk_fma_f32 v[68:69], v[70:71], v[48:49], v[68:69] op_sel:[1,1,0] op_sel_hi:[0,1,1] neg_lo:[1,0,0]
    v_cvt_pk_bf16_f32 v62, v68, v69
    v_pk_mul_f32 v[70:71], v[68:69], v[48:49] op_sel_hi:[1,0]
    v_pk_fma_f32 v[70:71], v[68:69], v[48:49], v[70:71] op_sel:[1,1,0] op_sel_hi:[0,1,1] neg_lo:[1,0,0]
    v_cvt_pk_bf16_f32 v63, v70, v71
    v_pk_mul_f32 v[68:69], v[70:71], v[48:49] op_sel_hi:[1,0]
    v_pk_fma_f32 v[68:69], v[70:71], v[48:49], v[68:69] op_sel:[1,1,0] op_sel_hi:[0,1,1] neg_lo:[1,0,0]
    v_cvt_pk_bf16_f32 v64, v68, v69
    v_pk_mul_f32 v[70:71], v[68:69], v[48:49] op_sel_hi:[1,0]
    v_pk_fma_f32 v[70:71], v[68:69], v[48:49], v[70:71] op_sel:[1,1,0] op_sel_hi:[0,1,1] neg_lo:[1,0,0]
    v_cvt_pk_bf16_f32 v65, v70, v71
    v_pk_mul_f32 v[68:69], v[70:71], v[48:49] op_sel_hi:[1,0]
    v_pk_fma_f32 v[68:69], v[70:71], v[48:49], v[68:69] op_sel:[1,1,0] op_sel_hi:[0,1,1] neg_lo:[1,0,0]
    v_cvt_pk_bf16_f32 v66, v68, v69
    v_pk_mul_f32 v[70:71], v[68:69], v[48:49] op_sel_hi:[1,0]
    v_pk_fma_f32 v[70:71], v[68:69], v[48:49], v[70:71] op_sel:[1,1,0] op_sel_hi:[0,1,1] neg_lo:[1,0,0]
    v_mfma_f32_32x32x16_bf16 v[112:127], a[40:43], a[8:11], v[112:127]
    v_mfma_f32_32x32x16_bf16 v[112:127], a[44:47], a[12:15], v[112:127]
    v_cvt_pk_bf16_f32 v67, v70, v71
    ds_write_addtid_b32 v60 offset:2176
    ds_write_addtid_b32 v61 offset:2448
    ds_write_addtid_b32 v62 offset:2720
    ds_write_addtid_b32 v63 offset:2992
    ds_write_addtid_b32 v64 offset:3264
    ds_write_addtid_b32 v65 offset:3536
    ds_write_addtid_b32 v66 offset:3808
    ds_write_addtid_b32 v67 offset:4080
    v_pk_mul_f32 v[68:69], v[70:71], v[48:49] op_sel_hi:[1,0]
    v_pk_fma_f32 v[68:69], v[70:71], v[48:49], v[68:69] op_sel:[1,1,0] op_sel_hi:[0,1,1] neg_lo:[1,0,0]
    v_cvt_pk_bf16_f32 v60, v68, v69
    v_pk_mul_f32 v[70:71], v[68:69], v[48:49] op_sel_hi:[1,0]
    v_pk_fma_f32 v[70:71], v[68:69], v[48:49], v[70:71] op_sel:[1,1,0] op_sel_hi:[0,1,1] neg_lo:[1,0,0]
    v_cvt_pk_bf16_f32 v61, v70, v71
    v_pk_mul_f32 v[68:69], v[70:71], v[48:49] op_sel_hi:[1,0]
    v_pk_fma_f32 v[68:69], v[70:71], v[48:49], v[68:69] op_sel:[1,1,0] op_sel_hi:[0,1,1] neg_lo:[1,0,0]
    v_cvt_pk_bf16_f32 v62, v68, v69
    v_pk_mul_f32 v[70:71], v[68:69], v[48:49] op_sel_hi:[1,0]
    v_pk_fma_f32 v[70:71], v[68:69], v[48:49], v[70:71] op_sel:[1,1,0] op_sel_hi:[0,1,1] neg_lo:[1,0,0]
    v_cvt_pk_bf16_f32 v63, v70, v71
    v_pk_mul_f32 v[68:69], v[70:71], v[48:49] op_sel_hi:[1,0]
    v_pk_fma_f32 v[68:69], v[70:71], v[48:49], v[68:69] op_sel:[1,1,0] op_sel_hi:[0,1,1] neg_lo:[1,0,0]
    v_cvt_pk_bf16_f32 v64, v68, v69
    v_pk_mul_f32 v[70:71], v[68:69], v[48:49] op_sel_hi:[1,0]
    v_pk_fma_f32 v[70:71], v[68:69], v[48:49], v[70:71] op_sel:[1,1,0] op_sel_hi:[0,1,1] neg_lo:[1,0,0]
    v_cvt_pk_bf16_f32 v65, v70, v71
    v_pk_mul_f32 v[68:69], v[70:71], v[48:49] op_sel_hi:[1,0]
    v_pk_fma_f32 v[68:69], v[70:71], v[48:49], v[68:69] op_sel:[1,1,0] op_sel_hi:[0,1,1] neg_lo:[1,0,0]
    v_cvt_pk_bf16_f32 v66, v68, v69
    v_pk_mul_f32 v[70:71], v[68:69], v[48:49] op_sel_hi:[1,0]
    v_pk_fma_f32 v[70:71], v[68:69], v[48:49], v[70:71] op_sel:[1,1,0] op_sel_hi:[0,1,1] neg_lo:[1,0,0]
    v_mfma_f32_32x32x16_bf16 v[112:127], a[48:51], a[16:19], v[112:127]
    v_mfma_f32_32x32x16_bf16 v[112:127], a[52:55], a[20:23], v[112:127]
    v_cvt_pk_bf16_f32 v67, v70, v71
    ds_write_addtid_b32 v60 offset:4352
    ds_write_addtid_b32 v61 offset:4624
    ds_write_addtid_b32 v62 offset:4896
    ds_write_addtid_b32 v63 offset:5168
    ds_write_addtid_b32 v64 offset:5440
    ds_write_addtid_b32 v65 offset:5712
    ds_write_addtid_b32 v66 offset:5984
    ds_write_addtid_b32 v67 offset:6256
    v_pk_mul_f32 v[68:69], v[70:71], v[48:49] op_sel_hi:[1,0]
    v_pk_fma_f32 v[68:69], v[70:71], v[48:49], v[68:69] op_sel:[1,1,0] op_sel_hi:[0,1,1] neg_lo:[1,0,0]
    v_cvt_pk_bf16_f32 v60, v68, v69
    v_pk_mul_f32 v[70:71], v[68:69], v[48:49] op_sel_hi:[1,0]
    v_pk_fma_f32 v[70:71], v[68:69], v[48:49], v[70:71] op_sel:[1,1,0] op_sel_hi:[0,1,1] neg_lo:[1,0,0]
    v_cvt_pk_bf16_f32 v61, v70, v71
    v_pk_mul_f32 v[68:69], v[70:71], v[48:49] op_sel_hi:[1,0]
    v_pk_fma_f32 v[68:69], v[70:71], v[48:49], v[68:69] op_sel:[1,1,0] op_sel_hi:[0,1,1] neg_lo:[1,0,0]
    v_cvt_pk_bf16_f32 v62, v68, v69
    v_pk_mul_f32 v[70:71], v[68:69], v[48:49] op_sel_hi:[1,0]
    v_pk_fma_f32 v[70:71], v[68:69], v[48:49], v[70:71] op_sel:[1,1,0] op_sel_hi:[0,1,1] neg_lo:[1,0,0]
    v_cvt_pk_bf16_f32 v63, v70, v71
    v_pk_mul_f32 v[68:69], v[70:71], v[48:49] op_sel_hi:[1,0]
    v_pk_fma_f32 v[68:69], v[70:71], v[48:49], v[68:69] op_sel:[1,1,0] op_sel_hi:[0,1,1] neg_lo:[1,0,0]
    v_cvt_pk_bf16_f32 v64, v68, v69
    v_pk_mul_f32 v[70:71], v[68:69], v[48:49] op_sel_hi:[1,0]
    v_pk_fma_f32 v[70:71], v[68:69], v[48:49], v[70:71] op_sel:[1,1,0] op_sel_hi:[0,1,1] neg_lo:[1,0,0]
    v_cvt_pk_bf16_f32 v65, v70, v71
    v_pk_mul_f32 v[68:69], v[70:71], v[48:49] op_sel_hi:[1,0]
    v_pk_fma_f32 v[68:69], v[70:71], v[48:49], v[68:69] op_sel:[1,1,0] op_sel_hi:[0,1,1] neg_lo:[1,0,0]
    v_cvt_pk_bf16_f32 v66, v68, v69
    v_pk_mul_f32 v[70:71], v[68:69], v[48:49] op_sel_hi:[1,0]
    v_pk_fma_f32 v[70:71], v[68:69], v[48:49], v[70:71] op_sel:[1,1,0] op_sel_hi:[0,1,1] neg_lo:[1,0,0]
    v_mfma_f32_32x32x16_bf16 v[112:127], a[56:59], a[24:27], v[112:127]
    v_mfma_f32_32x32x16_bf16 v[112:127], a[60:63], a[28:31], v[112:127]
    v_cvt_pk_bf16_f32 v67, v70, v71
    ds_write_addtid_b32 v60 offset:6528
    ds_write_addtid_b32 v61 offset:6800
    ds_write_addtid_b32 v62 offset:7072
    ds_write_addtid_b32 v63 offset:7344
    ds_write_addtid_b32 v64 offset:7616
    ds_write_addtid_b32 v65 offset:7888
    ds_write_addtid_b32 v66 offset:8160
    ds_write_addtid_b32 v67 offset:8432
    ds_read_b128 a[0:3], v100 offset:0
    ds_read_b128 a[4:7], v100 offset:32
    ds_read_b128 a[8:11], v100 offset:64
    ds_read_b128 a[12:15], v100 offset:96
    ds_read_b128 a[16:19], v100 offset:128
    ds_read_b128 a[20:23], v100 offset:160
    ds_read_b128 a[24:27], v100 offset:192
    ds_read_b128 a[28:31], v100 offset:224
    v_pk_mul_f32 v[72:73], v[70:71], v[48:49] op_sel_hi:[1,0]
    v_pk_fma_f32 v[72:73], v[70:71], v[48:49], v[72:73] op_sel:[1,1,0] op_sel_hi:[0,1,1] neg_lo:[1,0,0]
    v_pk_mul_f32 v[74:75], v[52:53], v[50:51] op_sel_hi:[1,0]
    v_pk_fma_f32 v[74:75], v[52:53], v[50:51], v[74:75] op_sel:[1,1,0] op_sel_hi:[0,1,1] neg_lo:[1,0,0]
    v_cvt_pk_bf16_f32 v60, v74, -v75
    v_pk_mul_f32 v[76:77], v[74:75], v[46:47] op_sel_hi:[1,0]
    v_pk_fma_f32 v[76:77], v[74:75], v[46:47], v[76:77] op_sel:[1,1,0] op_sel_hi:[0,1,1] neg_lo:[1,0,0]
    v_cvt_pk_bf16_f32 v61, v76, -v77
    v_pk_mul_f32 v[78:79], v[76:77], v[46:47] op_sel_hi:[1,0]
    v_pk_fma_f32 v[78:79], v[76:77], v[46:47], v[78:79] op_sel:[1,1,0] op_sel_hi:[0,1,1] neg_lo:[1,0,0]
    v_cvt_pk_bf16_f32 v62, v78, -v79
    v_pk_mul_f32 v[80:81], v[78:79], v[46:47] op_sel_hi:[1,0]
    v_pk_fma_f32 v[80:81], v[78:79], v[46:47], v[80:81] op_sel:[1,1,0] op_sel_hi:[0,1,1] neg_lo:[1,0,0]
    v_cvt_pk_bf16_f32 v63, v80, -v81
    v_pk_mul_f32 v[82:83], v[80:81], v[46:47] op_sel_hi:[1,0]
    v_pk_fma_f32 v[82:83], v[80:81], v[46:47], v[82:83] op_sel:[1,1,0] op_sel_hi:[0,1,1] neg_lo:[1,0,0]
    v_cvt_pk_bf16_f32 v64, v82, -v83
    v_pk_mul_f32 v[84:85], v[82:83], v[46:47] op_sel_hi:[1,0]
    v_pk_fma_f32 v[84:85], v[82:83], v[46:47], v[84:85] op_sel:[1,1,0] op_sel_hi:[0,1,1] neg_lo:[1,0,0]
    v_cvt_pk_bf16_f32 v65, v84, -v85
    v_pk_mul_f32 v[86:87], v[84:85], v[46:47] op_sel_hi:[1,0]
    v_pk_fma_f32 v[86:87], v[84:85], v[46:47], v[86:87] op_sel:[1,1,0] op_sel_hi:[0,1,1] neg_lo:[1,0,0]
    v_cvt_pk_bf16_f32 v66, v86, -v87
    v_pk_mul_f32 v[88:89], v[86:87], v[46:47] op_sel_hi:[1,0]
    v_pk_fma_f32 v[88:89], v[86:87], v[46:47], v[88:89] op_sel:[1,1,0] op_sel_hi:[0,1,1] neg_lo:[1,0,0]
    v_cvt_pk_bf16_f32 v67, v88, -v89
    ds_write_addtid_b32 v60 offset:0
    ds_write_addtid_b32 v61 offset:272
    ds_write_addtid_b32 v62 offset:544
    ds_write_addtid_b32 v63 offset:816
    ds_write_addtid_b32 v64 offset:1088
    ds_write_addtid_b32 v65 offset:1360
    ds_write_addtid_b32 v66 offset:1632
    ds_write_addtid_b32 v67 offset:1904
    v_pk_mul_f32 v[76:77], v[74:75], v[72:73] op_sel_hi:[1,0]
    v_pk_fma_f32 v[76:77], v[74:75], v[72:73], v[76:77] op_sel:[1,1,0] op_sel_hi:[0,1,1] neg_lo:[1,0,0]
    v_cvt_pk_bf16_f32 v60, v76, -v77
    v_pk_mul_f32 v[80:81], v[78:79], v[72:73] op_sel_hi:[1,0]
    v_pk_fma_f32 v[80:81], v[78:79], v[72:73], v[80:81] op_sel:[1,1,0] op_sel_hi:[0,1,1] neg_lo:[1,0,0]
    v_cvt_pk_bf16_f32 v61, v80, -v81
    v_pk_mul_f32 v[84:85], v[82:83], v[72:73] op_sel_hi:[1,0]
    v_pk_fma_f32 v[84:85], v[82:83], v[72:73], v[84:85] op_sel:[1,1,0] op_sel_hi:[0,1,1] neg_lo:[1,0,0]
    v_cvt_pk_bf16_f32 v62, v84, -v85
    v_pk_mul_f32 v[88:89], v[86:87], v[72:73] op_sel_hi:[1,0]
    v_pk_fma_f32 v[88:89], v[86:87], v[72:73], v[88:89] op_sel:[1,1,0] op_sel_hi:[0,1,1] neg_lo:[1,0,0]
    v_cvt_pk_bf16_f32 v63, v88, -v89
    v_pk_mul_f32 v[74:75], v[76:77], v[72:73] op_sel_hi:[1,0]
    v_pk_fma_f32 v[74:75], v[76:77], v[72:73], v[74:75] op_sel:[1,1,0] op_sel_hi:[0,1,1] neg_lo:[1,0,0]
    v_cvt_pk_bf16_f32 v64, v74, -v75
    v_pk_mul_f32 v[78:79], v[84:85], v[72:73] op_sel_hi:[1,0]
    v_pk_fma_f32 v[78:79], v[84:85], v[72:73], v[78:79] op_sel:[1,1,0] op_sel_hi:[0,1,1] neg_lo:[1,0,0]
    v_cvt_pk_bf16_f32 v65, v78, -v79
    v_pk_mul_f32 v[80:81], v[74:75], v[72:73] op_sel_hi:[1,0]
    v_pk_fma_f32 v[80:81], v[74:75], v[72:73], v[80:81] op_sel:[1,1,0] op_sel_hi:[0,1,1] neg_lo:[1,0,0]
    v_cvt_pk_bf16_f32 v66, v80, -v81
    v_pk_mul_f32 v[82:83], v[78:79], v[72:73] op_sel_hi:[1,0]
    v_pk_fma_f32 v[82:83], v[78:79], v[72:73], v[82:83] op_sel:[1,1,0] op_sel_hi:[0,1,1] neg_lo:[1,0,0]
    v_cvt_pk_bf16_f32 v67, v82, -v83
    ds_write_addtid_b32 v60 offset:2176
    ds_write_addtid_b32 v61 offset:2448
    ds_write_addtid_b32 v62 offset:2720
    ds_write_addtid_b32 v63 offset:2992
    ds_write_addtid_b32 v64 offset:3264
    ds_write_addtid_b32 v65 offset:3536
    ds_write_addtid_b32 v66 offset:3808
    ds_write_addtid_b32 v67 offset:4080
    v_pk_mul_f32 v[86:87], v[76:77], v[48:49] op_sel_hi:[1,0]
    v_pk_fma_f32 v[86:87], v[76:77], v[48:49], v[86:87] op_sel:[1,1,0] op_sel_hi:[0,1,1] neg_lo:[1,0,0]
    v_cvt_pk_bf16_f32 v60, v86, -v87
    v_pk_mul_f32 v[88:89], v[80:81], v[72:73] op_sel_hi:[1,0]
    v_pk_fma_f32 v[88:89], v[80:81], v[72:73], v[88:89] op_sel:[1,1,0] op_sel_hi:[0,1,1] neg_lo:[1,0,0]
    v_cvt_pk_bf16_f32 v61, v88, -v89
    v_pk_mul_f32 v[84:85], v[88:89], v[72:73] op_sel_hi:[1,0]
    v_pk_fma_f32 v[84:85], v[88:89], v[72:73], v[84:85] op_sel:[1,1,0] op_sel_hi:[0,1,1] neg_lo:[1,0,0]
    v_cvt_pk_bf16_f32 v62, v84, -v85
    v_pk_mul_f32 v[78:79], v[84:85], v[72:73] op_sel_hi:[1,0]
    v_pk_fma_f32 v[78:79], v[84:85], v[72:73], v[78:79] op_sel:[1,1,0] op_sel_hi:[0,1,1] neg_lo:[1,0,0]
    v_cvt_pk_bf16_f32 v63, v78, -v79
    v_pk_mul_f32 v[82:83], v[74:75], v[48:49] op_sel_hi:[1,0]
    v_pk_fma_f32 v[82:83], v[74:75], v[48:49], v[82:83] op_sel:[1,1,0] op_sel_hi:[0,1,1] neg_lo:[1,0,0]
    v_cvt_pk_bf16_f32 v64, v82, -v83
    v_pk_mul_f32 v[76:77], v[78:79], v[72:73] op_sel_hi:[1,0]
    v_pk_fma_f32 v[76:77], v[78:79], v[72:73], v[76:77] op_sel:[1,1,0] op_sel_hi:[0,1,1] neg_lo:[1,0,0]
    v_cvt_pk_bf16_f32 v65, v76, -v77
    v_pk_mul_f32 v[86:87], v[76:77], v[72:73] op_sel_hi:[1,0]
    v_pk_fma_f32 v[86:87], v[76:77], v[72:73], v[86:87] op_sel:[1,1,0] op_sel_hi:[0,1,1] neg_lo:[1,0,0]
    v_cvt_pk_bf16_f32 v66, v86, -v87
    v_pk_mul_f32 v[88:89], v[80:81], v[48:49] op_sel_hi:[1,0]
    v_pk_fma_f32 v[88:89], v[80:81], v[48:49], v[88:89] op_sel:[1,1,0] op_sel_hi:[0,1,1] neg_lo:[1,0,0]
    v_cvt_pk_bf16_f32 v67, v88, -v89
    ds_write_addtid_b32 v60 offset:4352
    ds_write_addtid_b32 v61 offset:4624
    ds_write_addtid_b32 v62 offset:4896
    ds_write_addtid_b32 v63 offset:5168
    ds_write_addtid_b32 v64 offset:5440
    ds_write_addtid_b32 v65 offset:5712
    ds_write_addtid_b32 v66 offset:5984
    ds_write_addtid_b32 v67 offset:6256
    ds_read_b128 a[32:35], v100 offset:0
    ds_read_b128 a[36:39], v100 offset:32
    ds_read_b128 a[40:43], v100 offset:64
    ds_read_b128 a[44:47], v100 offset:96
    ds_read_b128 a[48:51], v100 offset:128
    ds_read_b128 a[52:55], v100 offset:160
    ds_read_b128 a[56:59], v100 offset:192
    ds_read_b128 a[60:63], v100 offset:224
    s_mov_b64 exec, 1
    ds_add_u32 v5, v4 offset:8
    s_mov_b64 exec, -1
    v_cmp_eq_u32 vcc, 0, v1
    s_waitcnt vmcnt(8)
    v_lshlrev_b32 v131, 16, v131
    s_waitcnt vmcnt(7)
    v_lshlrev_b32 v132, 16, v132
    v_cndmask_b32 v131, 0, v131, vcc
    v_mov_b32 v133, v132
    v_mov_b32 v134, v132
    v_mov_b32 v135, v132
    v_mov_b32 v40, 0
    v_mov_b32 v41, 0
    v_mov_b32 v42, 0
    v_mov_b32 v43, 0
    ds_write_b128 v108, v[40:43]
    s_waitcnt lgkmcnt(9)
    v_mfma_f32_32x32x16_bf16 v[112:127], a[32:35], a[0:3], v[112:127]
    s_waitcnt lgkmcnt(8)
    v_mfma_f32_32x32x16_bf16 v[112:127], a[36:39], a[4:7], v[112:127]
    s_waitcnt lgkmcnt(1)
    v_mfma_f32_32x32x16_bf16 v[112:127], a[40:43], a[8:11], v[112:127]
    v_mfma_f32_32x32x16_bf16 v[112:127], a[44:47], a[12:15], v[112:127]
    v_mfma_f32_32x32x16_bf16 v[112:127], a[48:51], a[16:19], v[112:127]
    v_mfma_f32_32x32x16_bf16 v[112:127], a[52:55], a[20:23], v[112:127]
    v_mfma_f32_32x32x16_bf16 v[112:127], a[56:59], a[24:27], v[112:127]
    v_mfma_f32_32x32x16_bf16 v[112:127], a[60:63], a[28:31], v[112:127]
    s_nop 11
    v_add_f32 v112, v112, v131
    v_cvt_pk_bf16_f32 v44, v115, v114
    v_cvt_pk_bf16_f32 v45, v113, v112
    v_cvt_pk_bf16_f32 v51, v116, v116
    v_cvt_pk_bf16_f32 v48, v120, v119
    v_cvt_pk_bf16_f32 v49, v118, v118
    v_cvt_pk_bf16_f32 v50, v118, v117
    s_mov_b32 exec_lo, 0
    v_mov_b32 v48, 0
    v_mov_b32 v49, 0
    v_cvt_pk_bf16_f32 v50, 0, v116
    s_mov_b32 exec_lo, -1
    ds_write_b64 v101, v[44:45]
    s_mov_b32 exec_hi, 1
    ds_write_b128 v102, v[48:51]
    s_mov_b32 exec_hi, -1
    ds_read2_b32 v[56:57], v105 offset0:0 offset1:1
    ds_read2_b32 v[58:59], v105 offset0:2 offset1:3
    ds_read_b32 v60, v105 offset:16
    ds_read2_b32 v[62:63], v105 offset0:72 offset1:73
    ds_read2_b32 v[64:65], v105 offset0:74 offset1:75
    ds_read_b32 v66, v105 offset:304
    ds_read2_b32 v[68:69], v105 offset0:144 offset1:145
    ds_read2_b32 v[70:71], v105 offset0:146 offset1:147
    ds_read_b32 v72, v105 offset:592
    ds_read2_b32 v[74:75], v105 offset0:216 offset1:217
    ds_read2_b32 v[76:77], v105 offset0:218 offset1:219
    ds_read_b32 v78, v105 offset:880
    v_cvt_pk_bf16_f32 v52, v117, v120
    v_cvt_pk_bf16_f32 v53, v119, v123
    v_cvt_pk_bf16_f32 v54, v121, v121
    v_cvt_pk_bf16_f32 v55, v122, v123
    v_readfirstlane_b32 s12, v54
    s_mov_b32 exec_lo, 0
    ds_write2_b32 v103, v52, v53 offset0:0 offset1:32
    s_mov_b32 exec_lo, -2
    ds_write_b16 v104, v54
    s_mov_b32 exec_lo, -1
    s_mov_b32 exec_hi, 1
    ds_write_b16 v104, v55 offset:64
    s_mov_b32 exec_hi, 0
    ds_write_b16_d16_hi v104, v55 offset:128
    s_mov_b32 exec_hi, -1
    s_waitcnt vmcnt(0)
    v_and_b32 v16, s12, v16
    v_and_b32 v17, s12, v17
    v_and_b32 v18, s12, v18
    v_and_b32_e64 v19, s12, v19
    s_waitcnt lgkmcnt(14)
    v_alignbit_b32 v80, v57, v56, v107
    v_alignbit_b32 v81, v58, v57, v107
L_SC_hop2:
    s_cbranch_execz L_SC_ret
    s_nop 0
    v_alignbit_b32 v82, v59, v58, v107
    s_waitcnt lgkmcnt(11)
    v_alignbit_b32 v83, v60, v59, v107
    ds_write_b128 v106, v[80:83] offset:0
    v_alignbit_b32 v84, v63, v62, v107
    v_alignbit_b32 v85, v64, v63, v107
    v_alignbit_b32 v86, v65, v64, v107
    s_waitcnt lgkmcnt(7)
    v_alignbit_b32 v87, v66, v65, v107
    ds_write_b128 v106, v[84:87] offset:288
    v_alignbit_b32 v88, v69, v68, v107
    v_alignbit_b32 v89, v70, v69, v107
    v_alignbit_b32 v90, v71, v70, v107
    v_alignbit_b32 v91, v72, v71, v107
    ds_write_b128 v106, v[88:91] offset:576
    v_alignbit_b32 v92, v75, v74, v107
    s_waitcnt lgkmcnt(7)
    s_nop 0
    v_alignbit_b32 v93, v76, v75, v107
    v_alignbit_b32 v94, v77, v76, v107
    v_alignbit_b32 v95, v78, v77, v107
    ds_write_b128 v106, v[92:95] offset:864
    ds_read2_b32 a[56:57], v109 offset0:6 offset1:4
    ds_read2_b32 a[58:59], v109 offset0:2 offset1:0
    ds_read2_b32 a[60:61], v109 offset0:38 offset1:36
    ds_read2_b32 a[62:63], v109 offset0:34 offset1:32
    ds_read2_b32 a[64:65], v109 offset0:70 offset1:68
    ds_read2_b32 a[66:67], v109 offset0:66 offset1:64
    ds_read2_b32 a[68:69], v109 offset0:7 offset1:5
    ds_read2_b32 a[70:71], v109 offset0:3 offset1:1
    ds_read2_b32 a[72:73], v109 offset0:39 offset1:37
    ds_read2_b32 a[74:75], v109 offset0:35 offset1:33
    ds_read2_b32 a[76:77], v109 offset0:71 offset1:69
    ds_read2_b32 a[78:79], v109 offset0:67 offset1:65
    ds_read2_b32 a[80:81], v110 offset0:3 offset1:2
    ds_read2_b32 a[82:83], v110 offset0:1 offset1:0
    ds_read2_b32 a[84:85], v110 offset0:19 offset1:18
    ds_read2_b32 a[86:87], v110 offset0:17 offset1:16
    ds_read2_b32 a[88:89], v110 offset0:35 offset1:34
    ds_read2_b32 a[90:91], v110 offset0:33 offset1:32
    ds_read2_b32 a[92:93], v110 offset0:51 offset1:50
    ds_read2_b32 a[94:95], v110 offset0:49 offset1:48
    ds_read_b64 v[20:21], v15 offset:1024
    ds_read_b64 v[22:23], v15 offset:1032
    ds_read_b64 v[24:25], v15 offset:512
    ds_read_b64 v[26:27], v15 offset:520
    ds_read_b64 v[28:29], v15 offset:0
    ds_read_b64 v[30:31], v15 offset:8
    ds_read_b64 v[96:97], v15 offset:960
    ds_read_b64 v[98:99], v15 offset:968
    ds_read_b32 v6, v5 offset:12
    s_waitcnt lgkmcnt(0)
    v_cmp_gt_u32_e64 vcc, 4, v6
    s_cbranch_vccnz L_SC_p1_spin
L_SC_p1_ok:
    ds_read_b128 v[80:83], v32 offset:448
    ds_read_b128 v[84:87], v32 offset:432
    ds_read_b128 v[88:91], v32 offset:960
    ds_read_b128 v[92:95], v32 offset:944
    s_setprio 1
    s_waitcnt lgkmcnt(3)
    v_mfma_f32_16x16x32_bf16 v[36:39], v[80:83], a[96:99], 0
    v_mfma_f32_16x16x32_bf16 v[40:43], v[80:83], a[100:103], 0
    s_waitcnt lgkmcnt(2)
    v_mfma_f32_16x16x32_bf16 v[44:47], v[84:87], a[104:107], 0
    v_mfma_f32_16x16x32_bf16 v[48:51], v[84:87], a[108:111], 0
    v_mfma_f32_16x16x32_bf16 v[52:55], v[80:83], a[112:115], 0
    s_nop 3
    v_cvt_pk_bf16_f32 v60, v36, v40
    v_cvt_pk_bf16_f32 v61, v37, v41
    v_mfma_f32_16x16x32_bf16 v[56:59], v[84:87], a[116:119], 0
    v_cvt_pk_bf16_f32 v62, v38, v42
    v_cvt_pk_bf16_f32 v63, v39, v43
    v_mfma_f32_16x16x32_bf16 v[100:103], v[20:23], v[80:83], v[132:135]
    v_cvt_pk_bf16_f32 v64, v44, v48
    v_cvt_pk_bf16_f32 v65, v45, v49
    v_mfma_f32_16x16x32_bf16 v[104:107], v[24:27], v[80:83], v[132:135]
    v_cvt_pk_bf16_f32 v66, v46, v50
    v_cvt_pk_bf16_f32 v67, v47, v51
    v_mfma_f32_16x16x32_bf16 v[108:111], v[28:31], v[80:83], v[132:135]
    v_cvt_pk_bf16_f32 v68, v52, v56
    v_cvt_pk_bf16_f32 v69, v53, v57
    v_mfma_f32_16x16x32_bf16 v[116:119], v[16:19], v[80:83], v[132:135]
    v_cvt_pk_bf16_f32 v70, v54, v58
    v_cvt_pk_bf16_f32 v71, v55, v59
    s_waitcnt lgkmcnt(0)
    v_mfma_f32_16x16x32_bf16 v[36:39], v[88:91], a[96:99], 0
    ds_read_b128 v[84:87], v32 offset:1472
    v_mfma_f32_16x16x32_bf16 v[40:43], v[88:91], a[100:103], 0
    ds_read_b128 v[80:83], v32 offset:1456
    v_mfma_f32_16x16x32_bf16 v[44:47], v[92:95], a[104:107], 0
    v_mfma_f32_16x16x32_bf16 v[48:51], v[92:95], a[108:111], 0
    v_mfma_f32_16x16x32_bf16 v[52:55], v[88:91], a[112:115], 0
    s_nop 3
    v_cvt_pk_bf16_f32 v72, v36, v40
    v_cvt_pk_bf16_f32 v73, v37, v41
    v_mfma_f32_16x16x32_bf16 v[56:59], v[92:95], a[116:119], 0
    v_cvt_pk_bf16_f32 v74, v38, v42
    v_cvt_pk_bf16_f32 v75, v39, v43
    v_mfma_f32_16x16x32_bf16 v[104:107], v[20:23], v[88:91], v[104:107]
    v_cvt_pk_bf16_f32 v76, v44, v48
    v_cvt_pk_bf16_f32 v77, v45, v49
    v_mfma_f32_16x16x32_bf16 v[108:111], v[24:27], v[88:91], v[108:111]
    v_cvt_pk_bf16_f32 v78, v46, v50
    v_cvt_pk_bf16_f32 v79, v47, v51
    v_mfma_f32_16x16x32_bf16 v[112:115], v[28:31], v[88:91], v[132:135]
    ds_read_b128 v[92:95], v32 offset:1984
    v_mfma_f32_16x16x32_bf16 v[120:123], v[16:19], v[88:91], v[132:135]
    ds_read_b128 v[88:91], v32 offset:1968
    v_mfma_f32_16x16x32_bf16 v[108:111], v[60:63], a[56:59], v[108:111]
    v_mfma_f32_16x16x32_bf16 v[112:115], v[60:63], a[60:63], v[112:115]
    v_mfma_f32_16x16x32_bf16 v[116:119], v[60:63], a[64:67], v[116:119]
    v_cvt_pk_bf16_f32 v60, v52, v56
    v_cvt_pk_bf16_f32 v61, v53, v57
    v_mfma_f32_16x16x32_bf16 v[108:111], v[64:67], a[68:71], v[108:111]
    v_cvt_pk_bf16_f32 v62, v54, v58
    v_cvt_pk_bf16_f32 v63, v55, v59
    v_mfma_f32_16x16x32_bf16 v[112:115], v[64:67], a[72:75], v[112:115]
    v_mfma_f32_16x16x32_bf16 v[116:119], v[64:67], a[76:79], v[116:119]
    v_mfma_f32_16x16x32_bf16 v[116:119], v[68:71], a[80:83], v[116:119]
    v_mfma_f32_16x16x32_bf16 v[120:123], v[68:71], a[84:87], v[120:123]
    v_mfma_f32_16x16x32_bf16 v[124:127], v[68:71], a[88:91], v[132:135]
    v_mfma_f32_16x16x32_bf16 v[128:131], v[68:71], a[92:95], v[132:135]
    s_waitcnt lgkmcnt(0)
    v_mfma_f32_16x16x32_bf16 v[36:39], v[84:87], a[96:99], 0
    v_mfma_f32_16x16x32_bf16 v[40:43], v[84:87], a[100:103], 0
    v_mfma_f32_16x16x32_bf16 v[44:47], v[80:83], a[104:107], 0
    v_mfma_f32_16x16x32_bf16 v[48:51], v[80:83], a[108:111], 0
    v_mfma_f32_16x16x32_bf16 v[52:55], v[84:87], a[112:115], 0
    s_nop 4
    v_cvt_pk_bf16_f32 v64, v36, v40
    v_cvt_pk_bf16_f32 v65, v37, v41
    v_mfma_f32_16x16x32_bf16 v[56:59], v[80:83], a[116:119], 0
    v_cvt_pk_bf16_f32 v66, v38, v42
    v_cvt_pk_bf16_f32 v67, v39, v43
    v_mfma_f32_16x16x32_bf16 v[108:111], v[20:23], v[84:87], v[108:111]
    v_cvt_pk_bf16_f32 v68, v44, v48
    v_cvt_pk_bf16_f32 v69, v45, v49
    v_mfma_f32_16x16x32_bf16 v[112:115], v[24:27], v[84:87], v[112:115]
    v_cvt_pk_bf16_f32 v70, v46, v50
    v_cvt_pk_bf16_f32 v71, v47, v51
    v_mfma_f32_16x16x32_bf16 v[116:119], v[28:31], v[84:87], v[116:119]
    ds_read_b128 v[80:83], v32 offset:2496
    v_mfma_f32_16x16x32_bf16 v[124:127], v[16:19], v[84:87], v[124:127]
    ds_read_b128 v[84:87], v32 offset:2480
    v_mfma_f32_16x16x32_bf16 v[112:115], v[72:75], a[56:59], v[112:115]
    s_add_u32 s79, s78, 204800
    buffer_load_dwordx4 a[0:3], v12, s[72:75], s79 offen
    v_mfma_f32_16x16x32_bf16 v[116:119], v[72:75], a[60:63], v[116:119]
    v_mfma_f32_16x16x32_bf16 v[120:123], v[72:75], a[64:67], v[120:123]
    v_cvt_pk_bf16_f32 v72, v52, v56
    v_cvt_pk_bf16_f32 v73, v53, v57
    v_mfma_f32_16x16x32_bf16 v[112:115], v[76:79], a[68:71], v[112:115]
    v_cvt_pk_bf16_f32 v74, v54, v58
    v_cvt_pk_bf16_f32 v75, v55, v59
    v_mfma_f32_16x16x32_bf16 v[116:119], v[76:79], a[72:75], v[116:119]
    v_mfma_f32_16x16x32_bf16 v[120:123], v[76:79], a[76:79], v[120:123]
    v_mfma_f32_16x16x32_bf16 v[120:123], v[60:63], a[80:83], v[120:123]
    v_mfma_f32_16x16x32_bf16 v[124:127], v[60:63], a[84:87], v[124:127]
    v_mfma_f32_16x16x32_bf16 v[128:131], v[60:63], a[88:91], v[128:131]
    s_add_u32 s79, s78, 532480
    buffer_load_dwordx4 a[4:7], v12, s[72:75], s79 offen
    v_mfma_f32_16x16x32_bf16 v[36:39], v[92:95], a[96:99], 0
    v_mfma_f32_16x16x32_bf16 v[40:43], v[92:95], a[100:103], 0
    v_mfma_f32_16x16x32_bf16 v[44:47], v[88:91], a[104:107], 0
    v_mfma_f32_16x16x32_bf16 v[48:51], v[88:91], a[108:111], 0
    v_mfma_f32_16x16x32_bf16 v[52:55], v[92:95], a[112:115], 0
    s_nop 4
    v_cvt_pk_bf16_f32 v76, v36, v40
    v_cvt_pk_bf16_f32 v77, v37, v41
    v_mfma_f32_16x16x32_bf16 v[56:59], v[88:91], a[116:119], 0
    v_cvt_pk_bf16_f32 v78, v38, v42
    v_cvt_pk_bf16_f32 v79, v39, v43
    v_mfma_f32_16x16x32_bf16 v[112:115], v[20:23], v[92:95], v[112:115]
    v_cvt_pk_bf16_f32 v60, v44, v48
    v_cvt_pk_bf16_f32 v61, v45, v49
    v_mfma_f32_16x16x32_bf16 v[116:119], v[24:27], v[92:95], v[116:119]
    s_add_u32 s79, s78, 860160
    buffer_load_dwordx4 a[8:11], v12, s[72:75], s79 offen
    v_mfma_f32_16x16x32_bf16 v[120:123], v[28:31], v[92:95], v[120:123]
    v_cvt_pk_bf16_f32 v62, v46, v50
    v_cvt_pk_bf16_f32 v63, v47, v51
    v_mfma_f32_16x16x32_bf16 v[128:131], v[16:19], v[92:95], v[128:131]
    ds_read_b128 v[88:91], v32 offset:3008
    v_mfma_f32_16x16x32_bf16 v[116:119], v[64:67], a[56:59], v[116:119]
    ds_read_b128 v[92:95], v32 offset:2992
    v_mfma_f32_16x16x32_bf16 v[120:123], v[64:67], a[60:63], v[120:123]
    ds_read_b64 v[16:17], v15 offset:448
    ds_read_b64 v[18:19], v15 offset:456
    v_mfma_f32_16x16x32_bf16 v[124:127], v[64:67], a[64:67], v[124:127]
    v_cvt_pk_bf16_f32 v64, v52, v56
    v_cvt_pk_bf16_f32 v65, v53, v57
    v_mfma_f32_16x16x32_bf16 v[116:119], v[68:71], a[68:71], v[116:119]
    v_cvt_pk_bf16_f32 v66, v54, v58
    v_cvt_pk_bf16_f32 v67, v55, v59
    v_mfma_f32_16x16x32_bf16 v[120:123], v[68:71], a[72:75], v[120:123]
    v_mfma_f32_16x16x32_bf16 v[124:127], v[68:71], a[76:79], v[124:127]
    s_add_u32 s79, s78, 1187840
    buffer_load_dwordx4 a[12:15], v12, s[72:75], s79 offen
    v_mfma_f32_16x16x32_bf16 v[124:127], v[72:75], a[80:83], v[124:127]
    v_mfma_f32_16x16x32_bf16 v[128:131], v[72:75], a[84:87], v[128:131]
    s_waitcnt lgkmcnt(2)
    v_mfma_f32_16x16x32_bf16 v[36:39], v[80:83], a[96:99], 0
    v_mfma_f32_16x16x32_bf16 v[40:43], v[80:83], a[100:103], 0
    v_mfma_f32_16x16x32_bf16 v[44:47], v[84:87], a[104:107], 0
    v_mfma_f32_16x16x32_bf16 v[48:51], v[84:87], a[108:111], 0
    ds_read_b128 v[84:87], v32 offset:3520
    v_mfma_f32_16x16x32_bf16 v[116:119], v[20:23], v[80:83], v[116:119]
    s_nop 3
    v_cvt_pk_bf16_f32 v68, v36, v40
    v_cvt_pk_bf16_f32 v69, v37, v41
    v_mfma_f32_16x16x32_bf16 v[120:123], v[24:27], v[80:83], v[120:123]
    s_add_u32 s79, s78, 1515520
    buffer_load_dwordx4 a[16:19], v12, s[72:75], s79 offen
    v_mfma_f32_16x16x32_bf16 v[124:127], v[28:31], v[80:83], v[124:127]
    v_cvt_pk_bf16_f32 v70, v38, v42
    v_cvt_pk_bf16_f32 v71, v39, v43
    v_mfma_f32_16x16x32_bf16 v[120:123], v[76:79], a[56:59], v[120:123]
    v_cvt_pk_bf16_f32 v72, v44, v48
    v_cvt_pk_bf16_f32 v73, v45, v49
    v_mfma_f32_16x16x32_bf16 v[124:127], v[76:79], a[60:63], v[124:127]
    v_cvt_pk_bf16_f32 v74, v46, v50
    v_cvt_pk_bf16_f32 v75, v47, v51
    v_mfma_f32_16x16x32_bf16 v[128:131], v[76:79], a[64:67], v[128:131]
    ds_read_b128 v[80:83], v32 offset:4032
    v_mfma_f32_16x16x32_bf16 v[120:123], v[60:63], a[68:71], v[120:123]
    v_mfma_f32_16x16x32_bf16 v[124:127], v[60:63], a[72:75], v[124:127]
    v_mfma_f32_16x16x32_bf16 v[128:131], v[60:63], a[76:79], v[128:131]
    v_mfma_f32_16x16x32_bf16 v[128:131], v[64:67], a[80:83], v[128:131]
    s_add_u32 s79, s78, 1843200
    buffer_load_dwordx4 a[20:23], v12, s[72:75], s79 offen
    v_mfma_f32_16x16x32_bf16 v[36:39], v[88:91], a[96:99], 0
    ds_read_b128 v[64:67], v32 offset:3968
    v_mfma_f32_16x16x32_bf16 v[40:43], v[88:91], a[100:103], 0
    ds_read_b128 v[52:55], v32 offset:3456
    v_mfma_f32_16x16x32_bf16 v[44:47], v[92:95], a[104:107], 0
    ds_read_b128 v[56:59], v32 offset:2944
    v_mfma_f32_16x16x32_bf16 v[48:51], v[92:95], a[108:111], 0
    ds_read_b128 v[92:95], v32 offset:2432
    v_mfma_f32_16x16x32_bf16 v[120:123], v[20:23], v[88:91], v[120:123]
    s_nop 1
    v_cvt_pk_bf16_f32 v76, v36, v40
    v_cvt_pk_bf16_f32 v77, v37, v41
    v_mfma_f32_16x16x32_bf16 v[124:127], v[24:27], v[88:91], v[124:127]
    v_cvt_pk_bf16_f32 v78, v38, v42
    v_cvt_pk_bf16_f32 v79, v39, v43
    v_mfma_f32_16x16x32_bf16 v[128:131], v[28:31], v[88:91], v[128:131]
    v_cvt_pk_bf16_f32 v60, v44, v48
    v_cvt_pk_bf16_f32 v61, v45, v49
    v_mfma_f32_16x16x32_bf16 v[124:127], v[68:71], a[56:59], v[124:127]
    s_add_u32 s79, s78, 245760
    buffer_load_dwordx4 a[24:27], v12, s[72:75], s79 offen
    v_mfma_f32_16x16x32_bf16 v[128:131], v[68:71], a[60:63], v[128:131]
    v_cvt_pk_bf16_f32 v62, v46, v50
    v_cvt_pk_bf16_f32 v63, v47, v51
    v_mfma_f32_16x16x32_bf16 v[124:127], v[72:75], a[68:71], v[124:127]
    ds_read_b128 v[88:91], v32 offset:1920
    v_mfma_f32_16x16x32_bf16 v[128:131], v[72:75], a[72:75], v[128:131]
    ds_read_b128 v[68:71], v32 offset:1408
    s_waitcnt lgkmcnt(2)
    v_mfma_f32_16x16x32_bf16 v[124:127], v[20:23], v[84:87], v[124:127]
    ds_read_b128 v[72:75], v32 offset:896
    v_mfma_f32_16x16x32_bf16 v[128:131], v[24:27], v[84:87], v[128:131]
    ds_read_b128 v[84:87], v32 offset:384
    v_mfma_f32_16x16x32_bf16 v[128:131], v[76:79], a[56:59], v[128:131]
    ds_read_b64 v[28:29], v15 offset:896
    ds_read_b64 v[30:31], v15 offset:904
    v_mfma_f32_16x16x32_bf16 v[128:131], v[60:63], a[68:71], v[128:131]
    ds_read_b128 v[76:79], v32 offset:3904
    v_mfma_f32_16x16x32_bf16 v[128:131], v[20:23], v[80:83], v[128:131]
    s_add_u32 s79, s78, 573440
    buffer_load_dwordx4 a[28:31], v12, s[72:75], s79 offen
    v_mfma_f32_16x16x32_bf16 v[128:131], v[96:99], v[64:67], v[128:131]
    ds_read_b128 v[36:39], v32 offset:3392
    v_mfma_f32_16x16x32_bf16 v[124:127], v[96:99], v[52:55], v[124:127]
    ds_read_b64 v[24:25], v15 offset:384
    ds_read_b64 v[26:27], v15 offset:392
    v_mfma_f32_16x16x32_bf16 v[128:131], v[16:19], v[52:55], v[128:131]
    ds_read_b128 v[40:43], v32 offset:2880
    v_mfma_f32_16x16x32_bf16 v[120:123], v[96:99], v[56:59], v[120:123]
    ds_read_b128 v[60:63], v32 offset:2368
    v_mfma_f32_16x16x32_bf16 v[124:127], v[16:19], v[56:59], v[124:127]
    ds_read_b128 v[44:47], v32 offset:1856
    v_mfma_f32_16x16x32_bf16 v[116:119], v[96:99], v[92:95], v[116:119]
    ds_read_b128 v[48:51], v32 offset:1344
    v_mfma_f32_16x16x32_bf16 v[120:123], v[16:19], v[92:95], v[120:123]
    ds_read_b128 v[80:83], v32 offset:832
    s_waitcnt lgkmcnt(8)
    v_mfma_f32_16x16x32_bf16 v[112:115], v[96:99], v[88:91], v[112:115]
    s_add_u32 s79, s78, 901120
    buffer_load_dwordx4 a[32:35], v12, s[72:75], s79 offen
    v_mfma_f32_16x16x32_bf16 v[116:119], v[16:19], v[88:91], v[116:119]
    ds_read_b128 v[64:67], v32 offset:320
    v_mfma_f32_16x16x32_bf16 v[108:111], v[96:99], v[68:71], v[108:111]
    ds_read_b64 v[20:21], v15 offset:832
    ds_read_b64 v[22:23], v15 offset:840
    v_mfma_f32_16x16x32_bf16 v[112:115], v[16:19], v[68:71], v[112:115]
    ds_read_b128 v[52:55], v32 offset:3840
    v_mfma_f32_16x16x32_bf16 v[104:107], v[96:99], v[72:75], v[104:107]
    ds_read_b128 v[56:59], v32 offset:3328
    v_mfma_f32_16x16x32_bf16 v[108:111], v[16:19], v[72:75], v[108:111]
    ds_read_b128 v[92:95], v32 offset:2816
    v_mfma_f32_16x16x32_bf16 v[100:103], v[96:99], v[84:87], v[100:103]
    ds_read_b64 v[96:97], v15 offset:320
    ds_read_b64 v[98:99], v15 offset:328
    v_mfma_f32_16x16x32_bf16 v[104:107], v[16:19], v[84:87], v[104:107]
    ds_read_b128 v[88:91], v32 offset:2304
    v_mfma_f32_16x16x32_bf16 v[128:131], v[28:31], v[76:79], v[128:131]
    s_add_u32 s79, s78, 1228800
    buffer_load_dwordx4 a[36:39], v12, s[72:75], s79 offen
    s_waitcnt lgkmcnt(8)
    v_mfma_f32_16x16x32_bf16 v[124:127], v[28:31], v[36:39], v[124:127]
    ds_read_b128 v[68:71], v32 offset:1792
    v_mfma_f32_16x16x32_bf16 v[128:131], v[24:27], v[36:39], v[128:131]
    ds_read_b128 v[72:75], v32 offset:1280
    v_mfma_f32_16x16x32_bf16 v[120:123], v[28:31], v[40:43], v[120:123]
    ds_read_b128 v[84:87], v32 offset:768
    v_mfma_f32_16x16x32_bf16 v[124:127], v[24:27], v[40:43], v[124:127]
    ds_read_b128 v[76:79], v32 offset:256
    v_mfma_f32_16x16x32_bf16 v[116:119], v[28:31], v[60:63], v[116:119]
    ds_read_b64 v[16:17], v15 offset:768
    ds_read_b64 v[18:19], v15 offset:776
    v_mfma_f32_16x16x32_bf16 v[120:123], v[24:27], v[60:63], v[120:123]
    ds_read_b128 v[36:39], v32 offset:3776
    v_mfma_f32_16x16x32_bf16 v[112:115], v[28:31], v[44:47], v[112:115]
    ds_read_b128 v[40:43], v32 offset:3264
    v_mfma_f32_16x16x32_bf16 v[116:119], v[24:27], v[44:47], v[116:119]
    s_add_u32 s79, s78, 1556480
    buffer_load_dwordx4 a[40:43], v12, s[72:75], s79 offen
    v_mfma_f32_16x16x32_bf16 v[108:111], v[28:31], v[48:51], v[108:111]
    ds_read_b128 v[60:63], v32 offset:2752
    v_mfma_f32_16x16x32_bf16 v[112:115], v[24:27], v[48:51], v[112:115]
    ds_read_b128 v[44:47], v32 offset:2240
    v_mfma_f32_16x16x32_bf16 v[104:107], v[28:31], v[80:83], v[104:107]
    ds_read_b128 v[48:51], v32 offset:1728
    v_mfma_f32_16x16x32_bf16 v[108:111], v[24:27], v[80:83], v[108:111]
    ds_read_b128 v[80:83], v32 offset:1216
    v_mfma_f32_16x16x32_bf16 v[100:103], v[28:31], v[64:67], v[100:103]
    ds_read_b64 v[28:29], v15 offset:256
    ds_read_b64 v[30:31], v15 offset:264
    v_mfma_f32_16x16x32_bf16 v[104:107], v[24:27], v[64:67], v[104:107]
    ds_read_b128 v[64:67], v32 offset:704
    s_waitcnt lgkmcnt(7)
    v_mfma_f32_16x16x32_bf16 v[128:131], v[20:23], v[52:55], v[128:131]
    ds_read_b128 v[52:55], v32 offset:192
    v_mfma_f32_16x16x32_bf16 v[124:127], v[20:23], v[56:59], v[124:127]
    s_add_u32 s79, s78, 1884160
    buffer_load_dwordx4 a[44:47], v12, s[72:75], s79 offen
    v_mfma_f32_16x16x32_bf16 v[128:131], v[96:99], v[56:59], v[128:131]
    ds_read_b64 v[24:25], v15 offset:704
    ds_read_b64 v[26:27], v15 offset:712
    v_mfma_f32_16x16x32_bf16 v[120:123], v[20:23], v[92:95], v[120:123]
    ds_read_b128 v[56:59], v32 offset:3712
    v_mfma_f32_16x16x32_bf16 v[124:127], v[96:99], v[92:95], v[124:127]
    ds_read_b128 v[92:95], v32 offset:3200
    v_mfma_f32_16x16x32_bf16 v[116:119], v[20:23], v[88:91], v[116:119]
    v_mfma_f32_16x16x32_bf16 v[120:123], v[96:99], v[88:91], v[120:123]
    ds_read_b128 v[88:91], v32 offset:2688
    v_mfma_f32_16x16x32_bf16 v[112:115], v[20:23], v[68:71], v[112:115]
    v_mfma_f32_16x16x32_bf16 v[116:119], v[96:99], v[68:71], v[116:119]
    ds_read_b128 v[68:71], v32 offset:2176
    v_mfma_f32_16x16x32_bf16 v[108:111], v[20:23], v[72:75], v[108:111]
    s_add_u32 s79, s78, 286720
    buffer_load_dwordx4 a[48:51], v12, s[72:75], s79 offen
    v_mfma_f32_16x16x32_bf16 v[112:115], v[96:99], v[72:75], v[112:115]
    ds_read_b128 v[72:75], v32 offset:1664
    v_mfma_f32_16x16x32_bf16 v[104:107], v[20:23], v[84:87], v[104:107]
    v_mfma_f32_16x16x32_bf16 v[108:111], v[96:99], v[84:87], v[108:111]
    ds_read_b128 v[84:87], v32 offset:1152
    v_mfma_f32_16x16x32_bf16 v[100:103], v[20:23], v[76:79], v[100:103]
    ds_read_b64 v[20:21], v15 offset:192
    ds_read_b64 v[22:23], v15 offset:200
    v_mfma_f32_16x16x32_bf16 v[104:107], v[96:99], v[76:79], v[104:107]
    ds_read_b128 v[76:79], v32 offset:640
    v_mfma_f32_16x16x32_bf16 v[128:131], v[16:19], v[36:39], v[128:131]
    ds_read_b128 v[36:39], v32 offset:128
    v_mfma_f32_16x16x32_bf16 v[124:127], v[16:19], v[40:43], v[124:127]
    ds_read_b64 v[96:97], v15 offset:640
    ds_read_b64 v[98:99], v15 offset:648
    s_waitcnt lgkmcnt(8)
    v_mfma_f32_16x16x32_bf16 v[128:131], v[28:31], v[40:43], v[128:131]
    s_add_u32 s79, s78, 614400
    buffer_load_dwordx4 a[52:55], v12, s[72:75], s79 offen
    v_mfma_f32_16x16x32_bf16 v[120:123], v[16:19], v[60:63], v[120:123]
    ds_read_b128 v[40:43], v32 offset:3648
    v_mfma_f32_16x16x32_bf16 v[124:127], v[28:31], v[60:63], v[124:127]
    ds_read_b128 v[60:63], v32 offset:3136
    v_mfma_f32_16x16x32_bf16 v[116:119], v[16:19], v[44:47], v[116:119]
    v_mfma_f32_16x16x32_bf16 v[120:123], v[28:31], v[44:47], v[120:123]
    ds_read_b128 v[44:47], v32 offset:2624
    v_mfma_f32_16x16x32_bf16 v[112:115], v[16:19], v[48:51], v[112:115]
    v_mfma_f32_16x16x32_bf16 v[116:119], v[28:31], v[48:51], v[116:119]
    ds_read_b128 v[48:51], v32 offset:2112
    v_mfma_f32_16x16x32_bf16 v[108:111], v[16:19], v[80:83], v[108:111]
    v_mfma_f32_16x16x32_bf16 v[112:115], v[28:31], v[80:83], v[112:115]
    s_add_u32 s79, s78, 942080
    buffer_load_dwordx4 a[56:59], v12, s[72:75], s79 offen
    v_mfma_f32_16x16x32_bf16 v[104:107], v[16:19], v[64:67], v[104:107]
    ds_read_b128 v[80:83], v32 offset:1600
    v_mfma_f32_16x16x32_bf16 v[108:111], v[28:31], v[64:67], v[108:111]
    ds_read_b128 v[64:67], v32 offset:1088
    v_mfma_f32_16x16x32_bf16 v[100:103], v[16:19], v[52:55], v[100:103]
    ds_read_b64 v[16:17], v15 offset:128
    ds_read_b64 v[18:19], v15 offset:136
    v_mfma_f32_16x16x32_bf16 v[104:107], v[28:31], v[52:55], v[104:107]
    ds_read_b128 v[52:55], v32 offset:576
    v_mfma_f32_16x16x32_bf16 v[128:131], v[24:27], v[56:59], v[128:131]
    ds_read_b128 v[56:59], v32 offset:64
    v_mfma_f32_16x16x32_bf16 v[124:127], v[24:27], v[92:95], v[124:127]
    ds_read_b64 v[28:29], v15 offset:576
    ds_read_b64 v[30:31], v15 offset:584
    s_waitcnt lgkmcnt(8)
    v_mfma_f32_16x16x32_bf16 v[128:131], v[20:23], v[92:95], v[128:131]
    ds_read_b128 v[92:95], v32 offset:3584
    v_mfma_f32_16x16x32_bf16 v[120:123], v[24:27], v[88:91], v[120:123]
    s_add_u32 s79, s78, 1269760
    buffer_load_dwordx4 a[60:63], v12, s[72:75], s79 offen
    v_mfma_f32_16x16x32_bf16 v[124:127], v[20:23], v[88:91], v[124:127]
    ds_read_b128 v[88:91], v32 offset:3072
    v_mfma_f32_16x16x32_bf16 v[116:119], v[24:27], v[68:71], v[116:119]
    v_mfma_f32_16x16x32_bf16 v[120:123], v[20:23], v[68:71], v[120:123]
    ds_read_b128 v[68:71], v32 offset:2560
    v_mfma_f32_16x16x32_bf16 v[112:115], v[24:27], v[72:75], v[112:115]
    v_mfma_f32_16x16x32_bf16 v[116:119], v[20:23], v[72:75], v[116:119]
    ds_read_b128 v[72:75], v32 offset:2048
    v_mfma_f32_16x16x32_bf16 v[108:111], v[24:27], v[84:87], v[108:111]
    v_mfma_f32_16x16x32_bf16 v[112:115], v[20:23], v[84:87], v[112:115]
    ds_read_b128 v[84:87], v32 offset:1536
    v_mfma_f32_16x16x32_bf16 v[104:107], v[24:27], v[76:79], v[104:107]
    s_add_u32 s79, s78, 1597440
    buffer_load_dwordx4 a[64:67], v12, s[72:75], s79 offen
    v_mfma_f32_16x16x32_bf16 v[108:111], v[20:23], v[76:79], v[108:111]
    ds_read_b128 v[76:79], v32 offset:1024
    v_mfma_f32_16x16x32_bf16 v[100:103], v[24:27], v[36:39], v[100:103]
    ds_read_b64 v[24:25], v15 offset:64
    ds_read_b64 v[26:27], v15 offset:72
    v_mfma_f32_16x16x32_bf16 v[104:107], v[20:23], v[36:39], v[104:107]
    ds_read_b128 v[36:39], v32 offset:512
    v_mfma_f32_16x16x32_bf16 v[128:131], v[96:99], v[40:43], v[128:131]
    ds_read_b128 v[40:43], v32 offset:0
    v_mfma_f32_16x16x32_bf16 v[124:127], v[96:99], v[60:63], v[124:127]
    s_waitcnt lgkmcnt(6)
    v_mfma_f32_16x16x32_bf16 v[128:131], v[16:19], v[60:63], v[128:131]
    v_mfma_f32_16x16x32_bf16 v[120:123], v[96:99], v[44:47], v[120:123]
    v_mfma_f32_16x16x32_bf16 v[124:127], v[16:19], v[44:47], v[124:127]
    s_add_u32 s79, s78, 1925120
    buffer_load_dwordx4 a[68:71], v12, s[72:75], s79 offen
    v_mfma_f32_16x16x32_bf16 v[116:119], v[96:99], v[48:51], v[116:119]
    v_mfma_f32_16x16x32_bf16 v[120:123], v[16:19], v[48:51], v[120:123]
    v_mfma_f32_16x16x32_bf16 v[112:115], v[96:99], v[80:83], v[112:115]
    v_mfma_f32_16x16x32_bf16 v[116:119], v[16:19], v[80:83], v[116:119]
    v_mfma_f32_16x16x32_bf16 v[108:111], v[96:99], v[64:67], v[108:111]
    v_mfma_f32_16x16x32_bf16 v[112:115], v[16:19], v[64:67], v[112:115]
    v_mfma_f32_16x16x32_bf16 v[104:107], v[96:99], v[52:55], v[104:107]
    v_mfma_f32_16x16x32_bf16 v[108:111], v[16:19], v[52:55], v[108:111]
    v_mfma_f32_16x16x32_bf16 v[100:103], v[96:99], v[56:59], v[100:103]
    v_mfma_f32_16x16x32_bf16 v[104:107], v[16:19], v[56:59], v[104:107]
    v_mfma_f32_16x16x32_bf16 v[128:131], v[28:31], v[92:95], v[128:131]
    v_mfma_f32_16x16x32_bf16 v[124:127], v[28:31], v[88:91], v[124:127]
    s_waitcnt lgkmcnt(0)
    v_mfma_f32_16x16x32_bf16 v[128:131], v[24:27], v[88:91], v[128:131]
    v_mfma_f32_16x16x32_bf16 v[120:123], v[28:31], v[68:71], v[120:123]
    v_mfma_f32_16x16x32_bf16 v[124:127], v[24:27], v[68:71], v[124:127]
    v_mfma_f32_16x16x32_bf16 v[116:119], v[28:31], v[72:75], v[116:119]
    v_mfma_f32_16x16x32_bf16 v[120:123], v[24:27], v[72:75], v[120:123]
    v_mfma_f32_16x16x32_bf16 v[112:115], v[28:31], v[84:87], v[112:115]
    v_mfma_f32_16x16x32_bf16 v[116:119], v[24:27], v[84:87], v[116:119]
    v_mfma_f32_16x16x32_bf16 v[108:111], v[28:31], v[76:79], v[108:111]
    v_mfma_f32_16x16x32_bf16 v[112:115], v[24:27], v[76:79], v[112:115]
    v_mfma_f32_16x16x32_bf16 v[104:107], v[28:31], v[36:39], v[104:107]
    v_mfma_f32_16x16x32_bf16 v[108:111], v[24:27], v[36:39], v[108:111]
    v_mfma_f32_16x16x32_bf16 v[100:103], v[28:31], v[40:43], v[100:103]
    v_mfma_f32_16x16x32_bf16 v[104:107], v[24:27], v[40:43], v[104:107]
    ds_write_b8 v11, v4 offset:64
    s_nop 5
    v_cvt_pk_bf16_f32 v40, v100, v101
    v_cvt_pk_bf16_f32 v41, v102, v103
    v_cvt_pk_bf16_f32 v42, v104, v105
    v_cvt_pk_bf16_f32 v43, v106, v107
    s_nop 0
    v_permlane16_swap_b32 v40, v42
    v_permlane16_swap_b32 v41, v43
    buffer_store_dwordx4 v[40:43], v14, s[60:63], s80 offen offset:0 sc1
    v_cvt_pk_bf16_f32 v44, v108, v109
    v_cvt_pk_bf16_f32 v45, v110, v111
    v_cvt_pk_bf16_f32 v46, v112, v113
    v_cvt_pk_bf16_f32 v47, v114, v115
    s_nop 0
    v_permlane16_swap_b32 v44, v46
    v_permlane16_swap_b32 v45, v47
    buffer_store_dwordx4 v[44:47], v14, s[60:63], s80 offen offset:1024 sc1
    v_cvt_pk_bf16_f32 v48, v116, v117
    v_cvt_pk_bf16_f32 v49, v118, v119
    v_cvt_pk_bf16_f32 v50, v120, v121
    v_cvt_pk_bf16_f32 v51, v122, v123
    s_nop 0
    v_permlane16_swap_b32 v48, v50
    v_permlane16_swap_b32 v49, v51
    buffer_store_dwordx4 v[48:51], v14, s[60:63], s80 offen offset:2048 sc1
    v_cvt_pk_bf16_f32 v52, v124, v125
    v_cvt_pk_bf16_f32 v53, v126, v127
    v_cvt_pk_bf16_f32 v54, v128, v129
    v_cvt_pk_bf16_f32 v55, v130, v131
    s_nop 0
    v_permlane16_swap_b32 v52, v54
    v_permlane16_swap_b32 v53, v55
    buffer_store_dwordx4 v[52:55], v14, s[60:63], s80 offen offset:3072 sc1
    s_mul_i32 s14, s10, 39
    v_min_u32 v18, 38, v1
    v_add_u32 v18, s14, v18
    v_min_u32 v18, 383, v18
    v_lshrrev_b32_e64 v16, 4, v18
    v_mul_u32_u24 v16, 14336, v16
    v_lshl_add_u32 v18, v18, 7, v16
    s_mul_i32 s48, s7, 393216
    s_add_u32 s48, s48, 11010048
    v_lshrrev_b32 v16, 3, v1
    v_mul_u32_u24 v16, 32, v16
    v_lshl_add_u32 v16, v1, 2, v16
    s_mul_i32 s14, s7, 2048
    s_add_u32 s46, s14, 393216
    v_add_u32 v10, s77, v2
    v_add_u32 v17, 65536, v10
    ds_read_b32 v7, v5 offset:64
    s_waitcnt lgkmcnt(0)
    v_cmp_gt_u32 vcc, 16843009, v7
    s_cbranch_vccnz L_SC_p2_spin
L_SC_p2_ok:
    s_waitcnt vmcnt(21)
    ds_write_b128 v10, a[0:3] offset:0
    s_waitcnt vmcnt(20)
    ds_write_b128 v10, a[4:7] offset:4096
    s_waitcnt vmcnt(19)
    ds_write_b128 v10, a[8:11] offset:8192
    s_waitcnt vmcnt(18)
    ds_write_b128 v10, a[12:15] offset:12288
    s_waitcnt vmcnt(17)
    ds_write_b128 v10, a[16:19] offset:16384
    s_waitcnt vmcnt(16)
    ds_write_b128 v10, a[20:23] offset:20480
L_SC_hop3:
    s_cbranch_execz L_SC_ret
    s_nop 0
    ds_write_b8 v11, v4 offset:104
    s_waitcnt vmcnt(0)
    buffer_store_dword v4, v3, s[60:63], s49 offen offset:0 sc1
    s_cmp_lg_u32 s3, 0
    s_cbranch_scc1 L_alt2007_b
    v_mov_b32 v6, 1
    s_mov_b32 exec_lo, 0x3f3f3f3f
    s_mov_b32 exec_hi, 0x3f3f3f3f
    v_mov_b32 v6, 0
    buffer_atomic_add v6, v16, s[60:63], s46 offen offset:768 sc0 sc1
    s_mov_b64 exec, -1
    s_waitcnt vmcnt(0)
    v_cmp_gt_u32 vcc, 1, v6
    s_nop 0
    s_lshl_b64 vcc, vcc, 32
    s_cbranch_scc1 L_SC_p3_spin
L_SC_p3_ok:
    s_add_u32 s12, s48, 6144
    buffer_load_dword v8, v18, s[60:63], s12 offen sc1
    ds_write_b32 v5, v4 offset:44
    v_cmp_gt_u32_e64 vcc, 1, v6
    s_cbranch_vccnz L_SC_p4_spin
L_SC_p4_ok:
    s_add_u32 s12, s48, 8192
    s_waitcnt vmcnt(0)
    buffer_load_dword v8, v18, s[60:63], s12 offen sc1
    ds_write_b32 v5, v4 offset:48
L_alt2007_b:
L_alt2007_e:
    ds_read_b32 v7, v5 offset:68
    s_waitcnt lgkmcnt(0)
    v_cmp_gt_u32 vcc, 16843009, v7
    s_cbranch_vccnz L_SC_p5_spin
L_SC_p5_ok:
    ds_write_b128 v10, a[24:27] offset:40960
    ds_write_b128 v10, a[28:31] offset:45056
    ds_write_b128 v10, a[32:35] offset:49152
    ds_write_b128 v10, a[36:39] offset:53248
    ds_write_b128 v10, a[40:43] offset:57344
    ds_write_b128 v10, a[44:47] offset:61440
    ds_write_b8 v11, v4 offset:108
    ds_read_b32 v7, v5 offset:72
    s_waitcnt lgkmcnt(0)
    v_cmp_gt_u32 vcc, 16843009, v7
    s_cbranch_vccnz L_SC_p6_spin
L_SC_p6_ok:
    ds_write_b128 v17, a[48:51] offset:0
    ds_write_b128 v17, a[52:55] offset:4096
    ds_write_b128 v17, a[56:59] offset:8192
    ds_write_b128 v17, a[60:63] offset:12288
    ds_write_b128 v17, a[64:67] offset:16384
    ds_write_b128 v17, a[68:71] offset:20480
    ds_write_b8 v11, v4 offset:112
    s_cmp_lg_u32 s3, 2
    s_cbranch_scc1 L_alt2008_b
    ds_read_b32 v7, v5 offset:48
    s_waitcnt lgkmcnt(0)
    v_cmp_gt_u32 vcc, 1, v7
    s_cbranch_vccnz L_SC_p7_spin
L_SC_p7_ok:
    v_mov_b32 v6, 1
    s_mov_b32 exec_lo, 0x3f3f3f3f
    s_mov_b32 exec_hi, 0x0
    v_mov_b32 v6, 0
    buffer_atomic_add v6, v16, s[60:63], s46 offen offset:1280 sc0 sc1
    s_mov_b64 exec, -1
    s_waitcnt vmcnt(0)
    v_cmp_gt_u32 vcc, 1, v6
    s_nop 0
    s_lshl_b64 vcc, vcc, 32
    s_cbranch_scc1 L_SC_p8_spin
L_SC_p8_ok:
    s_add_u32 s12, s48, 10240
    buffer_load_dword v8, v18, s[60:63], s12 offen sc1
    ds_write_b32 v5, v4 offset:52
    v_mov_b32 v6, 1
    s_mov_b32 exec_lo, 0x3f3f3f3f
    s_mov_b32 exec_hi, 0x3f3f3f3f
    v_mov_b32 v6, 0
    buffer_atomic_add v6, v16, s[60:63], s46 offen offset:1536 sc0 sc1
    s_mov_b64 exec, -1
    s_waitcnt vmcnt(0)
    v_cmp_gt_u32 vcc, 1, v6
    s_nop 0
    s_lshl_b64 vcc, vcc, 32
    s_cbranch_scc1 L_SC_p9_spin
L_SC_p9_ok:
    s_add_u32 s12, s48, 12288
    buffer_load_dword v8, v18, s[60:63], s12 offen sc1
    ds_write_b32 v5, v4 offset:56
    v_cmp_gt_u32 vcc, 1, v6
    s_cbranch_vccnz L_SC_p10_spin
L_SC_p10_ok:
    s_add_u32 s12, s48, 14336
    s_waitcnt vmcnt(0)
    buffer_load_dword v8, v18, s[60:63], s12 offen sc1
    ds_write_b32 v5, v4 offset:60
L_alt2008_b:
L_alt2008_e:
    s_cmp_lg_u32 s3, 1
    s_cbranch_scc1 L_alt2009_b
    ds_read_b32 v7, v5 offset:72
    s_waitcnt lgkmcnt(0)
    v_cmp_gt_u32 vcc, 16843009, v7
    s_cbranch_vccnz L_SC_p11_spin
L_SC_p11_ok:
    v_mov_b32 v9, 0
    buffer_atomic_add v9, v33, s[60:63], s47 offen offset:0 sc0 sc1
    s_waitcnt vmcnt(0)
    v_cmp_gt_u32 vcc, 1, v9
    s_cbranch_vccnz L_SC_p12_spin
L_SC_p12_ok:
    ds_read_b32 v7, v5 offset:76
    s_waitcnt lgkmcnt(0)
    v_cmp_gt_u32 vcc, 16843009, v7
    s_cbranch_vccnz L_SC_p13_spin
L_SC_p13_ok:
    s_mov_b32 m0, 90112
    s_nop 0
    buffer_load_dwordx4 v13, s[60:63], s82 offen sc1 lds
    s_mov_b32 m0, 91152
    s_add_u32 s82, s82, 16384
    buffer_load_dwordx4 v13, s[60:63], s82 offen sc1 lds
    s_mov_b32 m0, 92192
    s_add_u32 s82, s82, 16384
    buffer_load_dwordx4 v13, s[60:63], s82 offen sc1 lds
    s_mov_b32 m0, 93232
    s_add_u32 s82, s82, 16384
    buffer_load_dwordx4 v13, s[60:63], s82 offen sc1 lds
    s_mov_b32 m0, 94272
    s_add_u32 s82, s82, 16384
    buffer_load_dwordx4 v13, s[60:63], s82 offen sc1 lds
    s_mov_b32 m0, 95312
    s_add_u32 s82, s82, 16384
    buffer_load_dwordx4 v13, s[60:63], s82 offen sc1 lds
    s_mov_b32 m0, 96352
    s_add_u32 s82, s82, 16384
    buffer_load_dwordx4 v13, s[60:63], s82 offen sc1 lds
    s_mov_b32 m0, 97392
    s_add_u32 s82, s82, 16384
    buffer_load_dwordx4 v13, s[60:63], s82 offen sc1 lds
    s_mov_b32 m0, 98432
    s_add_u32 s82, s82, 16384
    buffer_load_dwordx4 v13, s[60:63], s82 offen sc1 lds
    s_mov_b32 m0, 99472
    s_add_u32 s82, s82, 16384
    buffer_load_dwordx4 v13, s[60:63], s82 offen sc1 lds
    s_mov_b32 m0, 100512
    s_add_u32 s82, s82, 16384
    buffer_load_dwordx4 v13, s[60:63], s82 offen sc1 lds
    s_mov_b32 m0, 101552
    s_add_u32 s82, s82, 16384
    buffer_load_dwordx4 v13, s[60:63], s82 offen sc1 lds
    s_mov_b32 m0, 102592
    s_add_u32 s82, s82, 16384
    buffer_load_dwordx4 v13, s[60:63], s82 offen sc1 lds
    s_mov_b32 m0, 103632
    s_add_u32 s82, s82, 16384
    buffer_load_dwordx4 v13, s[60:63], s82 offen sc1 lds
    s_mov_b32 m0, 104672
    s_add_u32 s82, s82, 16384
    buffer_load_dwordx4 v13, s[60:63], s82 offen sc1 lds
    s_mov_b32 m0, 105712
    s_add_u32 s82, s82, 16384
    buffer_load_dwordx4 v13, s[60:63], s82 offen sc1 lds
    s_waitcnt vmcnt(0)
    ds_write_b32 v5, v4 offset:116
L_alt2009_b:
L_alt2009_e:
    s_endpgm
L_SC_p1_spin:
    s_mov_b32 s81, 0
L_SC_p1_chk:
    s_sleep 1
    ds_read_b32 v6, v5 offset:12
    s_add_u32 s81, s81, 1
    s_waitcnt lgkmcnt(0)
    v_cmp_gt_u32 vcc, 4, v6
    s_cmp_gt_u32 s81, 0x10000
    s_cbranch_scc1 L_SC_p1_ok
    s_cbranch_vccnz L_SC_p1_chk
    s_branch L_SC_p1_ok
L_SC_p2_spin:
    s_mov_b32 s81, 0
L_SC_p2_chk:
    s_sleep 1
    ds_read_b32 v7, v5 offset:64
    s_add_u32 s81, s81, 1
    s_waitcnt lgkmcnt(0)
    v_cmp_gt_u32 vcc, 16843009, v7
    s_cmp_gt_u32 s81, 0x10000
    s_cbranch_scc1 L_SC_p2_ok
    s_cbranch_vccnz L_SC_p2_chk
    s_branch L_SC_p2_ok
L_SC_p3_spin:
    s_mov_b32 s81, 0
L_SC_p3_chk:
    s_sleep 2
    s_mov_b32 exec_lo, 0x3f3f3f3f
    s_mov_b32 exec_hi, 0x3f3f3f3f
    v_mov_b32 v6, 0
    buffer_atomic_add v6, v16, s[60:63], s46 offen offset:768 sc0 sc1
    s_mov_b64 exec, -1
    s_add_u32 s81, s81, 1
    s_waitcnt vmcnt(0)
    v_cmp_gt_u32 vcc, 1, v6
    s_cmp_gt_u32 s81, 0x10000
    s_cbranch_scc1 L_SC_p3_ok
    s_lshl_b64 vcc, vcc, 32
    s_cbranch_scc1 L_SC_p3_chk
    s_branch L_SC_p3_ok
L_SC_p4_spin:
    s_mov_b32 s81, 0
L_SC_p4_chk:
    s_sleep 2
    s_mov_b32 exec_lo, 0x3f3f3f3f
    s_mov_b32 exec_hi, 0x3f3f3f3f
    v_mov_b32 v6, 0
    buffer_atomic_add v6, v16, s[60:63], s46 offen offset:768 sc0 sc1
    s_mov_b64 exec, -1
    s_add_u32 s81, s81, 1
    s_waitcnt vmcnt(0)
    v_cmp_gt_u32 vcc, 1, v6
    s_cmp_gt_u32 s81, 0x10000
    s_cbranch_scc1 L_SC_p4_ok
    s_cbranch_vccnz L_SC_p4_chk
    s_branch L_SC_p4_ok
L_SC_p5_spin:
    s_mov_b32 s81, 0
L_SC_p5_chk:
    s_sleep 1
    ds_read_b32 v7, v5 offset:68
    s_add_u32 s81, s81, 1
    s_waitcnt lgkmcnt(0)
    v_cmp_gt_u32 vcc, 16843009, v7
    s_cmp_gt_u32 s81, 0x10000
    s_cbranch_scc1 L_SC_p5_ok
    s_cbranch_vccnz L_SC_p5_chk
    s_branch L_SC_p5_ok
L_SC_p6_spin:
    s_mov_b32 s81, 0
L_SC_p6_chk:
    s_sleep 1
    ds_read_b32 v7, v5 offset:72
    s_add_u32 s81, s81, 1
    s_waitcnt lgkmcnt(0)
    v_cmp_gt_u32 vcc, 16843009, v7
    s_cmp_gt_u32 s81, 0x10000
    s_cbranch_scc1 L_SC_p6_ok
    s_cbranch_vccnz L_SC_p6_chk
    s_branch L_SC_p6_ok
L_SC_p7_spin:
    s_mov_b32 s81, 0
L_SC_p7_chk:
    s_sleep 2
    ds_read_b32 v7, v5 offset:48
    s_add_u32 s81, s81, 1
    s_waitcnt lgkmcnt(0)
    v_cmp_gt_u32 vcc, 1, v7
    s_cmp_gt_u32 s81, 0x10000
    s_cbranch_scc1 L_SC_p7_ok
    s_cbranch_vccnz L_SC_p7_chk
    s_branch L_SC_p7_ok
L_SC_p8_spin:
    s_mov_b32 s81, 0
L_SC_p8_chk:
    s_sleep 2
    s_mov_b32 exec_lo, 0x3f3f3f3f
    s_mov_b32 exec_hi, 0x0
    v_mov_b32 v6, 0
    buffer_atomic_add v6, v16, s[60:63], s46 offen offset:1280 sc0 sc1
    s_mov_b64 exec, -1
    s_add_u32 s81, s81, 1
    s_waitcnt vmcnt(0)
    v_cmp_gt_u32 vcc, 1, v6
    s_cmp_gt_u32 s81, 0x10000
    s_cbranch_scc1 L_SC_p8_ok
    s_lshl_b64 vcc, vcc, 32
    s_cbranch_scc1 L_SC_p8_chk
    s_branch L_SC_p8_ok
L_SC_p9_spin:
    s_mov_b32 s81, 0
L_SC_p9_chk:
    s_sleep 2
    s_mov_b32 exec_lo, 0x3f3f3f3f
    s_mov_b32 exec_hi, 0x3f3f3f3f
    v_mov_b32 v6, 0
    buffer_atomic_add v6, v16, s[60:63], s46 offen offset:1536 sc0 sc1
    s_mov_b64 exec, -1
    s_add_u32 s81, s81, 1
    s_waitcnt vmcnt(0)
    v_cmp_gt_u32 vcc, 1, v6
    s_cmp_gt_u32 s81, 0x10000
    s_cbranch_scc1 L_SC_p9_ok
    s_lshl_b64 vcc, vcc, 32
    s_cbranch_scc1 L_SC_p9_chk
    s_branch L_SC_p9_ok
L_SC_p10_spin:
    s_mov_b32 s81, 0
L_SC_p10_chk:
    s_sleep 2
    s_mov_b32 exec_lo, 0x3f3f3f3f
    s_mov_b32 exec_hi, 0x3f3f3f3f
    v_mov_b32 v6, 0
    buffer_atomic_add v6, v16, s[60:63], s46 offen offset:1536 sc0 sc1
    s_mov_b64 exec, -1
    s_add_u32 s81, s81, 1
    s_waitcnt vmcnt(0)
    v_cmp_gt_u32 vcc, 1, v6
    s_cmp_gt_u32 s81, 0x10000
    s_cbranch_scc1 L_SC_p10_ok
    s_cbranch_vccnz L_SC_p10_chk
    s_branch L_SC_p10_ok
L_SC_p11_spin:
    s_mov_b32 s81, 0
L_SC_p11_chk:
    s_sleep 1
    ds_read_b32 v7, v5 offset:72
    s_add_u32 s81, s81, 1
    s_waitcnt lgkmcnt(0)
    v_cmp_gt_u32 vcc, 16843009, v7
    s_cmp_gt_u32 s81, 0x10000
    s_cbranch_scc1 L_SC_p11_ok
    s_cbranch_vccnz L_SC_p11_chk
    s_branch L_SC_p11_ok
L_SC_p12_spin:
    s_mov_b32 s81, 0
L_SC_p12_chk:
    s_sleep 2
    v_mov_b32 v9, 0
    buffer_atomic_add v9, v33, s[60:63], s47 offen offset:0 sc0 sc1
    s_add_u32 s81, s81, 1
    s_waitcnt vmcnt(0)
    v_cmp_gt_u32 vcc, 1, v9
    s_cmp_gt_u32 s81, 0x10000
    s_cbranch_scc1 L_SC_p12_ok
    s_cbranch_vccnz L_SC_p12_chk
    s_branch L_SC_p12_ok
L_SC_p13_spin:
    s_mov_b32 s81, 0
L_SC_p13_chk:
    s_sleep 1
    ds_read_b32 v7, v5 offset:76
    s_add_u32 s81, s81, 1
    s_waitcnt lgkmcnt(0)
    v_cmp_gt_u32 vcc, 16843009, v7
    s_cmp_gt_u32 s81, 0x10000
    s_cbranch_scc1 L_SC_p13_ok
    s_cbranch_vccnz L_SC_p13_chk
    s_branch L_SC_p13_ok
.p2align 12
L_GM1:
L_GM_hop0:
    s_cbranch_execz L_GM_ret
    s_nop 0
    s_waitcnt vmcnt(7)
    v_lshl_or_b32 v88, v88, 16, v88
    s_waitcnt vmcnt(6)
    v_lshl_or_b32 v89, v89, 16, v89
    s_waitcnt vmcnt(5)
    v_lshl_or_b32 v90, v90, 16, v90
    s_waitcnt vmcnt(4)
    v_lshl_or_b32 v91, v91, 16, v91
    s_waitcnt vmcnt(3)
    v_lshl_or_b32 v92, v92, 16, v92
    s_waitcnt vmcnt(2)
    v_lshl_or_b32 v93, v93, 16, v93
    s_waitcnt vmcnt(1)
    v_lshl_or_b32 v94, v94, 16, v94
    s_waitcnt vmcnt(0)
    v_lshl_or_b32 v95, v95, 16, v95
    buffer_load_dword v6, v83, s[68:71], 0 offen offset:0 sc1
    ds_read_b32 v7, v5 offset:104
    s_waitcnt lgkmcnt(0)
    v_cmp_gt_u32 vcc, 16843009, v7
    s_cbranch_vccnz L_GM_p1_spin
L_GM_p1_ok:
    s_waitcnt vmcnt(0)
    v_cmp_gt_u32_e64 vcc, 1, v6
    s_cbranch_vccnz L_GM_p2_spin
L_GM_p2_ok:
    ds_read_b64_tr_b16 v[22:23], v10 offset:0
    ds_read_b64_tr_b16 v[24:25], v10 offset:512
    ds_read_b64_tr_b16 v[26:27], v11 offset:0
    ds_read_b64_tr_b16 v[28:29], v11 offset:512
    ds_read_b64_tr_b16 v[30:31], v10 offset:2048
    ds_read_b64_tr_b16 v[32:33], v10 offset:2560
    ds_read_b64_tr_b16 v[34:35], v11 offset:2048
    ds_read_b64_tr_b16 v[36:37], v11 offset:2560
    ds_read_b64_tr_b16 v[38:39], v10 offset:4096
    ds_read_b64_tr_b16 v[40:41], v10 offset:4608
    ds_read_b64_tr_b16 v[42:43], v11 offset:4096
    ds_read_b64_tr_b16 v[44:45], v11 offset:4608
    s_mov_b32 exec_hi, 0x0
    v_mov_b32 v6, 0
    buffer_atomic_add v6, v9, s[60:63], s45 offen offset:0 sc0 sc1
    s_mov_b32 exec_hi, -1
    s_waitcnt vmcnt(0)
    v_cmp_gt_u32 vcc, 1, v6
    s_nop 0
    s_lshl_b64 vcc, vcc, 32
    s_cbranch_scc1 L_GM_p3_spin
L_GM_p3_ok:
    buffer_load_dwordx4 v[96:99], v2, s[60:63], s72 offen offset:0 sc1
    buffer_load_dwordx4 v[100:103], v2, s[60:63], s72 offen offset:1024 sc1
    buffer_load_dwordx4 v[104:107], v2, s[60:63], s72 offen offset:2048 sc1
    buffer_load_dwordx4 v[108:111], v2, s[60:63], s72 offen offset:3072 sc1
    s_add_u32 s72, s72, 4096
    buffer_load_dwordx4 v[112:115], v2, s[60:63], s72 offen offset:0 sc1
    v_mov_b32 v7, v6
    buffer_load_dwordx4 v[116:119], v2, s[60:63], s72 offen offset:1024 sc1
    s_nop 0
    v_permlane32_swap_b32 v6, v7
    v_cmp_gt_u32 vcc, 32, v1
    buffer_load_dwordx4 v[120:123], v2, s[60:63], s72 offen offset:2048 sc1
    v_cvt_pk_bf16_f32 v7, 0, v6
    v_sub_f32 v7, v6, v7
    v_cvt_pk_bf16_f32 v7, v6, v7
    buffer_load_dwordx4 v[124:127], v2, s[60:63], s72 offen offset:3072 sc1
    v_cndmask_b32 v82, 0, v7, vcc
    v_mov_b32 v87, v82
    v_rcp_f32 v7, v6
    s_add_u32 s72, s72, 4096
    buffer_load_dwordx4 v[128:131], v2, s[60:63], s72 offen offset:0 sc1
    v_mov_b32 v20, v6
    v_mul_f32 v19, 0xc0135761, v7
    buffer_load_dwordx4 v[132:135], v2, s[60:63], s72 offen offset:1024 sc1
    v_mul_f32 v7, v7, v7
    v_mul_f32 v18, 0x3d372713, v19
    v_mul_f32_e64 v18, v18, v7
    buffer_load_dwordx4 a[0:3], v2, s[60:63], s73 offen offset:0 sc1
    v_mfma_f32_32x32x16_bf16 v[50:65], v[88:91], v[82:85], 0
    v_mfma_f32_32x32x16_bf16 v[66:81], v[86:89], v[84:87], 0
    s_waitcnt vmcnt(10) lgkmcnt(0)
    v_mfma_f32_32x32x16_bf16 v[50:65], v[22:25], v[96:99], v[50:65]
    ds_read_b64_tr_b16 v[46:47], v10 offset:6144
    ds_read_b64_tr_b16 v[48:49], v10 offset:6656
    v_mfma_f32_32x32x16_bf16 v[66:81], v[26:29], v[96:99], v[66:81]
    ds_read_b64_tr_b16 v[22:23], v11 offset:6144
    ds_read_b64_tr_b16 v[24:25], v11 offset:6656
    buffer_load_dwordx4 a[4:7], v2, s[60:63], s73 offen offset:1024 sc1
    s_waitcnt vmcnt(10)
    v_mfma_f32_32x32x16_bf16 v[50:65], v[30:33], v[100:103], v[50:65]
    ds_read_b64_tr_b16 v[26:27], v10 offset:8192
    ds_read_b64_tr_b16 v[28:29], v10 offset:8704
    v_mfma_f32_32x32x16_bf16 v[66:81], v[34:37], v[100:103], v[66:81]
    ds_read_b64_tr_b16 v[30:31], v11 offset:8192
    ds_read_b64_tr_b16 v[32:33], v11 offset:8704
    buffer_load_dwordx4 a[8:11], v2, s[60:63], s73 offen offset:2048 sc1
    s_waitcnt vmcnt(10)
    v_mfma_f32_32x32x16_bf16 v[50:65], v[38:41], v[104:107], v[50:65]
    ds_read_b64_tr_b16 v[34:35], v10 offset:10240
    ds_read_b64_tr_b16 v[36:37], v10 offset:10752
    v_mfma_f32_32x32x16_bf16 v[66:81], v[42:45], v[104:107], v[66:81]
    ds_read_b64_tr_b16 v[38:39], v11 offset:10240
    ds_read_b64_tr_b16 v[40:41], v11 offset:10752
    buffer_load_dwordx4 a[12:15], v2, s[60:63], s73 offen offset:3072 sc1
    s_waitcnt vmcnt(10) lgkmcnt(6)
    v_mfma_f32_32x32x16_bf16 v[50:65], v[46:49], v[108:111], v[50:65]
    ds_read_b64_tr_b16 v[42:43], v10 offset:12288
    ds_read_b64_tr_b16 v[44:45], v10 offset:12800
    v_mfma_f32_32x32x16_bf16 v[66:81], v[22:25], v[108:111], v[66:81]
    ds_read_b64_tr_b16 v[46:47], v11 offset:12288
    ds_read_b64_tr_b16 v[48:49], v11 offset:12800
    s_add_u32 s73, s73, 4096
    buffer_load_dwordx4 a[16:19], v2, s[60:63], s73 offen offset:0 sc1
    s_waitcnt vmcnt(10)
    v_mfma_f32_32x32x16_bf16 v[50:65], v[26:29], v[112:115], v[50:65]
    ds_read_b64_tr_b16 v[22:23], v10 offset:14336
    ds_read_b64_tr_b16 v[24:25], v10 offset:14848
    s_waitcnt lgkmcnt(6)
    v_mfma_f32_32x32x16_bf16 v[66:81], v[30:33], v[112:115], v[66:81]
    ds_read_b64_tr_b16 v[26:27], v11 offset:14336
    ds_read_b64_tr_b16 v[28:29], v11 offset:14848
    buffer_load_dwordx4 a[20:23], v2, s[60:63], s73 offen offset:1024 sc1
    s_waitcnt vmcnt(10)
    v_mfma_f32_32x32x16_bf16 v[50:65], v[34:37], v[116:119], v[50:65]
    ds_read_b64_tr_b16 v[30:31], v10 offset:16384
    ds_read_b64_tr_b16 v[32:33], v10 offset:16896
    v_mfma_f32_32x32x16_bf16 v[66:81], v[38:41], v[116:119], v[66:81]
    ds_read_b64_tr_b16 v[34:35], v11 offset:16384
    ds_read_b64_tr_b16 v[36:37], v11 offset:16896
    buffer_load_dwordx4 a[24:27], v2, s[60:63], s73 offen offset:2048 sc1
    s_waitcnt vmcnt(10) lgkmcnt(6)
    v_mfma_f32_32x32x16_bf16 v[50:65], v[42:45], v[120:123], v[50:65]
    ds_read_b64_tr_b16 v[38:39], v10 offset:18432
    ds_read_b64_tr_b16 v[40:41], v10 offset:18944
    v_mfma_f32_32x32x16_bf16 v[66:81], v[46:49], v[120:123], v[66:81]
    ds_read_b64_tr_b16 v[42:43], v11 offset:18432
    ds_read_b64_tr_b16 v[44:45], v11 offset:18944
    buffer_load_dwordx4 a[28:31], v2, s[60:63], s73 offen offset:3072 sc1
    s_waitcnt vmcnt(10)
    v_mfma_f32_32x32x16_bf16 v[50:65], v[22:25], v[124:127], v[50:65]
    ds_read_b64_tr_b16 v[46:47], v10 offset:40960
    ds_read_b64_tr_b16 v[48:49], v10 offset:41472
    s_waitcnt lgkmcnt(6)
    v_mfma_f32_32x32x16_bf16 v[66:81], v[26:29], v[124:127], v[66:81]
    ds_read_b64_tr_b16 v[22:23], v11 offset:40960
    ds_read_b64_tr_b16 v[24:25], v11 offset:41472
    s_add_u32 s73, s73, 4096
    buffer_load_dwordx4 a[32:35], v2, s[60:63], s73 offen offset:0 sc1
    s_waitcnt vmcnt(10)
    v_mfma_f32_32x32x16_bf16 v[50:65], v[30:33], v[128:131], v[50:65]
    ds_read_b64_tr_b16 v[26:27], v10 offset:43008
    ds_read_b64_tr_b16 v[28:29], v10 offset:43520
    v_mfma_f32_32x32x16_bf16 v[66:81], v[34:37], v[128:131], v[66:81]
    ds_read_b64_tr_b16 v[30:31], v11 offset:43008
    ds_read_b64_tr_b16 v[32:33], v11 offset:43520
    buffer_load_dwordx4 a[36:39], v2, s[60:63], s73 offen offset:1024 sc1
    s_waitcnt vmcnt(10) lgkmcnt(6)
    v_mfma_f32_32x32x16_bf16 v[50:65], v[38:41], v[132:135], v[50:65]
    ds_read_b64_tr_b16 v[34:35], v10 offset:45056
    ds_read_b64_tr_b16 v[36:37], v10 offset:45568
    v_mfma_f32_32x32x16_bf16 v[66:81], v[42:45], v[132:135], v[66:81]
    ds_read_b64_tr_b16 v[38:39], v11 offset:45056
    ds_read_b64_tr_b16 v[40:41], v11 offset:45568
    buffer_load_dwordx4 a[40:43], v2, s[60:63], s74 offen offset:0 sc1
    ds_write_b8 v16, v4 offset:68
    s_waitcnt vmcnt(10)
    v_mfma_f32_32x32x16_bf16 v[50:65], v[46:49], a[0:3], v[50:65]
    ds_read_b64_tr_b16 v[42:43], v10 offset:47104
    ds_read_b64_tr_b16 v[44:45], v10 offset:47616
    s_waitcnt lgkmcnt(7)
    v_mfma_f32_32x32x16_bf16 v[66:81], v[22:25], a[0:3], v[66:81]
    ds_read_b64_tr_b16 v[46:47], v11 offset:47104
    ds_read_b64_tr_b16 v[48:49], v11 offset:47616
    buffer_load_dwordx4 a[44:47], v2, s[60:63], s74 offen offset:1024 sc1
    s_waitcnt vmcnt(10)
    v_mfma_f32_32x32x16_bf16 v[50:65], v[26:29], a[4:7], v[50:65]
    ds_read_b64_tr_b16 v[22:23], v10 offset:49152
    ds_read_b64_tr_b16 v[24:25], v10 offset:49664
    v_mfma_f32_32x32x16_bf16 v[66:81], v[30:33], a[4:7], v[66:81]
    ds_read_b64_tr_b16 v[26:27], v11 offset:49152
    ds_read_b64_tr_b16 v[28:29], v11 offset:49664
    buffer_load_dwordx4 a[48:51], v2, s[60:63], s74 offen offset:2048 sc1
    s_waitcnt vmcnt(10) lgkmcnt(6)
    v_mfma_f32_32x32x16_bf16 v[50:65], v[34:37], a[8:11], v[50:65]
    ds_read_b64_tr_b16 v[30:31], v10 offset:51200
    ds_read_b64_tr_b16 v[32:33], v10 offset:51712
    v_mfma_f32_32x32x16_bf16 v[66:81], v[38:41], a[8:11], v[66:81]
    ds_read_b64_tr_b16 v[34:35], v11 offset:51200
    ds_read_b64_tr_b16 v[36:37], v11 offset:51712
    buffer_load_dwordx4 a[52:55], v2, s[60:63], s74 offen offset:3072 sc1
    s_waitcnt vmcnt(10)
    v_mfma_f32_32x32x16_bf16 v[50:65], v[42:45], a[12:15], v[50:65]
    ds_read_b64_tr_b16 v[38:39], v10 offset:53248
    ds_read_b64_tr_b16 v[40:41], v10 offset:53760
    s_waitcnt lgkmcnt(6)
    v_mfma_f32_32x32x16_bf16 v[66:81], v[46:49], a[12:15], v[66:81]
    ds_read_b64_tr_b16 v[42:43], v11 offset:53248
    ds_read_b64_tr_b16 v[44:45], v11 offset:53760
    s_add_u32 s74, s74, 4096
    buffer_load_dwordx4 a[56:59], v2, s[60:63], s74 offen offset:0 sc1
    s_waitcnt vmcnt(10)
    v_mfma_f32_32x32x16_bf16 v[50:65], v[22:25], a[16:19], v[50:65]
    ds_read_b64_tr_b16 v[46:47], v10 offset:55296
    ds_read_b64_tr_b16 v[48:49], v10 offset:55808
    v_mfma_f32_32x32x16_bf16 v[66:81], v[26:29], a[16:19], v[66:81]
    ds_read_b64_tr_b16 v[22:23], v11 offset:55296
    ds_read_b64_tr_b16 v[24:25], v11 offset:55808
    buffer_load_dwordx4 a[60:63], v2, s[60:63], s74 offen offset:1024 sc1
    s_waitcnt vmcnt(10) lgkmcnt(6)
    v_mfma_f32_32x32x16_bf16 v[50:65], v[30:33], a[20:23], v[50:65]
    ds_read_b64_tr_b16 v[26:27], v10 offset:57344
    ds_read_b64_tr_b16 v[28:29], v10 offset:57856
    v_mfma_f32_32x32x16_bf16 v[66:81], v[34:37], a[20:23], v[66:81]
    ds_read_b64_tr_b16 v[30:31], v11 offset:57344
    ds_read_b64_tr_b16 v[32:33], v11 offset:57856
    buffer_load_dwordx4 a[64:67], v2, s[60:63], s74 offen offset:2048 sc1
    s_waitcnt vmcnt(10)
    v_mfma_f32_32x32x16_bf16 v[50:65], v[38:41], a[24:27], v[50:65]
    ds_read_b64_tr_b16 v[34:35], v10 offset:59392
    ds_read_b64_tr_b16 v[36:37], v10 offset:59904
    s_waitcnt lgkmcnt(6)
    v_mfma_f32_32x32x16_bf16 v[66:81], v[42:45], a[24:27], v[66:81]
    ds_read_b64_tr_b16 v[38:39], v11 offset:59392
    ds_read_b64_tr_b16 v[40:41], v11 offset:59904
    buffer_load_dwordx4 a[68:71], v2, s[60:63], s74 offen offset:3072 sc1
    s_waitcnt vmcnt(10)
    v_mfma_f32_32x32x16_bf16 v[50:65], v[46:49], a[28:31], v[50:65]
    ds_read_b64_tr_b16 v[42:43], v12 offset:0
    ds_read_b64_tr_b16 v[44:45], v12 offset:512
    v_mfma_f32_32x32x16_bf16 v[66:81], v[22:25], a[28:31], v[66:81]
    ds_read_b64_tr_b16 v[46:47], v13 offset:0
    ds_read_b64_tr_b16 v[48:49], v13 offset:512
    s_add_u32 s74, s74, 4096
    buffer_load_dwordx4 a[72:75], v2, s[60:63], s74 offen offset:0 sc1
    s_waitcnt vmcnt(10) lgkmcnt(6)
    v_mfma_f32_32x32x16_bf16 v[50:65], v[26:29], a[32:35], v[50:65]
    ds_read_b64_tr_b16 v[22:23], v12 offset:2048
    ds_read_b64_tr_b16 v[24:25], v12 offset:2560
    v_mfma_f32_32x32x16_bf16 v[66:81], v[30:33], a[32:35], v[66:81]
    ds_read_b64_tr_b16 v[26:27], v13 offset:2048
    ds_read_b64_tr_b16 v[28:29], v13 offset:2560
    buffer_load_dwordx4 a[76:79], v2, s[60:63], s74 offen offset:1024 sc1
    s_waitcnt vmcnt(10)
    v_mfma_f32_32x32x16_bf16 v[50:65], v[34:37], a[36:39], v[50:65]
    ds_read_b64_tr_b16 v[30:31], v12 offset:4096
    ds_read_b64_tr_b16 v[32:33], v12 offset:4608
    s_waitcnt lgkmcnt(6)
    v_mfma_f32_32x32x16_bf16 v[66:81], v[38:41], a[36:39], v[66:81]
    ds_read_b64_tr_b16 v[34:35], v13 offset:4096
    ds_read_b64_tr_b16 v[36:37], v13 offset:4608
    buffer_load_dwordx4 a[80:83], v2, s[60:63], s75 offen offset:0 sc1
    s_waitcnt vmcnt(10)
    v_mfma_f32_32x32x16_bf16 v[50:65], v[42:45], a[40:43], v[50:65]
    ds_read_b64_tr_b16 v[38:39], v12 offset:6144
    ds_read_b64_tr_b16 v[40:41], v12 offset:6656
    v_mfma_f32_32x32x16_bf16 v[66:81], v[46:49], a[40:43], v[66:81]
    ds_read_b64_tr_b16 v[42:43], v13 offset:6144
    ds_read_b64_tr_b16 v[44:45], v13 offset:6656
    buffer_load_dwordx4 a[84:87], v2, s[60:63], s75 offen offset:1024 sc1
    s_waitcnt vmcnt(10) lgkmcnt(6)
    v_mfma_f32_32x32x16_bf16 v[50:65], v[22:25], a[44:47], v[50:65]
    ds_read_b64_tr_b16 v[46:47], v12 offset:8192
    ds_read_b64_tr_b16 v[48:49], v12 offset:8704
    v_mfma_f32_32x32x16_bf16 v[66:81], v[26:29], a[44:47], v[66:81]
    ds_read_b64_tr_b16 v[22:23], v13 offset:8192
    ds_read_b64_tr_b16 v[24:25], v13 offset:8704
    buffer_load_dwordx4 a[88:91], v2, s[60:63], s75 offen offset:2048 sc1
    s_waitcnt vmcnt(10)
    v_mfma_f32_32x32x16_bf16 v[50:65], v[30:33], a[48:51], v[50:65]
    ds_read_b64_tr_b16 v[26:27], v12 offset:10240
    ds_read_b64_tr_b16 v[28:29], v12 offset:10752
    s_waitcnt lgkmcnt(6)
    v_mfma_f32_32x32x16_bf16 v[66:81], v[34:37], a[48:51], v[66:81]
    ds_read_b64_tr_b16 v[30:31], v13 offset:10240
    ds_read_b64_tr_b16 v[32:33], v13 offset:10752
    buffer_load_dwordx4 a[92:95], v2, s[60:63], s75 offen offset:3072 sc1
    s_waitcnt vmcnt(10)
    v_mfma_f32_32x32x16_bf16 v[50:65], v[38:41], a[52:55], v[50:65]
    ds_read_b64_tr_b16 v[34:35], v12 offset:12288
    ds_read_b64_tr_b16 v[36:37], v12 offset:12800
    v_mfma_f32_32x32x16_bf16 v[66:81], v[42:45], a[52:55], v[66:81]
    ds_read_b64_tr_b16 v[38:39], v13 offset:12288
    ds_read_b64_tr_b16 v[40:41], v13 offset:12800
    s_add_u32 s75, s75, 4096
    buffer_load_dwordx4 a[96:99], v2, s[60:63], s75 offen offset:0 sc1
    s_waitcnt vmcnt(10) lgkmcnt(6)
    v_mfma_f32_32x32x16_bf16 v[50:65], v[46:49], a[56:59], v[50:65]
    ds_read_b64_tr_b16 v[42:43], v12 offset:14336
    ds_read_b64_tr_b16 v[44:45], v12 offset:14848
    v_mfma_f32_32x32x16_bf16 v[66:81], v[22:25], a[56:59], v[66:81]
    ds_read_b64_tr_b16 v[46:47], v13 offset:14336
    ds_read_b64_tr_b16 v[48:49], v13 offset:14848
    buffer_load_dwordx4 a[100:103], v2, s[60:63], s75 offen offset:1024 sc1
    s_waitcnt vmcnt(10)
    v_mfma_f32_32x32x16_bf16 v[50:65], v[26:29], a[60:63], v[50:65]
    ds_read_b64_tr_b16 v[22:23], v12 offset:16384
    ds_read_b64_tr_b16 v[24:25], v12 offset:16896
    s_waitcnt lgkmcnt(6)
    v_mfma_f32_32x32x16_bf16 v[66:81], v[30:33], a[60:63], v[66:81]
    ds_read_b64_tr_b16 v[26:27], v13 offset:16384
    ds_read_b64_tr_b16 v[28:29], v13 offset:16896
    buffer_load_dwordx4 a[104:107], v2, s[60:63], s75 offen offset:2048 sc1
    s_waitcnt vmcnt(10)
    v_mfma_f32_32x32x16_bf16 v[50:65], v[34:37], a[64:67], v[50:65]
    ds_read_b64_tr_b16 v[30:31], v12 offset:18432
    ds_read_b64_tr_b16 v[32:33], v12 offset:18944
    v_mfma_f32_32x32x16_bf16 v[66:81], v[38:41], a[64:67], v[66:81]
    ds_read_b64_tr_b16 v[34:35], v13 offset:18432
    ds_read_b64_tr_b16 v[36:37], v13 offset:18944
    buffer_load_dwordx4 a[108:111], v2, s[60:63], s75 offen offset:3072 sc1
    s_waitcnt vmcnt(10) lgkmcnt(6)
    v_mfma_f32_32x32x16_bf16 v[50:65], v[42:45], a[68:71], v[50:65]
    ds_read_b64_tr_b16 v[38:39], v12 offset:20480
    ds_read_b64_tr_b16 v[40:41], v12 offset:20992
    v_mfma_f32_32x32x16_bf16 v[66:81], v[46:49], a[68:71], v[66:81]
    ds_read_b64_tr_b16 v[42:43], v13 offset:20480
    ds_read_b64_tr_b16 v[44:45], v13 offset:20992
    s_add_u32 s75, s75, 4096
    buffer_load_dwordx4 a[112:115], v2, s[60:63], s75 offen offset:0 sc1
    s_waitcnt vmcnt(10)
    v_mfma_f32_32x32x16_bf16 v[50:65], v[22:25], a[72:75], v[50:65]
    ds_read_b64_tr_b16 v[46:47], v12 offset:22528
    ds_read_b64_tr_b16 v[48:49], v12 offset:23040
    s_waitcnt lgkmcnt(6)
    v_mfma_f32_32x32x16_bf16 v[66:81], v[26:29], a[72:75], v[66:81]
    ds_read_b64_tr_b16 v[22:23], v13 offset:22528
    ds_read_b64_tr_b16 v[24:25], v13 offset:23040
    buffer_load_dwordx4 a[116:119], v2, s[60:63], s75 offen offset:1024 sc1
    s_waitcnt vmcnt(10)
    v_mfma_f32_32x32x16_bf16 v[50:65], v[30:33], a[76:79], v[50:65]
    ds_read_b64_tr_b16 v[26:27], v12 offset:24576
    ds_read_b64_tr_b16 v[28:29], v12 offset:25088
    v_mfma_f32_32x32x16_bf16 v[66:81], v[34:37], a[76:79], v[66:81]
    ds_read_b64_tr_b16 v[30:31], v13 offset:24576
    ds_read_b64_tr_b16 v[32:33], v13 offset:25088
    ds_write_b8 v16, v4 offset:72
    s_waitcnt vmcnt(9) lgkmcnt(7)
    v_mfma_f32_32x32x16_bf16 v[50:65], v[38:41], a[80:83], v[50:65]
    ds_read_b64_tr_b16 v[34:35], v12 offset:26624
    ds_read_b64_tr_b16 v[36:37], v12 offset:27136
    v_mfma_f32_32x32x16_bf16 v[66:81], v[42:45], a[80:83], v[66:81]
    ds_read_b64_tr_b16 v[38:39], v13 offset:26624
    ds_read_b64_tr_b16 v[40:41], v13 offset:27136
    s_waitcnt vmcnt(8)
    v_mfma_f32_32x32x16_bf16 v[50:65], v[46:49], a[84:87], v[50:65]
    ds_read_b64_tr_b16 v[42:43], v12 offset:28672
    ds_read_b64_tr_b16 v[44:45], v12 offset:29184
    s_waitcnt lgkmcnt(7)
    v_mfma_f32_32x32x16_bf16 v[66:81], v[22:25], a[84:87], v[66:81]
    ds_read_b64_tr_b16 v[46:47], v13 offset:28672
    ds_read_b64_tr_b16 v[48:49], v13 offset:29184
    s_waitcnt vmcnt(7)
    v_mfma_f32_32x32x16_bf16 v[50:65], v[26:29], a[88:91], v[50:65]
    ds_read_b64_tr_b16 v[22:23], v12 offset:30720
    ds_read_b64_tr_b16 v[24:25], v12 offset:31232
    ds_read_b32 v7, v5 offset:108
    v_mfma_f32_32x32x16_bf16 v[66:81], v[30:33], a[88:91], v[66:81]
    ds_read_b64_tr_b16 v[26:27], v13 offset:30720
    ds_read_b64_tr_b16 v[28:29], v13 offset:31232
    s_waitcnt vmcnt(6) lgkmcnt(7)
    v_mfma_f32_32x32x16_bf16 v[50:65], v[34:37], a[92:95], v[50:65]
    ds_read_b64_tr_b16 v[30:31], v12 offset:32768
    ds_read_b64_tr_b16 v[32:33], v12 offset:33280
    v_mfma_f32_32x32x16_bf16 v[66:81], v[38:41], a[92:95], v[66:81]
    ds_read_b64_tr_b16 v[34:35], v13 offset:32768
    ds_read_b64_tr_b16 v[36:37], v13 offset:33280
    s_waitcnt vmcnt(5)
    v_mfma_f32_32x32x16_bf16 v[50:65], v[42:45], a[96:99], v[50:65]
    ds_read_b64_tr_b16 v[38:39], v12 offset:34816
    ds_read_b64_tr_b16 v[40:41], v12 offset:35328
    s_waitcnt lgkmcnt(6)
    v_mfma_f32_32x32x16_bf16 v[66:81], v[46:49], a[96:99], v[66:81]
    ds_read_b64_tr_b16 v[42:43], v13 offset:34816
    ds_read_b64_tr_b16 v[44:45], v13 offset:35328
    v_cmp_gt_u32 vcc, 16843009, v7
    s_cbranch_vccnz L_GM_p4_spin
L_GM_p4_ok:
    s_waitcnt vmcnt(4)
    v_mfma_f32_32x32x16_bf16 v[50:65], v[22:25], a[100:103], v[50:65]
    ds_read_b64_tr_b16 v[46:47], v12 offset:36864
    ds_read_b64_tr_b16 v[48:49], v12 offset:37376
    v_mfma_f32_32x32x16_bf16 v[66:81], v[26:29], a[100:103], v[66:81]
    ds_read_b64_tr_b16 v[22:23], v13 offset:36864
    ds_read_b64_tr_b16 v[24:25], v13 offset:37376
    s_waitcnt vmcnt(3) lgkmcnt(6)
    v_mfma_f32_32x32x16_bf16 v[50:65], v[30:33], a[104:107], v[50:65]
    ds_read_b64_tr_b16 v[26:27], v12 offset:38912
    ds_read_b64_tr_b16 v[28:29], v12 offset:39424
    v_mfma_f32_32x32x16_bf16 v[66:81], v[34:37], a[104:107], v[66:81]
    ds_read_b64_tr_b16 v[30:31], v13 offset:38912
    ds_read_b64_tr_b16 v[32:33], v13 offset:39424
    s_waitcnt vmcnt(2)
    v_mfma_f32_32x32x16_bf16 v[50:65], v[38:41], a[108:111], v[50:65]
    ds_read_b64_tr_b16 v[34:35], v12 offset:40960
    ds_read_b64_tr_b16 v[36:37], v12 offset:41472
    s_waitcnt lgkmcnt(6)
    v_mfma_f32_32x32x16_bf16 v[66:81], v[42:45], a[108:111], v[66:81]
    ds_read_b64_tr_b16 v[38:39], v12 offset:43008
    ds_read_b64_tr_b16 v[40:41], v12 offset:43520
    s_waitcnt vmcnt(1)
    v_mfma_f32_32x32x16_bf16 v[50:65], v[46:49], a[112:115], v[50:65]
    ds_read_b64_tr_b16 v[42:43], v12 offset:45056
    ds_read_b64_tr_b16 v[44:45], v12 offset:45568
    v_mfma_f32_32x32x16_bf16 v[66:81], v[22:25], a[112:115], v[66:81]
    ds_read_b64_tr_b16 v[46:47], v12 offset:47104
    ds_read_b64_tr_b16 v[48:49], v12 offset:47616
    s_waitcnt vmcnt(0) lgkmcnt(6)
    v_mfma_f32_32x32x16_bf16 v[50:65], v[26:29], a[116:119], v[50:65]
    ds_read_b64_tr_b16 v[22:23], v12 offset:49152
    ds_read_b64_tr_b16 v[24:25], v12 offset:49664
    v_mfma_f32_32x32x16_bf16 v[66:81], v[30:33], a[116:119], v[66:81]
    ds_read_b64_tr_b16 v[26:27], v12 offset:51200
    ds_read_b64_tr_b16 v[28:29], v12 offset:51712
    ds_write_b8 v16, v4 offset:76
    s_nop 5
    v_pk_mul_f32 v[0:1], v[50:51], v[50:51]
    v_pk_mul_f32 v[8:9], v[52:53], v[52:53]
    v_pk_fma_f32 v[0:1], v[0:1], v[18:19], v[18:19] op_sel:[0,0,1] op_sel_hi:[1,0,1]
    v_pk_fma_f32 v[8:9], v[8:9], v[18:19], v[18:19] op_sel:[0,0,1] op_sel_hi:[1,0,1]
    v_pk_mul_f32 v[0:1], v[0:1], v[50:51]
    v_pk_mul_f32 v[8:9], v[8:9], v[52:53]
    v_exp_f32 v0, v0
    v_exp_f32 v1, v1
    v_exp_f32 v8, v8
    v_exp_f32 v9, v9
    v_pk_fma_f32 v[0:1], v[0:1], v[20:21], v[20:21] op_sel_hi:[1,0,0]
    v_pk_fma_f32 v[8:9], v[8:9], v[20:21], v[20:21] op_sel_hi:[1,0,0]
    v_rcp_f32 v0, v0
    v_rcp_f32 v1, v1
    v_rcp_f32 v8, v8
    v_rcp_f32 v9, v9
    v_pk_mul_f32 v[0:1], v[0:1], v[50:51]
    v_pk_mul_f32 v[8:9], v[8:9], v[52:53]
    v_cvt_pk_bf16_f32 v50, v0, v1
    v_cvt_pk_bf16_f32 v51, v8, v9
    v_pk_mul_f32 v[0:1], v[54:55], v[54:55]
    v_pk_mul_f32 v[8:9], v[56:57], v[56:57]
    v_pk_fma_f32 v[0:1], v[0:1], v[18:19], v[18:19] op_sel:[0,0,1] op_sel_hi:[1,0,1]
    v_pk_fma_f32 v[8:9], v[8:9], v[18:19], v[18:19] op_sel:[0,0,1] op_sel_hi:[1,0,1]
    v_pk_mul_f32 v[0:1], v[0:1], v[54:55]
    v_pk_mul_f32 v[8:9], v[8:9], v[56:57]
    v_exp_f32 v0, v0
    v_exp_f32 v1, v1
    v_exp_f32 v8, v8
    v_exp_f32 v9, v9
    v_pk_fma_f32 v[0:1], v[0:1], v[20:21], v[20:21] op_sel_hi:[1,0,0]
    v_pk_fma_f32 v[8:9], v[8:9], v[20:21], v[20:21] op_sel_hi:[1,0,0]
    v_rcp_f32 v0, v0
    v_rcp_f32 v1, v1
    v_rcp_f32 v8, v8
    v_rcp_f32 v9, v9
    v_pk_mul_f32 v[0:1], v[0:1], v[54:55]
    v_pk_mul_f32 v[8:9], v[8:9], v[56:57]
    v_cvt_pk_bf16_f32 v52, v0, v1
    v_cvt_pk_bf16_f32 v53, v8, v9
    buffer_store_dwordx4 v[50:53], v2, s[60:63], s82 offen offset:0 sc1
    v_pk_mul_f32 v[0:1], v[58:59], v[58:59]
    v_pk_mul_f32 v[8:9], v[60:61], v[60:61]
    v_pk_fma_f32 v[0:1], v[0:1], v[18:19], v[18:19] op_sel:[0,0,1] op_sel_hi:[1,0,1]
    v_pk_fma_f32 v[8:9], v[8:9], v[18:19], v[18:19] op_sel:[0,0,1] op_sel_hi:[1,0,1]
    v_pk_mul_f32 v[0:1], v[0:1], v[58:59]
    v_pk_mul_f32 v[8:9], v[8:9], v[60:61]
    v_exp_f32 v0, v0
    v_exp_f32 v1, v1
    v_exp_f32 v8, v8
    v_exp_f32 v9, v9
    v_pk_fma_f32 v[0:1], v[0:1], v[20:21], v[20:21] op_sel_hi:[1,0,0]
    v_pk_fma_f32 v[8:9], v[8:9], v[20:21], v[20:21] op_sel_hi:[1,0,0]
    v_rcp_f32 v0, v0
    v_rcp_f32 v1, v1
    v_rcp_f32 v8, v8
    v_rcp_f32 v9, v9
    v_pk_mul_f32 v[0:1], v[0:1], v[58:59]
    v_pk_mul_f32 v[8:9], v[8:9], v[60:61]
    v_cvt_pk_bf16_f32 v58, v0, v1
    v_cvt_pk_bf16_f32 v59, v8, v9
    v_pk_mul_f32 v[0:1], v[62:63], v[62:63]
    v_pk_mul_f32 v[8:9], v[64:65], v[64:65]
    v_pk_fma_f32 v[0:1], v[0:1], v[18:19], v[18:19] op_sel:[0,0,1] op_sel_hi:[1,0,1]
    v_pk_fma_f32 v[8:9], v[8:9], v[18:19], v[18:19] op_sel:[0,0,1] op_sel_hi:[1,0,1]
    v_pk_mul_f32 v[0:1], v[0:1], v[62:63]
    v_pk_mul_f32 v[8:9], v[8:9], v[64:65]
    v_exp_f32 v0, v0
    v_exp_f32 v1, v1
    v_exp_f32 v8, v8
    v_exp_f32 v9, v9
    v_pk_fma_f32 v[0:1], v[0:1], v[20:21], v[20:21] op_sel_hi:[1,0,0]
    v_pk_fma_f32 v[8:9], v[8:9], v[20:21], v[20:21] op_sel_hi:[1,0,0]
    v_rcp_f32 v0, v0
    v_rcp_f32 v1, v1
    v_rcp_f32 v8, v8
    v_rcp_f32 v9, v9
    v_pk_mul_f32 v[0:1], v[0:1], v[62:63]
    v_pk_mul_f32 v[8:9], v[8:9], v[64:65]
    v_cvt_pk_bf16_f32 v60, v0, v1
    v_cvt_pk_bf16_f32 v61, v8, v9
    buffer_store_dwordx4 v[58:61], v2, s[60:63], s82 offen offset:1024 sc1
    s_nop 1
    v_mfma_f32_32x32x16_bf16 v[50:65], v[90:93], v[82:85], 0
    v_mfma_f32_32x32x16_bf16 v[50:65], v[34:37], v[96:99], v[50:65]
    ds_read_b64_tr_b16 v[30:31], v12 offset:53248
    ds_read_b64_tr_b16 v[32:33], v12 offset:53760
    v_mul_f32 v0, v66, v66
    v_mul_f32 v1, v67, v67
    v_mul_f32 v8, v68, v68
    v_mul_f32 v9, v69, v69
    s_waitcnt lgkmcnt(2)
    v_mfma_f32_32x32x16_bf16 v[50:65], v[38:41], v[100:103], v[50:65]
    ds_read_b64_tr_b16 v[34:35], v12 offset:55296
    ds_read_b64_tr_b16 v[36:37], v12 offset:55808
    v_fma_f32 v0, v0, v18, v19
    v_fma_f32 v1, v1, v18, v19
    v_fma_f32 v8, v8, v18, v19
    v_fma_f32 v9, v9, v18, v19
    v_mfma_f32_32x32x16_bf16 v[50:65], v[42:45], v[104:107], v[50:65]
    ds_read_b64_tr_b16 v[38:39], v12 offset:57344
    ds_read_b64_tr_b16 v[40:41], v12 offset:57856
    v_mul_f32 v0, v0, v66
    v_mul_f32 v1, v1, v67
    v_mul_f32 v8, v8, v68
    v_mul_f32 v9, v9, v69
    v_mfma_f32_32x32x16_bf16 v[50:65], v[46:49], v[108:111], v[50:65]
    ds_read_b64_tr_b16 v[42:43], v12 offset:59392
    ds_read_b64_tr_b16 v[44:45], v12 offset:59904
    v_exp_f32 v0, v0
    v_exp_f32 v1, v1
    v_mfma_f32_32x32x16_bf16 v[50:65], v[22:25], v[112:115], v[50:65]
    ds_read_b64_tr_b16 v[46:47], v14 offset:0
    ds_read_b64_tr_b16 v[48:49], v14 offset:512
    v_exp_f32 v8, v8
    v_exp_f32 v9, v9
    v_mfma_f32_32x32x16_bf16 v[50:65], v[26:29], v[116:119], v[50:65]
    ds_read_b64_tr_b16 v[22:23], v14 offset:2048
    ds_read_b64_tr_b16 v[24:25], v14 offset:2560
    v_fma_f32 v0, v0, v20, v20
    v_fma_f32 v1, v1, v20, v20
    v_fma_f32 v8, v8, v20, v20
    v_fma_f32 v9, v9, v20, v20
    s_waitcnt lgkmcnt(6)
    v_mfma_f32_32x32x16_bf16 v[50:65], v[30:33], v[120:123], v[50:65]
    ds_read_b64_tr_b16 v[26:27], v14 offset:4096
    ds_read_b64_tr_b16 v[28:29], v14 offset:4608
    v_rcp_f32 v0, v0
    v_rcp_f32_e64 v1, v1
    v_mfma_f32_32x32x16_bf16 v[50:65], v[34:37], v[124:127], v[50:65]
    ds_read_b64_tr_b16 v[30:31], v14 offset:6144
    ds_read_b64_tr_b16 v[32:33], v14 offset:6656
    v_rcp_f32 v8, v8
    v_rcp_f32 v9, v9
    v_mfma_f32_32x32x16_bf16 v[50:65], v[38:41], v[128:131], v[50:65]
    ds_read_b64_tr_b16 v[34:35], v14 offset:8192
    ds_read_b64_tr_b16 v[36:37], v14 offset:8704
    v_mul_f32 v0, v0, v66
    v_mul_f32 v1, v1, v67
    v_mul_f32 v8, v8, v68
    v_mul_f32_e64 v9, v9, v69
    s_waitcnt lgkmcnt(6)
    v_mfma_f32_32x32x16_bf16 v[50:65], v[42:45], v[132:135], v[50:65]
    ds_read_b64_tr_b16 v[38:39], v14 offset:10240
    ds_read_b64_tr_b16 v[40:41], v14 offset:10752
    v_cvt_pk_bf16_f32 v66, v0, v1
    v_cvt_pk_bf16_f32 v67, v8, v9
    v_mfma_f32_32x32x16_bf16 v[50:65], v[46:49], a[0:3], v[50:65]
    ds_read_b64_tr_b16 v[42:43], v14 offset:12288
    ds_read_b64_tr_b16 v[44:45], v14 offset:12800
    v_mul_f32 v0, v70, v70
    v_mul_f32 v1, v71, v71
    v_mul_f32 v8, v72, v72
    v_mul_f32 v9, v73, v73
    v_mfma_f32_32x32x16_bf16 v[50:65], v[22:25], a[4:7], v[50:65]
    ds_read_b64_tr_b16 v[46:47], v14 offset:14336
    ds_read_b64_tr_b16 v[48:49], v14 offset:14848
    v_fma_f32 v0, v0, v18, v19
    v_fma_f32 v1, v1, v18, v19
    v_fma_f32 v8, v8, v18, v19
    v_fma_f32 v9, v9, v18, v19
    s_waitcnt lgkmcnt(6)
    v_mfma_f32_32x32x16_bf16 v[50:65], v[26:29], a[8:11], v[50:65]
    ds_read_b64_tr_b16 v[22:23], v14 offset:16384
    ds_read_b64_tr_b16 v[24:25], v14 offset:16896
    v_mul_f32 v0, v0, v70
    v_mul_f32 v1, v1, v71
    v_mul_f32 v8, v8, v72
    v_mul_f32_e64 v9, v9, v73
    v_mfma_f32_32x32x16_bf16 v[50:65], v[30:33], a[12:15], v[50:65]
    ds_read_b64_tr_b16 v[26:27], v14 offset:18432
    ds_read_b64_tr_b16 v[28:29], v14 offset:18944
    v_exp_f32 v0, v0
    v_exp_f32 v1, v1
    v_mfma_f32_32x32x16_bf16 v[50:65], v[34:37], a[16:19], v[50:65]
    ds_read_b64_tr_b16 v[30:31], v14 offset:20480
L_GM_hop1:
    s_cbranch_execz L_GM_ret
    s_nop 0
    ds_read_b64_tr_b16 v[32:33], v14 offset:20992
    v_exp_f32 v8, v8
    v_exp_f32_e64 v9, v9
    s_waitcnt lgkmcnt(6)
    v_mfma_f32_32x32x16_bf16 v[50:65], v[38:41], a[20:23], v[50:65]
    ds_read_b64_tr_b16 v[34:35], v14 offset:22528
    ds_read_b64_tr_b16 v[36:37], v14 offset:23040
    v_fma_f32 v0, v0, v20, v20
    v_fma_f32 v1, v1, v20, v20
    v_fma_f32 v8, v8, v20, v20
    v_fma_f32 v9, v9, v20, v20
    v_mfma_f32_32x32x16_bf16 v[50:65], v[42:45], a[24:27], v[50:65]
    ds_read_b64_tr_b16 v[38:39], v14 offset:24576
    ds_read_b64_tr_b16 v[40:41], v14 offset:25088
    v_rcp_f32 v0, v0
    v_rcp_f32 v1, v1
    v_mfma_f32_32x32x16_bf16 v[50:65], v[46:49], a[28:31], v[50:65]
    ds_read_b64_tr_b16 v[42:43], v14 offset:26624
    ds_read_b64_tr_b16 v[44:45], v14 offset:27136
    v_rcp_f32 v8, v8
    v_rcp_f32_e64 v9, v9
    s_waitcnt lgkmcnt(6)
    v_mfma_f32_32x32x16_bf16 v[50:65], v[22:25], a[32:35], v[50:65]
    ds_read_b64_tr_b16 v[46:47], v14 offset:28672
    ds_read_b64_tr_b16 v[48:49], v14 offset:29184
    v_mul_f32 v0, v0, v70
    v_mul_f32 v1, v1, v71
    v_mul_f32 v8, v8, v72
    v_mul_f32 v9, v9, v73
    v_mfma_f32_32x32x16_bf16 v[50:65], v[26:29], a[36:39], v[50:65]
    ds_read_b64_tr_b16 v[22:23], v14 offset:30720
    ds_read_b64_tr_b16 v[24:25], v14 offset:31232
    s_waitcnt vmcnt(0)
    buffer_store_dword v4, v3, s[60:63], s49 offen offset:0 sc1
    v_cvt_pk_bf16_f32 v68, v0, v1
    v_cvt_pk_bf16_f32 v69, v8, v9
    v_mfma_f32_32x32x16_bf16 v[50:65], v[30:33], a[40:43], v[50:65]
    ds_read_b64_tr_b16 v[26:27], v14 offset:32768
    ds_read_b64_tr_b16 v[28:29], v14 offset:33280
    buffer_store_dwordx4 v[66:69], v2, s[60:63], s82 offen offset:2048 sc1
    v_mul_f32 v0, v74, v74
    v_mul_f32 v1, v75, v75
    v_mul_f32 v8, v76, v76
    v_mul_f32 v9, v77, v77
    s_waitcnt lgkmcnt(6)
    v_mfma_f32_32x32x16_bf16 v[50:65], v[34:37], a[44:47], v[50:65]
    ds_read_b64_tr_b16 v[30:31], v14 offset:34816
    ds_read_b64_tr_b16 v[32:33], v14 offset:35328
    v_fma_f32 v0, v0, v18, v19
    v_fma_f32 v1, v1, v18, v19
    v_fma_f32 v8, v8, v18, v19
    v_fma_f32 v9, v9, v18, v19
    v_mfma_f32_32x32x16_bf16 v[50:65], v[38:41], a[48:51], v[50:65]
    ds_read_b64_tr_b16 v[34:35], v14 offset:36864
    ds_read_b64_tr_b16 v[36:37], v14 offset:37376
    v_mul_f32 v0, v0, v74
    v_mul_f32 v1, v1, v75
    v_mul_f32 v8, v8, v76
    v_mul_f32 v9, v9, v77
    v_mfma_f32_32x32x16_bf16 v[50:65], v[42:45], a[52:55], v[50:65]
    ds_read_b64_tr_b16 v[38:39], v14 offset:38912
    ds_read_b64_tr_b16 v[40:41], v14 offset:39424
    v_exp_f32 v0, v0
    v_exp_f32_e64 v1, v1
    s_waitcnt lgkmcnt(6)
    v_mfma_f32_32x32x16_bf16 v[50:65], v[46:49], a[56:59], v[50:65]
    ds_read_b64_tr_b16 v[42:43], v10 offset:0
    ds_read_b64_tr_b16 v[44:45], v10 offset:512
    v_exp_f32 v8, v8
    v_exp_f32 v9, v9
    v_mfma_f32_32x32x16_bf16 v[50:65], v[22:25], a[60:63], v[50:65]
    ds_read_b64_tr_b16 v[46:47], v10 offset:2048
    ds_read_b64_tr_b16 v[48:49], v10 offset:2560
    v_fma_f32 v0, v0, v20, v20
    v_fma_f32 v1, v1, v20, v20
    v_fma_f32 v8, v8, v20, v20
    v_fma_f32 v9, v9, v20, v20
    v_mfma_f32_32x32x16_bf16 v[50:65], v[26:29], a[64:67], v[50:65]
    ds_read_b64_tr_b16 v[22:23], v10 offset:4096
    ds_read_b64_tr_b16 v[24:25], v10 offset:4608
    v_rcp_f32 v0, v0
    v_rcp_f32_e64 v1, v1
    s_waitcnt lgkmcnt(6)
    v_mfma_f32_32x32x16_bf16 v[50:65], v[30:33], a[68:71], v[50:65]
    ds_read_b64_tr_b16 v[26:27], v10 offset:6144
    ds_read_b64_tr_b16 v[28:29], v10 offset:6656
    v_rcp_f32 v8, v8
    v_rcp_f32 v9, v9
    v_mfma_f32_32x32x16_bf16 v[50:65], v[34:37], a[72:75], v[50:65]
    ds_read_b64_tr_b16 v[30:31], v10 offset:8192
    ds_read_b64_tr_b16 v[32:33], v10 offset:8704
    v_mul_f32 v0, v0, v74
    v_mul_f32 v1, v1, v75
    v_mul_f32 v8, v8, v76
    v_mul_f32 v9, v9, v77
    v_mfma_f32_32x32x16_bf16 v[50:65], v[38:41], a[76:79], v[50:65]
    ds_read_b64_tr_b16 v[34:35], v10 offset:10240
    ds_read_b64_tr_b16 v[36:37], v10 offset:10752
    v_cvt_pk_bf16_f32 v74, v0, v1
    v_cvt_pk_bf16_f32 v75, v8, v9
    s_waitcnt lgkmcnt(6)
    v_mfma_f32_32x32x16_bf16 v[50:65], v[42:45], a[80:83], v[50:65]
    ds_read_b64_tr_b16 v[38:39], v10 offset:12288
    ds_read_b64_tr_b16 v[40:41], v10 offset:12800
    v_mul_f32 v0, v78, v78
    v_mul_f32 v1, v79, v79
    v_mul_f32 v8, v80, v80
    v_mul_f32_e64 v9, v81, v81
    v_mfma_f32_32x32x16_bf16 v[50:65], v[46:49], a[84:87], v[50:65]
    ds_read_b64_tr_b16 v[42:43], v10 offset:14336
    ds_read_b64_tr_b16 v[44:45], v10 offset:14848
    v_fma_f32 v0, v0, v18, v19
    v_fma_f32 v1, v1, v18, v19
    v_fma_f32 v8, v8, v18, v19
    v_fma_f32 v9, v9, v18, v19
    v_mfma_f32_32x32x16_bf16 v[50:65], v[22:25], a[88:91], v[50:65]
    ds_read_b64_tr_b16 v[46:47], v10 offset:16384
    ds_read_b64_tr_b16 v[48:49], v10 offset:16896
    v_mul_f32 v0, v0, v78
    v_mul_f32 v1, v1, v79
    v_mul_f32 v8, v8, v80
    v_mul_f32_e64 v9, v9, v81
    s_waitcnt lgkmcnt(6)
    v_mfma_f32_32x32x16_bf16 v[50:65], v[26:29], a[92:95], v[50:65]
    ds_read_b64_tr_b16 v[22:23], v10 offset:18432
    ds_read_b64_tr_b16 v[24:25], v10 offset:18944
    v_exp_f32 v0, v0
    v_exp_f32 v1, v1
    v_mfma_f32_32x32x16_bf16 v[50:65], v[30:33], a[96:99], v[50:65]
    ds_read_b64_tr_b16 v[26:27], v13 offset:40960
    ds_read_b64_tr_b16 v[28:29], v13 offset:41472
    v_exp_f32 v8, v8
    v_exp_f32 v9, v9
    v_mfma_f32_32x32x16_bf16 v[50:65], v[34:37], a[100:103], v[50:65]
    ds_read_b64_tr_b16 v[30:31], v13 offset:43008
    ds_read_b64_tr_b16 v[32:33], v13 offset:43520
    v_fma_f32 v0, v0, v20, v20
    v_fma_f32 v1, v1, v20, v20
    v_fma_f32 v8, v8, v20, v20
    v_fma_f32 v9, v9, v20, v20
    s_waitcnt lgkmcnt(6)
    v_mfma_f32_32x32x16_bf16 v[50:65], v[38:41], a[104:107], v[50:65]
    ds_read_b64_tr_b16 v[34:35], v13 offset:45056
    ds_read_b64_tr_b16 v[36:37], v13 offset:45568
    v_rcp_f32 v0, v0
    v_rcp_f32_e64 v1, v1
    v_mfma_f32_32x32x16_bf16 v[50:65], v[42:45], a[108:111], v[50:65]
    ds_read_b64_tr_b16 v[38:39], v13 offset:47104
    ds_read_b64_tr_b16 v[40:41], v13 offset:47616
    v_rcp_f32 v8, v8
    v_rcp_f32 v9, v9
    v_mfma_f32_32x32x16_bf16 v[50:65], v[46:49], a[112:115], v[50:65]
    ds_read_b64_tr_b16 v[42:43], v13 offset:49152
    ds_read_b64_tr_b16 v[44:45], v13 offset:49664
    v_mul_f32 v0, v0, v78
    v_mul_f32 v1, v1, v79
    v_mul_f32 v8, v8, v80
    v_mul_f32_e64 v9, v9, v81
    s_waitcnt lgkmcnt(6)
    v_mfma_f32_32x32x16_bf16 v[50:65], v[22:25], a[116:119], v[50:65]
    ds_read_b64_tr_b16 v[46:47], v13 offset:51200
    ds_read_b64_tr_b16 v[48:49], v13 offset:51712
    v_cvt_pk_bf16_f32 v76, v0, v1
    v_cvt_pk_bf16_f32 v77, v8, v9
    buffer_store_dwordx4 v[74:77], v2, s[60:63], s82 offen offset:3072 sc1
    s_nop 1
    v_mfma_f32_32x32x16_bf16 v[66:81], v[88:91], v[84:87], 0
    v_mfma_f32_32x32x16_bf16 v[66:81], v[26:29], v[96:99], v[66:81]
    ds_read_b64_tr_b16 v[22:23], v13 offset:53248
    ds_read_b64_tr_b16 v[24:25], v13 offset:53760
    s_nop 0
    v_mul_f32 v0, v50, v50
    v_mul_f32 v1, v51, v51
    v_mul_f32 v8, v52, v52
    v_mul_f32 v9, v53, v53
    v_mfma_f32_32x32x16_bf16 v[66:81], v[30:33], v[100:103], v[66:81]
    ds_read_b64_tr_b16 v[26:27], v13 offset:55296
    ds_read_b64_tr_b16 v[28:29], v13 offset:55808
    v_fma_f32 v0, v0, v18, v19
    v_fma_f32 v1, v1, v18, v19
    v_fma_f32 v8, v8, v18, v19
    v_fma_f32 v9, v9, v18, v19
    s_waitcnt lgkmcnt(4)
    v_mfma_f32_32x32x16_bf16 v[66:81], v[34:37], v[104:107], v[66:81]
    ds_read_b64_tr_b16 v[30:31], v13 offset:57344
    ds_read_b64_tr_b16 v[32:33], v13 offset:57856
    v_mul_f32 v0, v0, v50
    v_mul_f32 v1, v1, v51
    v_mul_f32 v8, v8, v52
    v_mul_f32_e64 v9, v9, v53
    v_mfma_f32_32x32x16_bf16 v[66:81], v[38:41], v[108:111], v[66:81]
    ds_read_b64_tr_b16 v[34:35], v13 offset:59392
    ds_read_b64_tr_b16 v[36:37], v13 offset:59904
    v_exp_f32 v0, v0
    v_exp_f32 v1, v1
    v_mfma_f32_32x32x16_bf16 v[66:81], v[42:45], v[112:115], v[66:81]
    ds_read_b64_tr_b16 v[38:39], v15 offset:0
    ds_read_b64_tr_b16 v[40:41], v15 offset:512
    v_exp_f32 v8, v8
    v_exp_f32 v9, v9
    v_mfma_f32_32x32x16_bf16 v[66:81], v[46:49], v[116:119], v[66:81]
    ds_read_b64_tr_b16 v[42:43], v15 offset:2048
    ds_read_b64_tr_b16 v[44:45], v15 offset:2560
    v_fma_f32 v0, v0, v20, v20
    v_fma_f32 v1, v1, v20, v20
    v_fma_f32 v8, v8, v20, v20
    v_fma_f32 v9, v9, v20, v20
    s_waitcnt lgkmcnt(6)
    v_mfma_f32_32x32x16_bf16 v[66:81], v[22:25], v[120:123], v[66:81]
    ds_read_b64_tr_b16 v[46:47], v15 offset:4096
    ds_read_b64_tr_b16 v[48:49], v15 offset:4608
    v_rcp_f32 v0, v0
    v_rcp_f32_e64 v1, v1
    v_mfma_f32_32x32x16_bf16 v[66:81], v[26:29], v[124:127], v[66:81]
    ds_read_b64_tr_b16 v[22:23], v15 offset:6144
    ds_read_b64_tr_b16 v[24:25], v15 offset:6656
    v_rcp_f32 v8, v8
    v_rcp_f32 v9, v9
    v_mfma_f32_32x32x16_bf16 v[66:81], v[30:33], v[128:131], v[66:81]
    ds_read_b64_tr_b16 v[26:27], v15 offset:8192
    ds_read_b64_tr_b16 v[28:29], v15 offset:8704
    v_mul_f32 v0, v0, v50
    v_mul_f32 v1, v1, v51
    v_mul_f32 v8, v8, v52
    v_mul_f32_e64 v9, v9, v53
    s_waitcnt lgkmcnt(6)
    v_mfma_f32_32x32x16_bf16 v[66:81], v[34:37], v[132:135], v[66:81]
    ds_read_b64_tr_b16 v[30:31], v15 offset:10240
    ds_read_b64_tr_b16 v[32:33], v15 offset:10752
    ds_write_b8 v16, v4 offset:80
    v_cvt_pk_bf16_f32 v50, v0, v1
    v_cvt_pk_bf16_f32 v51, v8, v9
    v_mfma_f32_32x32x16_bf16 v[66:81], v[38:41], a[0:3], v[66:81]
    ds_read_b64_tr_b16 v[34:35], v15 offset:12288
    ds_read_b64_tr_b16 v[36:37], v15 offset:12800
    v_mul_f32 v0, v54, v54
    v_mul_f32 v1, v55, v55
    v_mul_f32 v8, v56, v56
    v_mul_f32 v9, v57, v57
    v_mfma_f32_32x32x16_bf16 v[66:81], v[42:45], a[4:7], v[66:81]
    ds_read_b64_tr_b16 v[38:39], v15 offset:14336
    ds_read_b64_tr_b16 v[40:41], v15 offset:14848
    v_fma_f32 v0, v0, v18, v19
    v_fma_f32 v1, v1, v18, v19
    v_fma_f32 v8, v8, v18, v19
    v_fma_f32 v9, v9, v18, v19
    s_waitcnt lgkmcnt(7)
    v_mfma_f32_32x32x16_bf16 v[66:81], v[46:49], a[8:11], v[66:81]
    ds_read_b64_tr_b16 v[42:43], v15 offset:16384
    ds_read_b64_tr_b16 v[44:45], v15 offset:16896
    v_mul_f32 v0, v0, v54
    v_mul_f32 v1, v1, v55
    v_mul_f32 v8, v8, v56
    v_mul_f32_e64 v9, v9, v57
    v_mfma_f32_32x32x16_bf16 v[66:81], v[22:25], a[12:15], v[66:81]
    ds_read_b64_tr_b16 v[46:47], v15 offset:18432
    ds_read_b64_tr_b16 v[48:49], v15 offset:18944
    v_exp_f32 v0, v0
    v_exp_f32 v1, v1
    v_mfma_f32_32x32x16_bf16 v[66:81], v[26:29], a[16:19], v[66:81]
    ds_read_b64_tr_b16 v[22:23], v15 offset:20480
    ds_read_b64_tr_b16 v[24:25], v15 offset:20992
    v_exp_f32 v8, v8
    v_exp_f32_e64 v9, v9
    s_waitcnt lgkmcnt(6)
    v_mfma_f32_32x32x16_bf16 v[66:81], v[30:33], a[20:23], v[66:81]
    ds_read_b64_tr_b16 v[26:27], v15 offset:22528
    ds_read_b64_tr_b16 v[28:29], v15 offset:23040
    v_fma_f32 v0, v0, v20, v20
    v_fma_f32 v1, v1, v20, v20
    v_fma_f32 v8, v8, v20, v20
    v_fma_f32 v9, v9, v20, v20
    v_mfma_f32_32x32x16_bf16 v[66:81], v[34:37], a[24:27], v[66:81]
    ds_read_b64_tr_b16 v[30:31], v15 offset:24576
    ds_read_b64_tr_b16 v[32:33], v15 offset:25088
    v_rcp_f32 v0, v0
    v_rcp_f32 v1, v1
    v_mfma_f32_32x32x16_bf16 v[66:81], v[38:41], a[28:31], v[66:81]
    ds_read_b64_tr_b16 v[34:35], v15 offset:26624
    ds_read_b64_tr_b16 v[36:37], v15 offset:27136
    v_rcp_f32 v8, v8
    v_rcp_f32_e64 v9, v9
    s_waitcnt lgkmcnt(6)
    v_mfma_f32_32x32x16_bf16 v[66:81], v[42:45], a[32:35], v[66:81]
    ds_read_b64_tr_b16 v[38:39], v15 offset:28672
    ds_read_b64_tr_b16 v[40:41], v15 offset:29184
    v_mul_f32 v0, v0, v54
    v_mul_f32 v1, v1, v55
    v_mul_f32 v8, v8, v56
    v_mul_f32 v9, v9, v57
    v_mfma_f32_32x32x16_bf16 v[66:81], v[46:49], a[36:39], v[66:81]
    ds_read_b64_tr_b16 v[42:43], v15 offset:30720
    ds_read_b64_tr_b16 v[44:45], v15 offset:31232
    s_waitcnt vmcnt(0)
    buffer_store_dword v4, v3, s[60:63], s49 offen offset:256 sc1
    v_cvt_pk_bf16_f32 v52, v0, v1
    v_cvt_pk_bf16_f32 v53, v8, v9
    v_mfma_f32_32x32x16_bf16 v[66:81], v[22:25], a[40:43], v[66:81]
    ds_read_b64_tr_b16 v[46:47], v15 offset:32768
    ds_read_b64_tr_b16 v[48:49], v15 offset:33280
    s_add_u32 s82, s82, 4096
    buffer_store_dwordx4 v[50:53], v2, s[60:63], s82 offen offset:0 sc1
    v_mul_f32 v0, v58, v58
    v_mul_f32 v1, v59, v59
    v_mul_f32 v8, v60, v60
    v_mul_f32 v9, v61, v61
    s_waitcnt lgkmcnt(6)
    v_mfma_f32_32x32x16_bf16 v[66:81], v[26:29], a[44:47], v[66:81]
    ds_read_b64_tr_b16 v[22:23], v15 offset:34816
    ds_read_b64_tr_b16 v[24:25], v15 offset:35328
    v_fma_f32 v0, v0, v18, v19
    v_fma_f32 v1, v1, v18, v19
    v_fma_f32 v8, v8, v18, v19
    v_fma_f32 v9, v9, v18, v19
    v_mfma_f32_32x32x16_bf16 v[66:81], v[30:33], a[48:51], v[66:81]
    ds_read_b64_tr_b16 v[26:27], v15 offset:36864
    ds_read_b64_tr_b16 v[28:29], v15 offset:37376
    v_mul_f32 v0, v0, v58
    v_mul_f32 v1, v1, v59
    v_mul_f32 v8, v8, v60
    v_mul_f32 v9, v9, v61
    v_mfma_f32_32x32x16_bf16 v[66:81], v[34:37], a[52:55], v[66:81]
    ds_read_b64_tr_b16 v[30:31], v15 offset:38912
    ds_read_b64_tr_b16 v[32:33], v15 offset:39424
    v_exp_f32 v0, v0
    v_exp_f32_e64 v1, v1
    s_waitcnt lgkmcnt(6)
    v_mfma_f32_32x32x16_bf16 v[66:81], v[38:41], a[56:59], v[66:81]
    ds_read_b64_tr_b16 v[34:35], v11 offset:0
    ds_read_b64_tr_b16 v[36:37], v11 offset:512
    ds_read_b32 v7, v5 offset:112
    v_exp_f32 v8, v8
    v_exp_f32 v9, v9
    v_mfma_f32_32x32x16_bf16 v[66:81], v[42:45], a[60:63], v[66:81]
    ds_read_b64_tr_b16 v[38:39], v11 offset:2048
    ds_read_b64_tr_b16 v[40:41], v11 offset:2560
    v_fma_f32 v0, v0, v20, v20
    v_fma_f32 v1, v1, v20, v20
    v_fma_f32 v8, v8, v20, v20
    v_fma_f32 v9, v9, v20, v20
    v_mfma_f32_32x32x16_bf16 v[66:81], v[46:49], a[64:67], v[66:81]
    ds_read_b64_tr_b16 v[42:43], v11 offset:4096
    ds_read_b64_tr_b16 v[44:45], v11 offset:4608
    v_rcp_f32 v0, v0
    v_rcp_f32_e64 v1, v1
    s_waitcnt lgkmcnt(7)
    v_mfma_f32_32x32x16_bf16 v[66:81], v[22:25], a[68:71], v[66:81]
    ds_read_b64_tr_b16 v[46:47], v11 offset:6144
    ds_read_b64_tr_b16 v[48:49], v11 offset:6656
    v_rcp_f32 v8, v8
    v_rcp_f32 v9, v9
    v_mfma_f32_32x32x16_bf16 v[66:81], v[26:29], a[72:75], v[66:81]
    ds_read_b64_tr_b16 v[22:23], v11 offset:8192
    ds_read_b64_tr_b16 v[24:25], v11 offset:8704
    v_mul_f32 v0, v0, v58
    v_mul_f32 v1, v1, v59
    v_mul_f32 v8, v8, v60
    v_mul_f32 v9, v9, v61
    v_mfma_f32_32x32x16_bf16 v[66:81], v[30:33], a[76:79], v[66:81]
    ds_read_b64_tr_b16 v[26:27], v11 offset:10240
    ds_read_b64_tr_b16 v[28:29], v11 offset:10752
    ds_write_b8 v16, v4 offset:84
    v_cvt_pk_bf16_f32 v58, v0, v1
    v_cvt_pk_bf16_f32 v59, v8, v9
    s_waitcnt lgkmcnt(9)
    v_cmp_gt_u32 vcc, 16843009, v7
    s_cbranch_vccnz L_GM_p5_spin
L_GM_p5_ok:
    v_mfma_f32_32x32x16_bf16 v[66:81], v[34:37], a[80:83], v[66:81]
    ds_read_b64_tr_b16 v[30:31], v11 offset:12288
    ds_read_b64_tr_b16 v[32:33], v11 offset:12800
    v_mul_f32 v0, v62, v62
    v_mul_f32 v1, v63, v63
    v_mul_f32 v8, v64, v64
    v_mul_f32 v9, v65, v65
    v_mfma_f32_32x32x16_bf16 v[66:81], v[38:41], a[84:87], v[66:81]
    ds_read_b64_tr_b16 v[34:35], v11 offset:14336
    ds_read_b64_tr_b16 v[36:37], v11 offset:14848
    v_fma_f32 v0, v0, v18, v19
    v_fma_f32 v1, v1, v18, v19
    v_fma_f32 v8, v8, v18, v19
    v_fma_f32 v9, v9, v18, v19
    s_waitcnt lgkmcnt(7)
    v_mfma_f32_32x32x16_bf16 v[66:81], v[42:45], a[88:91], v[66:81]
    ds_read_b64_tr_b16 v[38:39], v11 offset:16384
    ds_read_b64_tr_b16 v[40:41], v11 offset:16896
    v_mul_f32 v0, v0, v62
    v_mul_f32 v1, v1, v63
    v_mul_f32 v8, v8, v64
    v_mul_f32_e64 v9, v9, v65
    v_mfma_f32_32x32x16_bf16 v[66:81], v[46:49], a[92:95], v[66:81]
    ds_read_b64_tr_b16 v[42:43], v11 offset:18432
    ds_read_b64_tr_b16 v[44:45], v11 offset:18944
    v_exp_f32 v0, v0
    v_exp_f32 v1, v1
    v_mfma_f32_32x32x16_bf16 v[66:81], v[22:25], a[96:99], v[66:81]
    ds_read_b64_tr_b16 v[46:47], v10 offset:40960
    ds_read_b64_tr_b16 v[48:49], v10 offset:41472
    v_exp_f32 v8, v8
    v_exp_f32_e64 v9, v9
    s_waitcnt lgkmcnt(6)
    v_mfma_f32_32x32x16_bf16 v[66:81], v[26:29], a[100:103], v[66:81]
    ds_read_b64_tr_b16 v[22:23], v10 offset:43008
    ds_read_b64_tr_b16 v[24:25], v10 offset:43520
    v_fma_f32 v0, v0, v20, v20
    v_fma_f32 v1, v1, v20, v20
    v_fma_f32 v8, v8, v20, v20
    v_fma_f32 v9, v9, v20, v20
    v_mfma_f32_32x32x16_bf16 v[66:81], v[30:33], a[104:107], v[66:81]
    ds_read_b64_tr_b16 v[26:27], v10 offset:45056
    ds_read_b64_tr_b16 v[28:29], v10 offset:45568
    v_rcp_f32 v0, v0
    v_rcp_f32 v1, v1
    v_mfma_f32_32x32x16_bf16 v[66:81], v[34:37], a[108:111], v[66:81]
    ds_read_b64_tr_b16 v[30:31], v10 offset:47104
    ds_read_b64_tr_b16 v[32:33], v10 offset:47616
    v_rcp_f32 v8, v8
    v_rcp_f32_e64 v9, v9
    s_waitcnt lgkmcnt(6)
    v_mfma_f32_32x32x16_bf16 v[66:81], v[38:41], a[112:115], v[66:81]
    ds_read_b64_tr_b16 v[34:35], v10 offset:49152
    ds_read_b64_tr_b16 v[36:37], v10 offset:49664
    v_mul_f32 v0, v0, v62
    v_mul_f32 v1, v1, v63
    v_mul_f32 v8, v8, v64
    v_mul_f32 v9, v9, v65
    v_mfma_f32_32x32x16_bf16 v[66:81], v[42:45], a[116:119], v[66:81]
    ds_read_b64_tr_b16 v[38:39], v10 offset:51200
    ds_read_b64_tr_b16 v[40:41], v10 offset:51712
    ds_write_b8 v16, v4 offset:88
    v_cvt_pk_bf16_f32 v60, v0, v1
    v_cvt_pk_bf16_f32 v61, v8, v9
    buffer_store_dwordx4 v[58:61], v2, s[60:63], s82 offen offset:1024 sc1
    s_nop 1
    v_mfma_f32_32x32x16_bf16 v[50:65], v[92:95], v[82:85], 0
    v_mfma_f32_32x32x16_bf16 v[50:65], v[46:49], v[96:99], v[50:65]
    ds_read_b64_tr_b16 v[42:43], v10 offset:53248
    ds_read_b64_tr_b16 v[44:45], v10 offset:53760
    v_mul_f32 v0, v66, v66
    v_mul_f32 v1, v67, v67
    v_mul_f32 v8, v68, v68
    v_mul_f32 v9, v69, v69
    s_waitcnt lgkmcnt(5)
    v_mfma_f32_32x32x16_bf16 v[50:65], v[22:25], v[100:103], v[50:65]
    ds_read_b64_tr_b16 v[46:47], v10 offset:55296
    ds_read_b64_tr_b16 v[48:49], v10 offset:55808
    v_fma_f32 v0, v0, v18, v19
    v_fma_f32 v1, v1, v18, v19
    v_fma_f32 v8, v8, v18, v19
    v_fma_f32 v9, v9, v18, v19
    v_mfma_f32_32x32x16_bf16 v[50:65], v[26:29], v[104:107], v[50:65]
    ds_read_b64_tr_b16 v[22:23], v10 offset:57344
    ds_read_b64_tr_b16 v[24:25], v10 offset:57856
    v_mul_f32 v0, v0, v66
    v_mul_f32 v1, v1, v67
    v_mul_f32 v8, v8, v68
    v_mul_f32 v9, v9, v69
    v_mfma_f32_32x32x16_bf16 v[50:65], v[30:33], v[108:111], v[50:65]
    ds_read_b64_tr_b16 v[26:27], v10 offset:59392
    ds_read_b64_tr_b16 v[28:29], v10 offset:59904
    v_exp_f32 v0, v0
    v_exp_f32 v1, v1
    v_mfma_f32_32x32x16_bf16 v[50:65], v[34:37], v[112:115], v[50:65]
    ds_read_b64_tr_b16 v[30:31], v12 offset:0
    ds_read_b64_tr_b16 v[32:33], v12 offset:512
    v_exp_f32 v8, v8
    v_exp_f32_e64 v9, v9
    s_waitcnt lgkmcnt(6)
    v_mfma_f32_32x32x16_bf16 v[50:65], v[38:41], v[116:119], v[50:65]
    ds_read_b64_tr_b16 v[34:35], v12 offset:2048
    ds_read_b64_tr_b16 v[36:37], v12 offset:2560
    v_fma_f32 v0, v0, v20, v20
    v_fma_f32 v1, v1, v20, v20
    v_fma_f32 v8, v8, v20, v20
    v_fma_f32 v9, v9, v20, v20
    v_mfma_f32_32x32x16_bf16 v[50:65], v[42:45], v[120:123], v[50:65]
    ds_read_b64_tr_b16 v[38:39], v12 offset:4096
    ds_read_b64_tr_b16 v[40:41], v12 offset:4608
    v_rcp_f32 v0, v0
    v_rcp_f32 v1, v1
    v_mfma_f32_32x32x16_bf16 v[50:65], v[46:49], v[124:127], v[50:65]
    ds_read_b64_tr_b16 v[42:43], v12 offset:6144
    ds_read_b64_tr_b16 v[44:45], v12 offset:6656
    v_rcp_f32 v8, v8
    v_rcp_f32_e64 v9, v9
    s_waitcnt lgkmcnt(6)
    v_mfma_f32_32x32x16_bf16 v[50:65], v[22:25], v[128:131], v[50:65]
    ds_read_b64_tr_b16 v[46:47], v12 offset:8192
    ds_read_b64_tr_b16 v[48:49], v12 offset:8704
    v_mul_f32 v0, v0, v66
    v_mul_f32 v1, v1, v67
    v_mul_f32 v8, v8, v68
    v_mul_f32 v9, v9, v69
    v_mfma_f32_32x32x16_bf16 v[50:65], v[26:29], v[132:135], v[50:65]
    ds_read_b64_tr_b16 v[22:23], v12 offset:10240
    ds_read_b64_tr_b16 v[24:25], v12 offset:10752
    v_cvt_pk_bf16_f32 v66, v0, v1
    v_cvt_pk_bf16_f32 v67, v8, v9
    v_mfma_f32_32x32x16_bf16 v[50:65], v[30:33], a[0:3], v[50:65]
    ds_read_b64_tr_b16 v[26:27], v12 offset:12288
    ds_read_b64_tr_b16 v[28:29], v12 offset:12800
    v_mul_f32 v0, v70, v70
    v_mul_f32 v1, v71, v71
    v_mul_f32 v8, v72, v72
    v_mul_f32_e64 v9, v73, v73
    s_waitcnt lgkmcnt(6)
    v_mfma_f32_32x32x16_bf16 v[50:65], v[34:37], a[4:7], v[50:65]
    ds_read_b64_tr_b16 v[30:31], v12 offset:14336
    ds_read_b64_tr_b16 v[32:33], v12 offset:14848
    v_fma_f32 v0, v0, v18, v19
    v_fma_f32 v1, v1, v18, v19
    v_fma_f32 v8, v8, v18, v19
    v_fma_f32 v9, v9, v18, v19
    v_mfma_f32_32x32x16_bf16 v[50:65], v[38:41], a[8:11], v[50:65]
    ds_read_b64_tr_b16 v[34:35], v12 offset:16384
    ds_read_b64_tr_b16 v[36:37], v12 offset:16896
    v_mul_f32 v0, v0, v70
    v_mul_f32 v1, v1, v71
    v_mul_f32 v8, v8, v72
    v_mul_f32 v9, v9, v73
    v_mfma_f32_32x32x16_bf16 v[50:65], v[42:45], a[12:15], v[50:65]
    ds_read_b64_tr_b16 v[38:39], v12 offset:18432
    ds_read_b64_tr_b16 v[40:41], v12 offset:18944
    v_exp_f32 v0, v0
    v_exp_f32_e64 v1, v1
    s_waitcnt lgkmcnt(6)
    v_mfma_f32_32x32x16_bf16 v[50:65], v[46:49], a[16:19], v[50:65]
    ds_read_b64_tr_b16 v[42:43], v12 offset:20480
    ds_read_b64_tr_b16 v[44:45], v12 offset:20992
    ds_read_b32 v7, v5 offset:116
    v_exp_f32 v8, v8
    v_exp_f32 v9, v9
    v_mfma_f32_32x32x16_bf16 v[50:65], v[22:25], a[20:23], v[50:65]
    ds_read_b64_tr_b16 v[46:47], v12 offset:22528
    ds_read_b64_tr_b16 v[48:49], v12 offset:23040
    v_fma_f32 v0, v0, v20, v20
    v_fma_f32 v1, v1, v20, v20
    v_fma_f32 v8, v8, v20, v20
    v_fma_f32 v9, v9, v20, v20
    v_mfma_f32_32x32x16_bf16 v[50:65], v[26:29], a[24:27], v[50:65]
    ds_read_b64_tr_b16 v[22:23], v12 offset:24576
    ds_read_b64_tr_b16 v[24:25], v12 offset:25088
    v_rcp_f32 v0, v0
    v_rcp_f32_e64 v1, v1
    s_waitcnt lgkmcnt(7)
    v_mfma_f32_32x32x16_bf16 v[50:65], v[30:33], a[28:31], v[50:65]
    ds_read_b64_tr_b16 v[26:27], v12 offset:26624
    ds_read_b64_tr_b16 v[28:29], v12 offset:27136
    v_rcp_f32 v8, v8
    v_rcp_f32 v9, v9
    v_mfma_f32_32x32x16_bf16 v[50:65], v[34:37], a[32:35], v[50:65]
    ds_read_b64_tr_b16 v[30:31], v12 offset:28672
    ds_read_b64_tr_b16 v[32:33], v12 offset:29184
    v_mul_f32 v0, v0, v70
    v_mul_f32 v1, v1, v71
    v_mul_f32 v8, v8, v72
    v_mul_f32 v9, v9, v73
    v_mfma_f32_32x32x16_bf16 v[50:65], v[38:41], a[36:39], v[50:65]
    ds_read_b64_tr_b16 v[34:35], v12 offset:30720
    ds_read_b64_tr_b16 v[36:37], v12 offset:31232
    s_waitcnt vmcnt(0)
    buffer_store_dword v4, v3, s[60:63], s49 offen offset:512 sc1
    v_cvt_pk_bf16_f32 v68, v0, v1
    v_cvt_pk_bf16_f32 v69, v8, v9
    s_waitcnt lgkmcnt(8)
    v_cmp_gt_u32 vcc, 16843009, v7
    s_cbranch_vccnz L_GM_p6_spin
L_GM_p6_ok:
    v_mfma_f32_32x32x16_bf16 v[50:65], v[42:45], a[40:43], v[50:65]
    ds_read_b64_tr_b16 v[38:39], v12 offset:32768
    ds_read_b64_tr_b16 v[40:41], v12 offset:33280
    buffer_store_dwordx4 v[66:69], v2, s[60:63], s82 offen offset:2048 sc1
    v_mul_f32 v0, v74, v74
    v_mul_f32 v1, v75, v75
    v_mul_f32 v8, v76, v76
    v_mul_f32_e64 v9, v77, v77
    v_mfma_f32_32x32x16_bf16 v[50:65], v[46:49], a[44:47], v[50:65]
    ds_read_b64_tr_b16 v[42:43], v12 offset:34816
    ds_read_b64_tr_b16 v[44:45], v12 offset:35328
    v_fma_f32 v0, v0, v18, v19
    v_fma_f32 v1, v1, v18, v19
    v_fma_f32 v8, v8, v18, v19
    v_fma_f32 v9, v9, v18, v19
    s_waitcnt lgkmcnt(6)
    v_mfma_f32_32x32x16_bf16 v[50:65], v[22:25], a[48:51], v[50:65]
    ds_read_b64_tr_b16 v[46:47], v12 offset:36864
    ds_read_b64_tr_b16 v[48:49], v12 offset:37376
    v_mul_f32 v0, v0, v74
    v_mul_f32 v1, v1, v75
    v_mul_f32 v8, v8, v76
    v_mul_f32_e64 v9, v9, v77
    v_mfma_f32_32x32x16_bf16 v[50:65], v[26:29], a[52:55], v[50:65]
    ds_read_b64_tr_b16 v[22:23], v12 offset:38912
    ds_read_b64_tr_b16 v[24:25], v12 offset:39424
    v_exp_f32 v0, v0
    v_exp_f32 v1, v1
    v_mfma_f32_32x32x16_bf16 v[50:65], v[30:33], a[56:59], v[50:65]
    ds_read_b64_tr_b16 v[26:27], v12 offset:40960
    ds_read_b64_tr_b16 v[28:29], v12 offset:41472
    v_exp_f32 v8, v8
    v_exp_f32_e64 v9, v9
    s_waitcnt lgkmcnt(6)
    v_mfma_f32_32x32x16_bf16 v[50:65], v[34:37], a[60:63], v[50:65]
    ds_read_b64_tr_b16 v[30:31], v12 offset:43008
    ds_read_b64_tr_b16 v[32:33], v12 offset:43520
    v_fma_f32 v0, v0, v20, v20
    v_fma_f32 v1, v1, v20, v20
    v_fma_f32 v8, v8, v20, v20
    v_fma_f32 v9, v9, v20, v20
    v_mfma_f32_32x32x16_bf16 v[50:65], v[38:41], a[64:67], v[50:65]
L_GM_hop2:
    s_cbranch_execz L_GM_ret
    s_nop 0
    ds_read_b64_tr_b16 v[34:35], v12 offset:45056
    ds_read_b64_tr_b16 v[36:37], v12 offset:45568
    v_rcp_f32 v0, v0
    v_rcp_f32 v1, v1
    v_mfma_f32_32x32x16_bf16 v[50:65], v[42:45], a[68:71], v[50:65]
    ds_read_b64_tr_b16 v[38:39], v12 offset:47104
    ds_read_b64_tr_b16 v[40:41], v12 offset:47616
    v_rcp_f32 v8, v8
    v_rcp_f32_e64 v9, v9
    s_waitcnt lgkmcnt(6)
    v_mfma_f32_32x32x16_bf16 v[50:65], v[46:49], a[72:75], v[50:65]
    ds_read_b64_tr_b16 v[42:43], v12 offset:49152
    ds_read_b64_tr_b16 v[44:45], v12 offset:49664
    v_mul_f32 v0, v0, v74
    v_mul_f32 v1, v1, v75
    v_mul_f32 v8, v8, v76
    v_mul_f32 v9, v9, v77
    v_mfma_f32_32x32x16_bf16 v[50:65], v[22:25], a[76:79], v[50:65]
    ds_read_b64_tr_b16 v[46:47], v12 offset:51200
    ds_read_b64_tr_b16 v[48:49], v12 offset:51712
    v_cvt_pk_bf16_f32 v74, v0, v1
    v_cvt_pk_bf16_f32 v75, v8, v9
    v_mfma_f32_32x32x16_bf16 v[50:65], v[26:29], a[80:83], v[50:65]
    ds_read_b64_tr_b16 v[22:23], v12 offset:53248
    ds_read_b64_tr_b16 v[24:25], v12 offset:53760
    v_mul_f32 v0, v78, v78
    v_mul_f32 v1, v79, v79
    v_mul_f32 v8, v80, v80
    v_mul_f32_e64 v9, v81, v81
    s_waitcnt lgkmcnt(6)
    v_mfma_f32_32x32x16_bf16 v[50:65], v[30:33], a[84:87], v[50:65]
    ds_read_b64_tr_b16 v[26:27], v12 offset:55296
    ds_read_b64_tr_b16 v[28:29], v12 offset:55808
    v_fma_f32 v0, v0, v18, v19
    v_fma_f32 v1, v1, v18, v19
    v_fma_f32 v8, v8, v18, v19
    v_fma_f32 v9, v9, v18, v19
    v_mfma_f32_32x32x16_bf16 v[50:65], v[34:37], a[88:91], v[50:65]
    ds_read_b64_tr_b16 v[30:31], v12 offset:57344
    ds_read_b64_tr_b16 v[32:33], v12 offset:57856
    v_mul_f32 v0, v0, v78
    v_mul_f32 v1, v1, v79
    v_mul_f32 v8, v8, v80
    v_mul_f32 v9, v9, v81
    v_mfma_f32_32x32x16_bf16 v[50:65], v[38:41], a[92:95], v[50:65]
    ds_read_b64_tr_b16 v[34:35], v12 offset:59392
    ds_read_b64_tr_b16 v[36:37], v12 offset:59904
    v_exp_f32 v0, v0
    v_exp_f32_e64 v1, v1
    s_waitcnt lgkmcnt(6)
    v_mfma_f32_32x32x16_bf16 v[50:65], v[42:45], a[96:99], v[50:65]
    ds_read_b64_tr_b16 v[38:39], v11 offset:40960
    ds_read_b64_tr_b16 v[40:41], v11 offset:41472
    v_exp_f32 v8, v8
    v_exp_f32 v9, v9
    v_mfma_f32_32x32x16_bf16 v[50:65], v[46:49], a[100:103], v[50:65]
    ds_read_b64_tr_b16 v[42:43], v11 offset:43008
    ds_read_b64_tr_b16 v[44:45], v11 offset:43520
    v_fma_f32 v0, v0, v20, v20
    v_fma_f32 v1, v1, v20, v20
    v_fma_f32 v8, v8, v20, v20
    v_fma_f32 v9, v9, v20, v20
    v_mfma_f32_32x32x16_bf16 v[50:65], v[22:25], a[104:107], v[50:65]
    ds_read_b64_tr_b16 v[46:47], v11 offset:45056
    ds_read_b64_tr_b16 v[48:49], v11 offset:45568
    v_rcp_f32 v0, v0
    v_rcp_f32_e64 v1, v1
    s_waitcnt lgkmcnt(6)
    v_mfma_f32_32x32x16_bf16 v[50:65], v[26:29], a[108:111], v[50:65]
    ds_read_b64_tr_b16 v[22:23], v11 offset:47104
    ds_read_b64_tr_b16 v[24:25], v11 offset:47616
    v_rcp_f32 v8, v8
    v_rcp_f32 v9, v9
    v_mfma_f32_32x32x16_bf16 v[50:65], v[30:33], a[112:115], v[50:65]
    ds_read_b64_tr_b16 v[26:27], v11 offset:49152
    ds_read_b64_tr_b16 v[28:29], v11 offset:49664
    v_mul_f32 v0, v0, v78
    v_mul_f32 v1, v1, v79
    v_mul_f32 v8, v8, v80
    v_mul_f32 v9, v9, v81
    v_mfma_f32_32x32x16_bf16 v[50:65], v[34:37], a[116:119], v[50:65]
    ds_read_b64_tr_b16 v[30:31], v11 offset:51200
    ds_read_b64_tr_b16 v[32:33], v11 offset:51712
    v_cvt_pk_bf16_f32 v76, v0, v1
    v_cvt_pk_bf16_f32 v77, v8, v9
    buffer_store_dwordx4 v[74:77], v2, s[60:63], s82 offen offset:3072 sc1
    s_nop 1
    v_mfma_f32_32x32x16_bf16 v[66:81], v[90:93], v[84:87], 0
    s_waitcnt lgkmcnt(4)
    v_mfma_f32_32x32x16_bf16 v[66:81], v[38:41], v[96:99], v[66:81]
    ds_read_b64_tr_b16 v[34:35], v11 offset:53248
    ds_read_b64_tr_b16 v[36:37], v11 offset:53760
    v_mul_f32 v0, v50, v50
    v_mul_f32 v1, v51, v51
    v_mul_f32 v8, v52, v52
    v_mul_f32 v9, v53, v53
    v_mfma_f32_32x32x16_bf16 v[66:81], v[42:45], v[100:103], v[66:81]
    ds_read_b64_tr_b16 v[38:39], v11 offset:55296
    ds_read_b64_tr_b16 v[40:41], v11 offset:55808
    v_fma_f32 v0, v0, v18, v19
    v_fma_f32 v1, v1, v18, v19
    v_fma_f32 v8, v8, v18, v19
    v_fma_f32 v9, v9, v18, v19
    v_mfma_f32_32x32x16_bf16 v[66:81], v[46:49], v[104:107], v[66:81]
    ds_read_b64_tr_b16 v[42:43], v11 offset:57344
    ds_read_b64_tr_b16 v[44:45], v11 offset:57856
    v_mul_f32 v0, v0, v50
    v_mul_f32 v1, v1, v51
    v_mul_f32 v8, v8, v52
    v_mul_f32 v9, v9, v53
    v_mfma_f32_32x32x16_bf16 v[66:81], v[22:25], v[108:111], v[66:81]
    ds_read_b64_tr_b16 v[46:47], v11 offset:59392
    ds_read_b64_tr_b16 v[48:49], v11 offset:59904
    v_exp_f32 v0, v0
    v_exp_f32_e64 v1, v1
    s_waitcnt lgkmcnt(6)
    v_mfma_f32_32x32x16_bf16 v[66:81], v[26:29], v[112:115], v[66:81]
    ds_read_b64_tr_b16 v[22:23], v13 offset:0
    ds_read_b64_tr_b16 v[24:25], v13 offset:512
    v_exp_f32 v8, v8
    v_exp_f32 v9, v9
    v_mfma_f32_32x32x16_bf16 v[66:81], v[30:33], v[116:119], v[66:81]
    ds_read_b64_tr_b16 v[26:27], v13 offset:2048
    ds_read_b64_tr_b16 v[28:29], v13 offset:2560
    v_fma_f32 v0, v0, v20, v20
    v_fma_f32 v1, v1, v20, v20
    v_fma_f32 v8, v8, v20, v20
    v_fma_f32 v9, v9, v20, v20
    v_mfma_f32_32x32x16_bf16 v[66:81], v[34:37], v[120:123], v[66:81]
    ds_read_b64_tr_b16 v[30:31], v13 offset:4096
    ds_read_b64_tr_b16 v[32:33], v13 offset:4608
    v_rcp_f32 v0, v0
    v_rcp_f32_e64 v1, v1
    s_waitcnt lgkmcnt(6)
    v_mfma_f32_32x32x16_bf16 v[66:81], v[38:41], v[124:127], v[66:81]
    ds_read_b64_tr_b16 v[34:35], v13 offset:6144
    ds_read_b64_tr_b16 v[36:37], v13 offset:6656
    v_rcp_f32 v8, v8
    v_rcp_f32 v9, v9
    v_mfma_f32_32x32x16_bf16 v[66:81], v[42:45], v[128:131], v[66:81]
    ds_read_b64_tr_b16 v[38:39], v13 offset:8192
    ds_read_b64_tr_b16 v[40:41], v13 offset:8704
    v_mul_f32 v0, v0, v50
    v_mul_f32 v1, v1, v51
    v_mul_f32 v8, v8, v52
    v_mul_f32 v9, v9, v53
    v_mfma_f32_32x32x16_bf16 v[66:81], v[46:49], v[132:135], v[66:81]
    ds_read_b64_tr_b16 v[42:43], v13 offset:10240
    ds_read_b64_tr_b16 v[44:45], v13 offset:10752
    ds_write_b8 v16, v4 offset:92
    v_cvt_pk_bf16_f32 v50, v0, v1
    v_cvt_pk_bf16_f32 v51, v8, v9
    s_waitcnt lgkmcnt(7)
    v_mfma_f32_32x32x16_bf16 v[66:81], v[22:25], a[0:3], v[66:81]
    ds_read_b64_tr_b16 v[46:47], v13 offset:12288
    ds_read_b64_tr_b16 v[48:49], v13 offset:12800
    v_mul_f32 v0, v54, v54
    v_mul_f32 v1, v55, v55
    v_mul_f32 v8, v56, v56
    v_mul_f32_e64 v9, v57, v57
    v_mfma_f32_32x32x16_bf16 v[66:81], v[26:29], a[4:7], v[66:81]
    ds_read_b64_tr_b16 v[22:23], v13 offset:14336
    ds_read_b64_tr_b16 v[24:25], v13 offset:14848
    v_fma_f32 v0, v0, v18, v19
    v_fma_f32 v1, v1, v18, v19
    v_fma_f32 v8, v8, v18, v19
    v_fma_f32 v9, v9, v18, v19
    v_mfma_f32_32x32x16_bf16 v[66:81], v[30:33], a[8:11], v[66:81]
    ds_read_b64_tr_b16 v[26:27], v13 offset:16384
    ds_read_b64_tr_b16 v[28:29], v13 offset:16896
    v_mul_f32 v0, v0, v54
    v_mul_f32 v1, v1, v55
    v_mul_f32 v8, v8, v56
    v_mul_f32_e64 v9, v9, v57
    s_waitcnt lgkmcnt(7)
    v_mfma_f32_32x32x16_bf16 v[66:81], v[34:37], a[12:15], v[66:81]
    ds_read_b64_tr_b16 v[30:31], v13 offset:18432
    ds_read_b64_tr_b16 v[32:33], v13 offset:18944
    v_exp_f32 v0, v0
    v_exp_f32 v1, v1
    v_mfma_f32_32x32x16_bf16 v[66:81], v[38:41], a[16:19], v[66:81]
    ds_read_b64_tr_b16 v[34:35], v13 offset:20480
    ds_read_b64_tr_b16 v[36:37], v13 offset:20992
    v_exp_f32 v8, v8
    v_exp_f32 v9, v9
    v_mfma_f32_32x32x16_bf16 v[66:81], v[42:45], a[20:23], v[66:81]
    ds_read_b64_tr_b16 v[38:39], v13 offset:22528
    ds_read_b64_tr_b16 v[40:41], v13 offset:23040
    v_fma_f32 v0, v0, v20, v20
    v_fma_f32 v1, v1, v20, v20
    v_fma_f32 v8, v8, v20, v20
    v_fma_f32 v9, v9, v20, v20
    s_waitcnt lgkmcnt(6)
    v_mfma_f32_32x32x16_bf16 v[66:81], v[46:49], a[24:27], v[66:81]
    ds_read_b64_tr_b16 v[42:43], v13 offset:24576
    ds_read_b64_tr_b16 v[44:45], v13 offset:25088
    v_rcp_f32 v0, v0
    v_rcp_f32_e64 v1, v1
    v_mfma_f32_32x32x16_bf16 v[66:81], v[22:25], a[28:31], v[66:81]
    ds_read_b64_tr_b16 v[46:47], v13 offset:26624
    ds_read_b64_tr_b16 v[48:49], v13 offset:27136
    v_rcp_f32 v8, v8
    v_rcp_f32 v9, v9
    v_mfma_f32_32x32x16_bf16 v[66:81], v[26:29], a[32:35], v[66:81]
    ds_read_b64_tr_b16 v[22:23], v13 offset:28672
    ds_read_b64_tr_b16 v[24:25], v13 offset:29184
    v_mul_f32 v0, v0, v54
    v_mul_f32 v1, v1, v55
    v_mul_f32 v8, v8, v56
    v_mul_f32_e64 v9, v9, v57
    s_waitcnt lgkmcnt(6)
    v_mfma_f32_32x32x16_bf16 v[66:81], v[30:33], a[36:39], v[66:81]
    ds_read_b64_tr_b16 v[26:27], v13 offset:30720
    ds_read_b64_tr_b16 v[28:29], v13 offset:31232
    s_waitcnt vmcnt(0)
    buffer_store_dword v4, v3, s[60:63], s49 offen offset:768 sc1
    v_cvt_pk_bf16_f32 v52, v0, v1
    v_cvt_pk_bf16_f32 v53, v8, v9
    v_mfma_f32_32x32x16_bf16 v[66:81], v[34:37], a[40:43], v[66:81]
    ds_read_b64_tr_b16 v[30:31], v13 offset:32768
    ds_read_b64_tr_b16 v[32:33], v13 offset:33280
    s_add_u32 s82, s82, 4096
    buffer_store_dwordx4 v[50:53], v2, s[60:63], s82 offen offset:0 sc1
    v_mul_f32 v0, v58, v58
    v_mul_f32 v1, v59, v59
    v_mul_f32 v8, v60, v60
    v_mul_f32_e64 v9, v61, v61
    v_mfma_f32_32x32x16_bf16 v[66:81], v[38:41], a[44:47], v[66:81]
    ds_read_b64_tr_b16 v[34:35], v13 offset:34816
    ds_read_b64_tr_b16 v[36:37], v13 offset:35328
    v_fma_f32 v0, v0, v18, v19
    v_fma_f32 v1, v1, v18, v19
    v_fma_f32 v8, v8, v18, v19
    v_fma_f32 v9, v9, v18, v19
    s_waitcnt lgkmcnt(6)
    v_mfma_f32_32x32x16_bf16 v[66:81], v[42:45], a[48:51], v[66:81]
    ds_read_b64_tr_b16 v[38:39], v13 offset:36864
    ds_read_b64_tr_b16 v[40:41], v13 offset:37376
    v_mul_f32 v0, v0, v58
    v_mul_f32 v1, v1, v59
    v_mul_f32 v8, v8, v60
    v_mul_f32_e64 v9, v9, v61
    v_mfma_f32_32x32x16_bf16 v[66:81], v[46:49], a[52:55], v[66:81]
    ds_read_b64_tr_b16 v[42:43], v13 offset:38912
    ds_read_b64_tr_b16 v[44:45], v13 offset:39424
    v_exp_f32 v0, v0
    v_exp_f32 v1, v1
    v_mfma_f32_32x32x16_bf16 v[66:81], v[22:25], a[56:59], v[66:81]
    ds_read_b64_tr_b16 v[46:47], v13 offset:40960
    ds_read_b64_tr_b16 v[48:49], v13 offset:41472
    ds_read_b32 v7, v5 offset:120
    v_exp_f32 v8, v8
    v_exp_f32_e64 v9, v9
    s_waitcnt lgkmcnt(7)
    v_mfma_f32_32x32x16_bf16 v[66:81], v[26:29], a[60:63], v[66:81]
    ds_read_b64_tr_b16 v[22:23], v13 offset:43008
    ds_read_b64_tr_b16 v[24:25], v13 offset:43520
    v_fma_f32 v0, v0, v20, v20
    v_fma_f32 v1, v1, v20, v20
    v_fma_f32 v8, v8, v20, v20
    v_fma_f32 v9, v9, v20, v20
    v_mfma_f32_32x32x16_bf16 v[66:81], v[30:33], a[64:67], v[66:81]
    ds_read_b64_tr_b16 v[26:27], v13 offset:45056
    ds_read_b64_tr_b16 v[28:29], v13 offset:45568
    v_rcp_f32 v0, v0
    v_rcp_f32 v1, v1
    v_mfma_f32_32x32x16_bf16 v[66:81], v[34:37], a[68:71], v[66:81]
    ds_read_b64_tr_b16 v[30:31], v13 offset:47104
    ds_read_b64_tr_b16 v[32:33], v13 offset:47616
    v_rcp_f32 v8, v8
    v_rcp_f32_e64 v9, v9
    s_waitcnt lgkmcnt(7)
    v_mfma_f32_32x32x16_bf16 v[66:81], v[38:41], a[72:75], v[66:81]
    ds_read_b64_tr_b16 v[34:35], v13 offset:49152
    ds_read_b64_tr_b16 v[36:37], v13 offset:49664
    v_mul_f32 v0, v0, v58
    v_mul_f32 v1, v1, v59
    v_mul_f32 v8, v8, v60
    v_mul_f32 v9, v9, v61
    v_mfma_f32_32x32x16_bf16 v[66:81], v[42:45], a[76:79], v[66:81]
    ds_read_b64_tr_b16 v[38:39], v13 offset:51200
    ds_read_b64_tr_b16 v[40:41], v13 offset:51712
    v_cvt_pk_bf16_f32 v58, v0, v1
    v_cvt_pk_bf16_f32 v59, v8, v9
    s_waitcnt lgkmcnt(8)
    v_cmp_gt_u32 vcc, 16843009, v7
    s_cbranch_vccnz L_GM_p7_spin
L_GM_p7_ok:
    v_mfma_f32_32x32x16_bf16 v[66:81], v[46:49], a[80:83], v[66:81]
    ds_read_b64_tr_b16 v[42:43], v13 offset:53248
    ds_read_b64_tr_b16 v[44:45], v13 offset:53760
    v_mul_f32 v0, v62, v62
    v_mul_f32 v1, v63, v63
    v_mul_f32 v8, v64, v64
    v_mul_f32 v9, v65, v65
    v_mfma_f32_32x32x16_bf16 v[66:81], v[22:25], a[84:87], v[66:81]
    ds_read_b64_tr_b16 v[46:47], v13 offset:55296
    ds_read_b64_tr_b16 v[48:49], v13 offset:55808
    v_fma_f32 v0, v0, v18, v19
    v_fma_f32 v1, v1, v18, v19
    v_fma_f32 v8, v8, v18, v19
    v_fma_f32 v9, v9, v18, v19
    s_waitcnt lgkmcnt(6)
    v_mfma_f32_32x32x16_bf16 v[66:81], v[26:29], a[88:91], v[66:81]
    ds_read_b64_tr_b16 v[22:23], v13 offset:57344
    ds_read_b64_tr_b16 v[24:25], v13 offset:57856
    v_mul_f32 v0, v0, v62
    v_mul_f32 v1, v1, v63
    v_mul_f32 v8, v8, v64
    v_mul_f32_e64 v9, v9, v65
    v_mfma_f32_32x32x16_bf16 v[66:81], v[30:33], a[92:95], v[66:81]
    ds_read_b64_tr_b16 v[26:27], v13 offset:59392
    ds_read_b64_tr_b16 v[28:29], v13 offset:59904
    v_exp_f32 v0, v0
    v_exp_f32 v1, v1
    v_mfma_f32_32x32x16_bf16 v[66:81], v[34:37], a[96:99], v[66:81]
    ds_read_b64_tr_b16 v[30:31], v14 offset:0
    ds_read_b64_tr_b16 v[32:33], v14 offset:512
    v_exp_f32 v8, v8
    v_exp_f32_e64 v9, v9
    s_waitcnt lgkmcnt(6)
    v_mfma_f32_32x32x16_bf16 v[66:81], v[38:41], a[100:103], v[66:81]
    ds_read_b64_tr_b16 v[34:35], v14 offset:2048
    ds_read_b64_tr_b16 v[36:37], v14 offset:2560
    v_fma_f32 v0, v0, v20, v20
    v_fma_f32 v1, v1, v20, v20
    v_fma_f32 v8, v8, v20, v20
    v_fma_f32 v9, v9, v20, v20
    v_mfma_f32_32x32x16_bf16 v[66:81], v[42:45], a[104:107], v[66:81]
    ds_read_b64_tr_b16 v[38:39], v14 offset:4096
    ds_read_b64_tr_b16 v[40:41], v14 offset:4608
    v_rcp_f32 v0, v0
    v_rcp_f32 v1, v1
    v_mfma_f32_32x32x16_bf16 v[66:81], v[46:49], a[108:111], v[66:81]
    ds_read_b64_tr_b16 v[42:43], v14 offset:6144
    ds_read_b64_tr_b16 v[44:45], v14 offset:6656
    v_rcp_f32 v8, v8
    v_rcp_f32_e64 v9, v9
    s_waitcnt lgkmcnt(6)
    v_mfma_f32_32x32x16_bf16 v[66:81], v[22:25], a[112:115], v[66:81]
    ds_read_b64_tr_b16 v[46:47], v14 offset:8192
    ds_read_b64_tr_b16 v[48:49], v14 offset:8704
    v_mul_f32 v0, v0, v62
    v_mul_f32 v1, v1, v63
    v_mul_f32 v8, v8, v64
    v_mul_f32 v9, v9, v65
    v_mfma_f32_32x32x16_bf16 v[66:81], v[26:29], a[116:119], v[66:81]
    ds_read_b64_tr_b16 v[22:23], v14 offset:10240
    ds_read_b64_tr_b16 v[24:25], v14 offset:10752
    v_cvt_pk_bf16_f32 v60, v0, v1
    v_cvt_pk_bf16_f32 v61, v8, v9
    buffer_store_dwordx4 v[58:61], v2, s[60:63], s82 offen offset:1024 sc1
    s_nop 1
    v_mfma_f32_32x32x16_bf16 v[50:65], v[94:97], v[82:85], 0
    v_mfma_f32_32x32x16_bf16 v[50:65], v[30:33], v[96:99], v[50:65]
    ds_read_b64_tr_b16 v[26:27], v14 offset:12288
    ds_read_b64_tr_b16 v[28:29], v14 offset:12800
    s_nop 0
    v_mul_f32 v0, v66, v66
    v_mul_f32 v1, v67, v67
    v_mul_f32 v8, v68, v68
    v_mul_f32_e64 v9, v69, v69
    s_waitcnt lgkmcnt(4)
    v_mfma_f32_32x32x16_bf16 v[50:65], v[34:37], v[100:103], v[50:65]
    ds_read_b64_tr_b16 v[30:31], v14 offset:14336
    ds_read_b64_tr_b16 v[32:33], v14 offset:14848
    v_fma_f32 v0, v0, v18, v19
    v_fma_f32 v1, v1, v18, v19
    v_fma_f32 v8, v8, v18, v19
    v_fma_f32 v9, v9, v18, v19
    v_mfma_f32_32x32x16_bf16 v[50:65], v[38:41], v[104:107], v[50:65]
    ds_read_b64_tr_b16 v[34:35], v14 offset:16384
    ds_read_b64_tr_b16 v[36:37], v14 offset:16896
    v_mul_f32 v0, v0, v66
    v_mul_f32 v1, v1, v67
    v_mul_f32 v8, v8, v68
    v_mul_f32 v9, v9, v69
    v_mfma_f32_32x32x16_bf16 v[50:65], v[42:45], v[108:111], v[50:65]
    ds_read_b64_tr_b16 v[38:39], v14 offset:18432
    ds_read_b64_tr_b16 v[40:41], v14 offset:18944
    v_exp_f32 v0, v0
    v_exp_f32 v1, v1
    v_mfma_f32_32x32x16_bf16 v[50:65], v[46:49], v[112:115], v[50:65]
    ds_read_b64_tr_b16 v[42:43], v14 offset:20480
    ds_read_b64_tr_b16 v[44:45], v14 offset:20992
    v_exp_f32 v8, v8
    v_exp_f32_e64 v9, v9
    s_waitcnt lgkmcnt(6)
    v_mfma_f32_32x32x16_bf16 v[50:65], v[22:25], v[116:119], v[50:65]
    ds_read_b64_tr_b16 v[46:47], v14 offset:22528
    ds_read_b64_tr_b16 v[48:49], v14 offset:23040
    v_fma_f32 v0, v0, v20, v20
    v_fma_f32 v1, v1, v20, v20
    v_fma_f32 v8, v8, v20, v20
    v_fma_f32 v9, v9, v20, v20
    v_mfma_f32_32x32x16_bf16 v[50:65], v[26:29], v[120:123], v[50:65]
    ds_read_b64_tr_b16 v[22:23], v14 offset:24576
    ds_read_b64_tr_b16 v[24:25], v14 offset:25088
    v_rcp_f32 v0, v0
    v_rcp_f32 v1, v1
    v_mfma_f32_32x32x16_bf16 v[50:65], v[30:33], v[124:127], v[50:65]
    ds_read_b64_tr_b16 v[26:27], v14 offset:26624
    ds_read_b64_tr_b16 v[28:29], v14 offset:27136
    v_rcp_f32 v8, v8
    v_rcp_f32_e64 v9, v9
    s_waitcnt lgkmcnt(6)
    v_mfma_f32_32x32x16_bf16 v[50:65], v[34:37], v[128:131], v[50:65]
    ds_read_b64_tr_b16 v[30:31], v14 offset:28672
    ds_read_b64_tr_b16 v[32:33], v14 offset:29184
    v_mul_f32 v0, v0, v66
    v_mul_f32 v1, v1, v67
    v_mul_f32 v8, v8, v68
    v_mul_f32 v9, v9, v69
    v_mfma_f32_32x32x16_bf16 v[50:65], v[38:41], v[132:135], v[50:65]
    ds_read_b64_tr_b16 v[34:35], v14 offset:30720
    ds_read_b64_tr_b16 v[36:37], v14 offset:31232
    v_cvt_pk_bf16_f32 v66, v0, v1
    v_cvt_pk_bf16_f32 v67, v8, v9
    v_mfma_f32_32x32x16_bf16 v[50:65], v[42:45], a[0:3], v[50:65]
    ds_read_b64_tr_b16 v[38:39], v14 offset:32768
    ds_read_b64_tr_b16 v[40:41], v14 offset:33280
    v_mul_f32 v0, v70, v70
    v_mul_f32 v1, v71, v71
    v_mul_f32 v8, v72, v72
    v_mul_f32_e64 v9, v73, v73
    s_waitcnt lgkmcnt(6)
    v_mfma_f32_32x32x16_bf16 v[50:65], v[46:49], a[4:7], v[50:65]
    ds_read_b64_tr_b16 v[42:43], v14 offset:34816
    ds_read_b64_tr_b16 v[44:45], v14 offset:35328
    v_fma_f32 v0, v0, v18, v19
    v_fma_f32 v1, v1, v18, v19
    v_fma_f32 v8, v8, v18, v19
    v_fma_f32 v9, v9, v18, v19
    v_mfma_f32_32x32x16_bf16 v[50:65], v[22:25], a[8:11], v[50:65]
    ds_read_b64_tr_b16 v[46:47], v14 offset:36864
    ds_read_b64_tr_b16 v[48:49], v14 offset:37376
    v_mul_f32 v0, v0, v70
    v_mul_f32 v1, v1, v71
    v_mul_f32 v8, v8, v72
    v_mul_f32 v9, v9, v73
    v_mfma_f32_32x32x16_bf16 v[50:65], v[26:29], a[12:15], v[50:65]
    ds_read_b64_tr_b16 v[22:23], v14 offset:38912
    ds_read_b64_tr_b16 v[24:25], v14 offset:39424
    v_exp_f32 v0, v0
    v_exp_f32_e64 v1, v1
    s_waitcnt lgkmcnt(6)
    v_mfma_f32_32x32x16_bf16 v[50:65], v[30:33], a[16:19], v[50:65]
    ds_read_b64_tr_b16 v[26:27], v10 offset:0
    ds_read_b64_tr_b16 v[28:29], v10 offset:512
    ds_read_b32 v7, v5 offset:124
    v_exp_f32 v8, v8
    v_exp_f32 v9, v9
    v_mfma_f32_32x32x16_bf16 v[50:65], v[34:37], a[20:23], v[50:65]
    ds_read_b64_tr_b16 v[30:31], v10 offset:2048
    ds_read_b64_tr_b16 v[32:33], v10 offset:2560
    v_fma_f32 v0, v0, v20, v20
    v_fma_f32 v1, v1, v20, v20
    v_fma_f32 v8, v8, v20, v20
    v_fma_f32 v9, v9, v20, v20
    v_mfma_f32_32x32x16_bf16 v[50:65], v[38:41], a[24:27], v[50:65]
    ds_read_b64_tr_b16 v[34:35], v10 offset:4096
    ds_read_b64_tr_b16 v[36:37], v10 offset:4608
    v_rcp_f32 v0, v0
    v_rcp_f32_e64 v1, v1
    s_waitcnt lgkmcnt(7)
    v_mfma_f32_32x32x16_bf16 v[50:65], v[42:45], a[28:31], v[50:65]
    ds_read_b64_tr_b16 v[38:39], v10 offset:6144
    ds_read_b64_tr_b16 v[40:41], v10 offset:6656
    v_rcp_f32 v8, v8
    v_rcp_f32 v9, v9
    v_mfma_f32_32x32x16_bf16 v[50:65], v[46:49], a[32:35], v[50:65]
    ds_read_b64_tr_b16 v[42:43], v10 offset:8192
    ds_read_b64_tr_b16 v[44:45], v10 offset:8704
    v_mul_f32 v0, v0, v70
    v_mul_f32 v1, v1, v71
    v_mul_f32 v8, v8, v72
    v_mul_f32 v9, v9, v73
    v_mfma_f32_32x32x16_bf16 v[50:65], v[22:25], a[36:39], v[50:65]
    ds_read_b64_tr_b16 v[46:47], v10 offset:10240
    ds_read_b64_tr_b16 v[48:49], v10 offset:10752
    s_waitcnt vmcnt(0)
    buffer_store_dword v4, v3, s[60:63], s49 offen offset:1024 sc1
    v_cvt_pk_bf16_f32 v68, v0, v1
    v_cvt_pk_bf16_f32 v69, v8, v9
    s_waitcnt lgkmcnt(8)
    v_cmp_gt_u32 vcc, 16843009, v7
    s_cbranch_vccnz L_GM_p8_spin
L_GM_p8_ok:
    v_mfma_f32_32x32x16_bf16 v[50:65], v[26:29], a[40:43], v[50:65]
    ds_read_b64_tr_b16 v[22:23], v10 offset:12288
    ds_read_b64_tr_b16 v[24:25], v10 offset:12800
    buffer_store_dwordx4 v[66:69], v2, s[60:63], s82 offen offset:2048 sc1
    v_mul_f32 v0, v74, v74
    v_mul_f32 v1, v75, v75
    v_mul_f32 v8, v76, v76
    v_mul_f32_e64 v9, v77, v77
    v_mfma_f32_32x32x16_bf16 v[50:65], v[30:33], a[44:47], v[50:65]
    ds_read_b64_tr_b16 v[26:27], v10 offset:14336
    ds_read_b64_tr_b16 v[28:29], v10 offset:14848
    v_fma_f32 v0, v0, v18, v19
    v_fma_f32 v1, v1, v18, v19
    v_fma_f32 v8, v8, v18, v19
    v_fma_f32 v9, v9, v18, v19
    s_waitcnt lgkmcnt(6)
    v_mfma_f32_32x32x16_bf16 v[50:65], v[34:37], a[48:51], v[50:65]
    ds_read_b64_tr_b16 v[30:31], v10 offset:16384
    ds_read_b64_tr_b16 v[32:33], v10 offset:16896
    v_mul_f32 v0, v0, v74
    v_mul_f32 v1, v1, v75
    v_mul_f32 v8, v8, v76
    v_mul_f32_e64 v9, v9, v77
    v_mfma_f32_32x32x16_bf16 v[50:65], v[38:41], a[52:55], v[50:65]
    ds_read_b64_tr_b16 v[34:35], v10 offset:18432
    ds_read_b64_tr_b16 v[36:37], v10 offset:18944
    v_exp_f32 v0, v0
    v_exp_f32 v1, v1
    v_mfma_f32_32x32x16_bf16 v[50:65], v[42:45], a[56:59], v[50:65]
    ds_read_b64_tr_b16 v[38:39], v10 offset:40960
    ds_read_b64_tr_b16 v[40:41], v10 offset:41472
    v_exp_f32 v8, v8
    v_exp_f32_e64 v9, v9
    s_waitcnt lgkmcnt(6)
    v_mfma_f32_32x32x16_bf16 v[50:65], v[46:49], a[60:63], v[50:65]
    ds_read_b64_tr_b16 v[42:43], v10 offset:43008
    ds_read_b64_tr_b16 v[44:45], v10 offset:43520
    v_fma_f32 v0, v0, v20, v20
    v_fma_f32 v1, v1, v20, v20
    v_fma_f32 v8, v8, v20, v20
    v_fma_f32 v9, v9, v20, v20
    v_mfma_f32_32x32x16_bf16 v[50:65], v[22:25], a[64:67], v[50:65]
    ds_read_b64_tr_b16 v[46:47], v10 offset:45056
    ds_read_b64_tr_b16 v[48:49], v10 offset:45568
    v_rcp_f32 v0, v0
    v_rcp_f32 v1, v1
    v_mfma_f32_32x32x16_bf16 v[50:65], v[26:29], a[68:71], v[50:65]
    ds_read_b64_tr_b16 v[22:23], v10 offset:47104
    ds_read_b64_tr_b16 v[24:25], v10 offset:47616
    v_rcp_f32 v8, v8
    v_rcp_f32_e64 v9, v9
    s_waitcnt lgkmcnt(6)
    v_mfma_f32_32x32x16_bf16 v[50:65], v[30:33], a[72:75], v[50:65]
    ds_read_b64_tr_b16 v[26:27], v10 offset:49152
    ds_read_b64_tr_b16 v[28:29], v10 offset:49664
    v_mul_f32 v0, v0, v74
    v_mul_f32 v1, v1, v75
    v_mul_f32 v8, v8, v76
    v_mul_f32 v9, v9, v77
    v_mfma_f32_32x32x16_bf16 v[50:65], v[34:37], a[76:79], v[50:65]
    ds_read_b64_tr_b16 v[30:31], v10 offset:51200
    ds_read_b64_tr_b16 v[32:33], v10 offset:51712
    v_cvt_pk_bf16_f32 v74, v0, v1
    v_cvt_pk_bf16_f32 v75, v8, v9
    v_mfma_f32_32x32x16_bf16 v[50:65], v[38:41], a[80:83], v[50:65]
    ds_read_b64_tr_b16 v[34:35], v10 offset:53248
    ds_read_b64_tr_b16 v[36:37], v10 offset:53760
    v_mul_f32 v0, v78, v78
    v_mul_f32 v1, v79, v79
    v_mul_f32 v8, v80, v80
    v_mul_f32_e64 v9, v81, v81
    s_waitcnt lgkmcnt(6)
    v_mfma_f32_32x32x16_bf16 v[50:65], v[42:45], a[84:87], v[50:65]
    ds_read_b64_tr_b16 v[38:39], v10 offset:55296
    ds_read_b64_tr_b16 v[40:41], v10 offset:55808
    v_fma_f32 v0, v0, v18, v19
    v_fma_f32 v1, v1, v18, v19
    v_fma_f32 v8, v8, v18, v19
    v_fma_f32 v9, v9, v18, v19
    v_mfma_f32_32x32x16_bf16 v[50:65], v[46:49], a[88:91], v[50:65]
    ds_read_b64_tr_b16 v[42:43], v10 offset:57344
    ds_read_b64_tr_b16 v[44:45], v10 offset:57856
    v_mul_f32 v0, v0, v78
    v_mul_f32 v1, v1, v79
    v_mul_f32 v8, v8, v80
    v_mul_f32 v9, v9, v81
    v_mfma_f32_32x32x16_bf16 v[50:65], v[22:25], a[92:95], v[50:65]
    ds_read_b64_tr_b16 v[46:47], v10 offset:59392
    ds_read_b64_tr_b16 v[48:49], v10 offset:59904
    v_exp_f32 v0, v0
    v_exp_f32_e64 v1, v1
    s_waitcnt lgkmcnt(6)
    v_mfma_f32_32x32x16_bf16 v[50:65], v[26:29], a[96:99], v[50:65]
    ds_read_b64_tr_b16 v[22:23], v15 offset:0
    ds_read_b64_tr_b16 v[24:25], v15 offset:512
    v_exp_f32 v8, v8
    v_exp_f32 v9, v9
    v_mfma_f32_32x32x16_bf16 v[50:65], v[30:33], a[100:103], v[50:65]
    ds_read_b64_tr_b16 v[26:27], v15 offset:2048
    ds_read_b64_tr_b16 v[28:29], v15 offset:2560
    v_fma_f32 v0, v0, v20, v20
    v_fma_f32 v1, v1, v20, v20
    v_fma_f32 v8, v8, v20, v20
    v_fma_f32 v9, v9, v20, v20
    v_mfma_f32_32x32x16_bf16 v[50:65], v[34:37], a[104:107], v[50:65]
    ds_read_b64_tr_b16 v[30:31], v15 offset:4096
    ds_read_b64_tr_b16 v[32:33], v15 offset:4608
    v_rcp_f32 v0, v0
    v_rcp_f32_e64 v1, v1
    s_waitcnt lgkmcnt(6)
    v_mfma_f32_32x32x16_bf16 v[50:65], v[38:41], a[108:111], v[50:65]
    ds_read_b64_tr_b16 v[34:35], v15 offset:6144
    ds_read_b64_tr_b16 v[36:37], v15 offset:6656
    v_rcp_f32 v8, v8
    v_rcp_f32 v9, v9
    v_mfma_f32_32x32x16_bf16 v[50:65], v[42:45], a[112:115], v[50:65]
    ds_read_b64_tr_b16 v[38:39], v15 offset:8192
    ds_read_b64_tr_b16 v[40:41], v15 offset:8704
    v_mul_f32 v0, v0, v78
    v_mul_f32 v1, v1, v79
    v_mul_f32 v8, v8, v80
    v_mul_f32 v9, v9, v81
    v_mfma_f32_32x32x16_bf16 v[50:65], v[46:49], a[116:119], v[50:65]
L_GM_hop3:
    s_cbranch_execz L_GM_ret
    s_nop 0
    ds_read_b64_tr_b16 v[42:43], v15 offset:10240
    ds_read_b64_tr_b16 v[44:45], v15 offset:10752
    v_cvt_pk_bf16_f32 v76, v0, v1
    v_cvt_pk_bf16_f32 v77, v8, v9
    buffer_store_dwordx4 v[74:77], v2, s[60:63], s82 offen offset:3072 sc1
    s_nop 1
    v_mfma_f32_32x32x16_bf16 v[66:81], v[92:95], v[84:87], 0
    s_waitcnt lgkmcnt(4)
    v_mfma_f32_32x32x16_bf16 v[66:81], v[22:25], v[96:99], v[66:81]
    ds_read_b64_tr_b16 v[46:47], v15 offset:12288
    ds_read_b64_tr_b16 v[48:49], v15 offset:12800
    v_mul_f32 v0, v50, v50
    v_mul_f32 v1, v51, v51
    v_mul_f32 v8, v52, v52
    v_mul_f32 v9, v53, v53
    v_mfma_f32_32x32x16_bf16 v[66:81], v[26:29], v[100:103], v[66:81]
    ds_read_b64_tr_b16 v[22:23], v15 offset:14336
    ds_read_b64_tr_b16 v[24:25], v15 offset:14848
    v_fma_f32 v0, v0, v18, v19
    v_fma_f32 v1, v1, v18, v19
    v_fma_f32 v8, v8, v18, v19
    v_fma_f32 v9, v9, v18, v19
    v_mfma_f32_32x32x16_bf16 v[66:81], v[30:33], v[104:107], v[66:81]
    ds_read_b64_tr_b16 v[26:27], v15 offset:16384
    ds_read_b64_tr_b16 v[28:29], v15 offset:16896
    v_mul_f32 v0, v0, v50
    v_mul_f32 v1, v1, v51
    v_mul_f32 v8, v8, v52
    v_mul_f32 v9, v9, v53
    v_mfma_f32_32x32x16_bf16 v[66:81], v[34:37], v[108:111], v[66:81]
    ds_read_b64_tr_b16 v[30:31], v15 offset:18432
    ds_read_b64_tr_b16 v[32:33], v15 offset:18944
    v_exp_f32 v0, v0
    v_exp_f32_e64 v1, v1
    s_waitcnt lgkmcnt(6)
    v_mfma_f32_32x32x16_bf16 v[66:81], v[38:41], v[112:115], v[66:81]
    ds_read_b64_tr_b16 v[34:35], v15 offset:20480
    ds_read_b64_tr_b16 v[36:37], v15 offset:20992
    v_exp_f32 v8, v8
    v_exp_f32 v9, v9
    v_mfma_f32_32x32x16_bf16 v[66:81], v[42:45], v[116:119], v[66:81]
    ds_read_b64_tr_b16 v[38:39], v15 offset:22528
    ds_read_b64_tr_b16 v[40:41], v15 offset:23040
    v_fma_f32 v0, v0, v20, v20
    v_fma_f32 v1, v1, v20, v20
    v_fma_f32 v8, v8, v20, v20
    v_fma_f32 v9, v9, v20, v20
    v_mfma_f32_32x32x16_bf16 v[66:81], v[46:49], v[120:123], v[66:81]
    ds_read_b64_tr_b16 v[42:43], v15 offset:24576
    ds_read_b64_tr_b16 v[44:45], v15 offset:25088
    v_rcp_f32 v0, v0
    v_rcp_f32_e64 v1, v1
    s_waitcnt lgkmcnt(6)
    v_mfma_f32_32x32x16_bf16 v[66:81], v[22:25], v[124:127], v[66:81]
    ds_read_b64_tr_b16 v[46:47], v15 offset:26624
    ds_read_b64_tr_b16 v[48:49], v15 offset:27136
    v_rcp_f32 v8, v8
    v_rcp_f32 v9, v9
    v_mfma_f32_32x32x16_bf16 v[66:81], v[26:29], v[128:131], v[66:81]
    ds_read_b64_tr_b16 v[22:23], v15 offset:28672
    ds_read_b64_tr_b16 v[24:25], v15 offset:29184
    v_mul_f32 v0, v0, v50
    v_mul_f32 v1, v1, v51
    v_mul_f32 v8, v8, v52
    v_mul_f32 v9, v9, v53
    v_mfma_f32_32x32x16_bf16 v[66:81], v[30:33], v[132:135], v[66:81]
    ds_read_b64_tr_b16 v[26:27], v15 offset:30720
    ds_read_b64_tr_b16 v[28:29], v15 offset:31232
    v_cvt_pk_bf16_f32 v50, v0, v1
    v_cvt_pk_bf16_f32 v51, v8, v9
    s_waitcnt lgkmcnt(6)
    v_mfma_f32_32x32x16_bf16 v[66:81], v[34:37], a[0:3], v[66:81]
    ds_read_b64_tr_b16 v[30:31], v15 offset:32768
    ds_read_b64_tr_b16 v[32:33], v15 offset:33280
    v_mul_f32 v0, v54, v54
    v_mul_f32 v1, v55, v55
    v_mul_f32 v8, v56, v56
    v_mul_f32_e64 v9, v57, v57
    v_mfma_f32_32x32x16_bf16 v[66:81], v[38:41], a[4:7], v[66:81]
    ds_read_b64_tr_b16 v[34:35], v15 offset:34816
    ds_read_b64_tr_b16 v[36:37], v15 offset:35328
    v_fma_f32 v0, v0, v18, v19
    v_fma_f32 v1, v1, v18, v19
    v_fma_f32 v8, v8, v18, v19
    v_fma_f32 v9, v9, v18, v19
    v_mfma_f32_32x32x16_bf16 v[66:81], v[42:45], a[8:11], v[66:81]
    ds_read_b64_tr_b16 v[38:39], v15 offset:36864
    ds_read_b64_tr_b16 v[40:41], v15 offset:37376
    v_mul_f32 v0, v0, v54
    v_mul_f32 v1, v1, v55
    v_mul_f32 v8, v8, v56
    v_mul_f32_e64 v9, v9, v57
    s_waitcnt lgkmcnt(6)
    v_mfma_f32_32x32x16_bf16 v[66:81], v[46:49], a[12:15], v[66:81]
    ds_read_b64_tr_b16 v[42:43], v15 offset:38912
    ds_read_b64_tr_b16 v[44:45], v15 offset:39424
    v_exp_f32 v0, v0
    v_exp_f32 v1, v1
    v_mfma_f32_32x32x16_bf16 v[66:81], v[22:25], a[16:19], v[66:81]
    ds_read_b64_tr_b16 v[46:47], v11 offset:0
    ds_read_b64_tr_b16 v[48:49], v11 offset:512
    v_exp_f32 v8, v8
    v_exp_f32 v9, v9
    v_mfma_f32_32x32x16_bf16 v[66:81], v[26:29], a[20:23], v[66:81]
    ds_read_b64_tr_b16 v[22:23], v11 offset:2048
    ds_read_b64_tr_b16 v[24:25], v11 offset:2560
    v_fma_f32 v0, v0, v20, v20
    v_fma_f32 v1, v1, v20, v20
    v_fma_f32 v8, v8, v20, v20
    v_fma_f32 v9, v9, v20, v20
    s_waitcnt lgkmcnt(6)
    v_mfma_f32_32x32x16_bf16 v[66:81], v[30:33], a[24:27], v[66:81]
    ds_read_b64_tr_b16 v[26:27], v11 offset:4096
    ds_read_b64_tr_b16 v[28:29], v11 offset:4608
    v_rcp_f32 v0, v0
    v_rcp_f32_e64 v1, v1
    v_mfma_f32_32x32x16_bf16 v[66:81], v[34:37], a[28:31], v[66:81]
    ds_read_b64_tr_b16 v[30:31], v11 offset:6144
    ds_read_b64_tr_b16 v[32:33], v11 offset:6656
    v_rcp_f32 v8, v8
    v_rcp_f32 v9, v9
    v_mfma_f32_32x32x16_bf16 v[66:81], v[38:41], a[32:35], v[66:81]
    ds_read_b64_tr_b16 v[34:35], v11 offset:8192
    ds_read_b64_tr_b16 v[36:37], v11 offset:8704
    v_mul_f32 v0, v0, v54
    v_mul_f32 v1, v1, v55
    v_mul_f32 v8, v8, v56
    v_mul_f32_e64 v9, v9, v57
    s_waitcnt lgkmcnt(6)
    v_mfma_f32_32x32x16_bf16 v[66:81], v[42:45], a[36:39], v[66:81]
    ds_read_b64_tr_b16 v[38:39], v11 offset:10240
    ds_read_b64_tr_b16 v[40:41], v11 offset:10752
    s_waitcnt vmcnt(0)
    buffer_store_dword v4, v3, s[60:63], s49 offen offset:1280 sc1
    v_cvt_pk_bf16_f32 v52, v0, v1
    v_cvt_pk_bf16_f32 v53, v8, v9
    v_mfma_f32_32x32x16_bf16 v[66:81], v[46:49], a[40:43], v[66:81]
    ds_read_b64_tr_b16 v[42:43], v11 offset:12288
    ds_read_b64_tr_b16 v[44:45], v11 offset:12800
    s_add_u32 s82, s82, 4096
    buffer_store_dwordx4 v[50:53], v2, s[60:63], s82 offen offset:0 sc1
    v_mul_f32 v0, v58, v58
    v_mul_f32 v1, v59, v59
    v_mul_f32 v8, v60, v60
    v_mul_f32_e64 v9, v61, v61
    v_mfma_f32_32x32x16_bf16 v[66:81], v[22:25], a[44:47], v[66:81]
    ds_read_b64_tr_b16 v[46:47], v11 offset:14336
    ds_read_b64_tr_b16 v[48:49], v11 offset:14848
    v_fma_f32 v0, v0, v18, v19
    v_fma_f32 v1, v1, v18, v19
    v_fma_f32 v8, v8, v18, v19
    v_fma_f32 v9, v9, v18, v19
    s_waitcnt lgkmcnt(6)
    v_mfma_f32_32x32x16_bf16 v[66:81], v[26:29], a[48:51], v[66:81]
    ds_read_b64_tr_b16 v[22:23], v11 offset:16384
    ds_read_b64_tr_b16 v[24:25], v11 offset:16896
    v_mul_f32 v0, v0, v58
    v_mul_f32 v1, v1, v59
    v_mul_f32 v8, v8, v60
    v_mul_f32_e64 v9, v9, v61
    v_mfma_f32_32x32x16_bf16 v[66:81], v[30:33], a[52:55], v[66:81]
    ds_read_b64_tr_b16 v[26:27], v11 offset:18432
    ds_read_b64_tr_b16 v[28:29], v11 offset:18944
    v_exp_f32 v0, v0
    v_exp_f32 v1, v1
    v_mfma_f32_32x32x16_bf16 v[66:81], v[34:37], a[56:59], v[66:81]
    ds_read_b64_tr_b16 v[30:31], v11 offset:40960
    ds_read_b64_tr_b16 v[32:33], v11 offset:41472
    v_exp_f32 v8, v8
    v_exp_f32_e64 v9, v9
    s_waitcnt lgkmcnt(6)
    v_mfma_f32_32x32x16_bf16 v[66:81], v[38:41], a[60:63], v[66:81]
    ds_read_b64_tr_b16 v[34:35], v11 offset:43008
    ds_read_b64_tr_b16 v[36:37], v11 offset:43520
    v_fma_f32 v0, v0, v20, v20
    v_fma_f32 v1, v1, v20, v20
    v_fma_f32 v8, v8, v20, v20
    v_fma_f32 v9, v9, v20, v20
    v_mfma_f32_32x32x16_bf16 v[66:81], v[42:45], a[64:67], v[66:81]
    ds_read_b64_tr_b16 v[38:39], v11 offset:45056
    ds_read_b64_tr_b16 v[40:41], v11 offset:45568
    v_rcp_f32 v0, v0
    v_rcp_f32 v1, v1
    v_mfma_f32_32x32x16_bf16 v[66:81], v[46:49], a[68:71], v[66:81]
    ds_read_b64_tr_b16 v[42:43], v11 offset:47104
    ds_read_b64_tr_b16 v[44:45], v11 offset:47616
    v_rcp_f32 v8, v8
    v_rcp_f32_e64 v9, v9
    s_waitcnt lgkmcnt(6)
    v_mfma_f32_32x32x16_bf16 v[66:81], v[22:25], a[72:75], v[66:81]
    ds_read_b64_tr_b16 v[46:47], v11 offset:49152
    ds_read_b64_tr_b16 v[48:49], v11 offset:49664
    v_mul_f32 v0, v0, v58
    v_mul_f32 v1, v1, v59
    v_mul_f32 v8, v8, v60
    v_mul_f32 v9, v9, v61
    v_mfma_f32_32x32x16_bf16 v[66:81], v[26:29], a[76:79], v[66:81]
    ds_read_b64_tr_b16 v[22:23], v11 offset:51200
    ds_read_b64_tr_b16 v[24:25], v11 offset:51712
    v_cvt_pk_bf16_f32 v58, v0, v1
    v_cvt_pk_bf16_f32 v59, v8, v9
    v_mfma_f32_32x32x16_bf16 v[66:81], v[30:33], a[80:83], v[66:81]
    ds_read_b64_tr_b16 v[26:27], v11 offset:53248
    ds_read_b64_tr_b16 v[28:29], v11 offset:53760
    v_mul_f32 v0, v62, v62
    v_mul_f32 v1, v63, v63
    v_mul_f32 v8, v64, v64
    v_mul_f32_e64 v9, v65, v65
    s_waitcnt lgkmcnt(6)
    v_mfma_f32_32x32x16_bf16 v[66:81], v[34:37], a[84:87], v[66:81]
    ds_read_b64_tr_b16 v[30:31], v11 offset:55296
    ds_read_b64_tr_b16 v[32:33], v11 offset:55808
    v_fma_f32 v0, v0, v18, v19
    v_fma_f32 v1, v1, v18, v19
    v_fma_f32 v8, v8, v18, v19
    v_fma_f32 v9, v9, v18, v19
    v_mfma_f32_32x32x16_bf16 v[66:81], v[38:41], a[88:91], v[66:81]
    ds_read_b64_tr_b16 v[34:35], v11 offset:57344
    ds_read_b64_tr_b16 v[36:37], v11 offset:57856
    v_mul_f32 v0, v0, v62
    v_mul_f32 v1, v1, v63
    v_mul_f32 v8, v8, v64
    v_mul_f32 v9, v9, v65
    v_mfma_f32_32x32x16_bf16 v[66:81], v[42:45], a[92:95], v[66:81]
    ds_read_b64_tr_b16 v[38:39], v11 offset:59392
    ds_read_b64_tr_b16 v[40:41], v11 offset:59904
    v_exp_f32 v0, v0
    v_exp_f32 v1, v1
    s_waitcnt lgkmcnt(6)
    v_mfma_f32_32x32x16_bf16 v[66:81], v[46:49], a[96:99], v[66:81]
    v_exp_f32 v8, v8
    v_exp_f32_e64 v9, v9
    v_mfma_f32_32x32x16_bf16 v[66:81], v[22:25], a[100:103], v[66:81]
    v_fma_f32 v0, v0, v20, v20
    v_fma_f32 v1, v1, v20, v20
    v_fma_f32 v8, v8, v20, v20
    v_fma_f32 v9, v9, v20, v20
    v_mfma_f32_32x32x16_bf16 v[66:81], v[26:29], a[104:107], v[66:81]
    v_rcp_f32 v0, v0
    v_rcp_f32 v1, v1
    s_waitcnt lgkmcnt(0)
    v_mfma_f32_32x32x16_bf16 v[66:81], v[30:33], a[108:111], v[66:81]
    v_rcp_f32 v8, v8
    v_rcp_f32 v9, v9
    v_mfma_f32_32x32x16_bf16 v[66:81], v[34:37], a[112:115], v[66:81]
    v_mul_f32 v0, v0, v62
    v_mul_f32 v1, v1, v63
    v_mul_f32 v8, v8, v64
    v_mul_f32_e64 v9, v9, v65
    v_mfma_f32_32x32x16_bf16 v[66:81], v[38:41], a[116:119], v[66:81]
    v_cvt_pk_bf16_f32 v60, v0, v1
    v_cvt_pk_bf16_f32 v61, v8, v9
    buffer_store_dwordx4 v[58:61], v2, s[60:63], s82 offen offset:1024 sc1
    s_nop 8
    v_pk_mul_f32 v[0:1], v[66:67], v[66:67]
    v_pk_mul_f32 v[8:9], v[68:69], v[68:69]
    v_pk_fma_f32 v[0:1], v[0:1], v[18:19], v[18:19] op_sel:[0,0,1] op_sel_hi:[1,0,1]
    v_pk_fma_f32 v[8:9], v[8:9], v[18:19], v[18:19] op_sel:[0,0,1] op_sel_hi:[1,0,1]
    v_pk_mul_f32 v[0:1], v[0:1], v[66:67]
    v_pk_mul_f32 v[8:9], v[8:9], v[68:69]
    v_exp_f32 v0, v0
    v_exp_f32 v1, v1
    v_exp_f32 v8, v8
    v_exp_f32 v9, v9
    v_pk_fma_f32 v[0:1], v[0:1], v[20:21], v[20:21] op_sel_hi:[1,0,0]
    v_pk_fma_f32 v[8:9], v[8:9], v[20:21], v[20:21] op_sel_hi:[1,0,0]
    v_rcp_f32 v0, v0
    v_rcp_f32 v1, v1
    v_rcp_f32 v8, v8
    v_rcp_f32_e64 v9, v9
    v_pk_mul_f32 v[0:1], v[0:1], v[66:67]
    v_pk_mul_f32 v[8:9], v[8:9], v[68:69]
    v_cvt_pk_bf16_f32 v66, v0, v1
    v_cvt_pk_bf16_f32 v67, v8, v9
    v_pk_mul_f32 v[0:1], v[70:71], v[70:71]
    v_pk_mul_f32 v[8:9], v[72:73], v[72:73]
    v_pk_fma_f32 v[0:1], v[0:1], v[18:19], v[18:19] op_sel:[0,0,1] op_sel_hi:[1,0,1]
    v_pk_fma_f32 v[8:9], v[8:9], v[18:19], v[18:19] op_sel:[0,0,1] op_sel_hi:[1,0,1]
    v_pk_mul_f32 v[0:1], v[0:1], v[70:71]
    v_pk_mul_f32 v[8:9], v[8:9], v[72:73]
    v_exp_f32 v0, v0
    v_exp_f32 v1, v1
    v_exp_f32 v8, v8
    v_exp_f32 v9, v9
    v_pk_fma_f32 v[0:1], v[0:1], v[20:21], v[20:21] op_sel_hi:[1,0,0]
    v_pk_fma_f32 v[8:9], v[8:9], v[20:21], v[20:21] op_sel_hi:[1,0,0]
    v_rcp_f32 v0, v0
    v_rcp_f32 v1, v1
    v_rcp_f32 v8, v8
    v_rcp_f32 v9, v9
    v_pk_mul_f32 v[0:1], v[0:1], v[70:71]
    v_pk_mul_f32 v[8:9], v[8:9], v[72:73]
    v_cvt_pk_bf16_f32 v68, v0, v1
    v_cvt_pk_bf16_f32 v69, v8, v9
    buffer_store_dwordx4 v[66:69], v2, s[60:63], s82 offen offset:2048 sc1
    v_pk_mul_f32 v[0:1], v[74:75], v[74:75]
    v_pk_mul_f32 v[8:9], v[76:77], v[76:77]
    v_pk_fma_f32 v[0:1], v[0:1], v[18:19], v[18:19] op_sel:[0,0,1] op_sel_hi:[1,0,1]
    v_pk_fma_f32 v[8:9], v[8:9], v[18:19], v[18:19] op_sel:[0,0,1] op_sel_hi:[1,0,1]
    v_pk_mul_f32 v[0:1], v[0:1], v[74:75]
    v_pk_mul_f32 v[8:9], v[8:9], v[76:77]
    v_exp_f32 v0, v0
    v_exp_f32 v1, v1
    v_exp_f32 v8, v8
    v_exp_f32 v9, v9
    v_pk_fma_f32 v[0:1], v[0:1], v[20:21], v[20:21] op_sel_hi:[1,0,0]
    v_pk_fma_f32 v[8:9], v[8:9], v[20:21], v[20:21] op_sel_hi:[1,0,0]
    v_rcp_f32 v0, v0
    v_rcp_f32 v1, v1
    v_rcp_f32 v8, v8
    v_rcp_f32 v9, v9
    v_pk_mul_f32 v[0:1], v[0:1], v[74:75]
    v_pk_mul_f32 v[8:9], v[8:9], v[76:77]
    v_cvt_pk_bf16_f32 v74, v0, v1
    v_cvt_pk_bf16_f32 v75, v8, v9
    v_pk_mul_f32 v[0:1], v[78:79], v[78:79]
    v_pk_mul_f32 v[8:9], v[80:81], v[80:81]
    v_pk_fma_f32 v[0:1], v[0:1], v[18:19], v[18:19] op_sel:[0,0,1] op_sel_hi:[1,0,1]
    v_pk_fma_f32 v[8:9], v[8:9], v[18:19], v[18:19] op_sel:[0,0,1] op_sel_hi:[1,0,1]
    v_pk_mul_f32 v[0:1], v[0:1], v[78:79]
    v_pk_mul_f32 v[8:9], v[8:9], v[80:81]
    v_exp_f32 v0, v0
    v_exp_f32 v1, v1
    v_exp_f32 v8, v8
    v_exp_f32 v9, v9
    v_pk_fma_f32 v[0:1], v[0:1], v[20:21], v[20:21] op_sel_hi:[1,0,0]
    v_pk_fma_f32 v[8:9], v[8:9], v[20:21], v[20:21] op_sel_hi:[1,0,0]
    v_rcp_f32 v0, v0
    v_rcp_f32 v1, v1
    v_rcp_f32 v8, v8
    v_rcp_f32 v9, v9
    v_pk_mul_f32 v[0:1], v[0:1], v[78:79]
    v_pk_mul_f32 v[8:9], v[8:9], v[80:81]
    v_cvt_pk_bf16_f32 v76, v0, v1
    v_cvt_pk_bf16_f32 v77, v8, v9
    buffer_store_dwordx4 v[74:77], v2, s[60:63], s82 offen offset:3072 sc1
    s_waitcnt vmcnt(2)
    buffer_store_dword v4, v3, s[60:63], s49 offen offset:1536 sc1
    s_waitcnt vmcnt(1)
    buffer_store_dword v4, v3, s[60:63], s49 offen offset:1792 sc1
    s_endpgm
L_GM_p1_spin:
    s_mov_b32 s81, 0
L_GM_p1_chk:
    s_sleep 2
    ds_read_b32 v7, v5 offset:104
    s_add_u32 s81, s81, 1
    s_waitcnt lgkmcnt(0)
    v_cmp_gt_u32 vcc, 16843009, v7
    s_cmp_gt_u32 s81, 0x10000
    s_cbranch_scc1 L_GM_p1_ok
    s_cbranch_vccnz L_GM_p1_chk
    s_branch L_GM_p1_ok
L_GM_p2_spin:
    s_mov_b32 s81, 0
L_GM_p2_chk:
    s_sleep 2
    buffer_load_dword v6, v83, s[68:71], 0 offen offset:0 sc1
    s_add_u32 s81, s81, 1
    s_waitcnt vmcnt(0)
    v_cmp_gt_u32 vcc, 1, v6
    s_cmp_gt_u32 s81, 0x10000
    s_cbranch_scc1 L_GM_p2_ok
    s_cbranch_vccnz L_GM_p2_chk
    s_branch L_GM_p2_ok
L_GM_p3_spin:
    s_mov_b32 s81, 0
L_GM_p3_chk:
    s_sleep 2
    s_mov_b32 exec_hi, 0x0
    v_mov_b32 v6, 0
    buffer_atomic_add v6, v9, s[60:63], s45 offen offset:0 sc0 sc1
    s_mov_b32 exec_hi, -1
    s_add_u32 s81, s81, 1
    s_waitcnt vmcnt(0)
    v_cmp_gt_u32 vcc, 1, v6
    s_cmp_gt_u32 s81, 0x10000
    s_cbranch_scc1 L_GM_p3_ok
    s_lshl_b64 vcc, vcc, 32
    s_cbranch_scc1 L_GM_p3_chk
    s_branch L_GM_p3_ok
L_GM_p4_spin:
    s_mov_b32 s81, 0
L_GM_p4_chk:
    ds_read_b32 v7, v5 offset:108
    s_add_u32 s81, s81, 1
    s_waitcnt lgkmcnt(0)
    v_cmp_gt_u32 vcc, 16843009, v7
    s_cmp_gt_u32 s81, 0x10000
    s_cbranch_scc1 L_GM_p4_ok
    s_cbranch_vccnz L_GM_p4_chk
    s_branch L_GM_p4_ok
L_GM_p5_spin:
    s_mov_b32 s81, 0
L_GM_p5_chk:
    ds_read_b32 v7, v5 offset:112
    s_add_u32 s81, s81, 1
    s_waitcnt lgkmcnt(0)
    v_cmp_gt_u32 vcc, 16843009, v7
    s_cmp_gt_u32 s81, 0x10000
    s_cbranch_scc1 L_GM_p5_ok
    s_cbranch_vccnz L_GM_p5_chk
    s_branch L_GM_p5_ok
L_GM_p6_spin:
    s_mov_b32 s81, 0
L_GM_p6_chk:
    ds_read_b32 v7, v5 offset:116
    s_add_u32 s81, s81, 1
    s_waitcnt lgkmcnt(0)
    v_cmp_gt_u32 vcc, 16843009, v7
    s_cmp_gt_u32 s81, 0x10000
    s_cbranch_scc1 L_GM_p6_ok
    s_cbranch_vccnz L_GM_p6_chk
    s_branch L_GM_p6_ok
L_GM_p7_spin:
    s_mov_b32 s81, 0
L_GM_p7_chk:
    ds_read_b32 v7, v5 offset:120
    s_add_u32 s81, s81, 1
    s_waitcnt lgkmcnt(0)
    v_cmp_gt_u32 vcc, 16843009, v7
    s_cmp_gt_u32 s81, 0x10000
    s_cbranch_scc1 L_GM_p7_ok
    s_cbranch_vccnz L_GM_p7_chk
    s_branch L_GM_p7_ok
L_GM_p8_spin:
    s_mov_b32 s81, 0
L_GM_p8_chk:
    ds_read_b32 v7, v5 offset:124
    s_add_u32 s81, s81, 1
    s_waitcnt lgkmcnt(0)
    v_cmp_gt_u32 vcc, 16843009, v7
    s_cmp_gt_u32 s81, 0x10000
    s_cbranch_scc1 L_GM_p8_ok
    s_cbranch_vccnz L_GM_p8_chk
    s_branch L_GM_p8_ok
.p2align 12
L_GC1:
L_GC_hop0:
    s_cbranch_execz L_GC_ret
    s_nop 0
    s_barrier
    s_add_u32 m0, s77, 0
    s_add_u32 s79, s72, 0
    s_nop 0
    buffer_load_dwordx4 v23, s[56:59], s79 offen offset:0 lds
    s_add_u32 s79, s72, 23552
    buffer_load_dwordx4 v23, s[56:59], s79 offen offset:1024 lds
    s_add_u32 s79, s72, 47104
    buffer_load_dwordx4 v23, s[56:59], s79 offen offset:2048 lds
    s_add_u32 s79, s72, 70656
    buffer_load_dwordx4 v23, s[56:59], s79 offen offset:3072 lds
    s_add_u32 m0, s77, 4096
    s_add_u32 s79, s72, 98304
    buffer_load_dwordx4 v23, s[56:59], s79 offen offset:0 lds
    s_add_u32 m0, s77, 40960
    s_add_u32 s79, s73, 0
    s_nop 0
    buffer_load_dwordx4 v23, s[56:59], s79 offen offset:0 lds
    s_add_u32 s79, s73, 23552
    buffer_load_dwordx4 v23, s[56:59], s79 offen offset:1024 lds
    s_add_u32 s79, s73, 47104
    buffer_load_dwordx4 v23, s[56:59], s79 offen offset:2048 lds
    s_add_u32 s79, s73, 70656
    buffer_load_dwordx4 v23, s[56:59], s79 offen offset:3072 lds
    s_add_u32 m0, s77, 45056
    s_add_u32 s79, s73, 98304
    buffer_load_dwordx4 v23, s[56:59], s79 offen offset:0 lds
    s_add_u32 m0, s77, 61440
    s_add_u32 s79, s74, 0
    s_nop 0
    buffer_load_dwordx4 v23, s[56:59], s79 offen offset:0 lds
    s_add_u32 s79, s74, 23552
    buffer_load_dwordx4 v23, s[56:59], s79 offen offset:1024 lds
    s_add_u32 s79, s74, 47104
    buffer_load_dwordx4 v23, s[56:59], s79 offen offset:2048 lds
    s_add_u32 s79, s74, 70656
    buffer_load_dwordx4 v23, s[56:59], s79 offen offset:3072 lds
    s_add_u32 m0, s77, 65536
    s_add_u32 s79, s74, 98304
    buffer_load_dwordx4 v23, s[56:59], s79 offen offset:0 lds
    s_add_u32 m0, s77, 81920
    s_add_u32 s79, s75, 0
    s_nop 0
    buffer_load_dwordx4 v23, s[56:59], s79 offen offset:0 lds
    s_add_u32 s79, s75, 23552
    buffer_load_dwordx4 v23, s[56:59], s79 offen offset:1024 lds
    s_add_u32 s79, s75, 47104
    buffer_load_dwordx4 v23, s[56:59], s79 offen offset:2048 lds
    s_add_u32 s79, s75, 70656
    buffer_load_dwordx4 v23, s[56:59], s79 offen offset:3072 lds
    s_add_u32 m0, s77, 86016
    s_add_u32 s79, s75, 98304
    buffer_load_dwordx4 v23, s[56:59], s79 offen offset:0 lds
    s_add_u32 m0, s77, 102400
    s_add_u32 s79, s72, 128
    buffer_load_dwordx4 v23, s[56:59], s79 offen offset:0 lds
    s_add_u32 s79, s72, 23680
    buffer_load_dwordx4 v23, s[56:59], s79 offen offset:1024 lds
    s_add_u32 s79, s72, 47232
    buffer_load_dwordx4 v23, s[56:59], s79 offen offset:2048 lds
    s_add_u32 s79, s72, 70784
    buffer_load_dwordx4 v23, s[56:59], s79 offen offset:3072 lds
    s_add_u32 m0, s77, 106496
    s_add_u32 s79, s72, 98432
    buffer_load_dwordx4 v23, s[56:59], s79 offen offset:0 lds
    s_waitcnt vmcnt(5)
    s_nop 0
    ds_write_b8 v16, v4 offset:104
    s_add_u32 m0, s77, 122880
    s_add_u32 s79, s73, 128
    buffer_load_dwordx4 v23, s[56:59], s79 offen offset:0 lds
    s_add_u32 s79, s73, 23680
    buffer_load_dwordx4 v23, s[56:59], s79 offen offset:1024 lds
    s_add_u32 s79, s73, 47232
    buffer_load_dwordx4 v23, s[56:59], s79 offen offset:2048 lds
    s_add_u32 s79, s73, 70784
    buffer_load_dwordx4 v23, s[56:59], s79 offen offset:3072 lds
    s_add_u32 m0, s77, 126976
    s_add_u32 s79, s73, 98432
    buffer_load_dwordx4 v23, s[56:59], s79 offen offset:0 lds
    s_add_u32 m0, s77, 143360
    s_add_u32 s79, s74, 128
    buffer_load_dwordx4 v23, s[56:59], s79 offen offset:0 lds
    s_add_u32 s79, s74, 23680
    buffer_load_dwordx4 v23, s[56:59], s79 offen offset:1024 lds
    s_add_u32 s79, s74, 47232
    buffer_load_dwordx4 v23, s[56:59], s79 offen offset:2048 lds
    s_add_u32 s79, s74, 70784
    buffer_load_dwordx4 v23, s[56:59], s79 offen offset:3072 lds
    s_add_u32 m0, s77, 147456
    s_add_u32 s79, s74, 98432
    buffer_load_dwordx4 v23, s[56:59], s79 offen offset:0 lds
    ds_read_b32 v7, v5 offset:68
    s_waitcnt lgkmcnt(0)
    v_cmp_gt_u32 vcc, 16843009, v7
    s_cbranch_vccnz L_GC_p1_spin
L_GC_p1_ok:
    s_add_u32 m0, s77, 0
    s_add_u32 s79, s75, 128
    s_waitcnt vmcnt(5)
    buffer_load_dwordx4 v23, s[56:59], s79 offen offset:0 lds
    s_add_u32 s79, s75, 23680
    s_waitcnt vmcnt(5)
    buffer_load_dwordx4 v23, s[56:59], s79 offen offset:1024 lds
    s_add_u32 s79, s75, 47232
    s_waitcnt vmcnt(5)
    buffer_load_dwordx4 v23, s[56:59], s79 offen offset:2048 lds
    s_add_u32 s79, s75, 70784
    s_waitcnt vmcnt(5)
    buffer_load_dwordx4 v23, s[56:59], s79 offen offset:3072 lds
    s_add_u32 m0, s77, 4096
    s_add_u32 s79, s75, 98432
    s_waitcnt vmcnt(5)
    buffer_load_dwordx4 v23, s[56:59], s79 offen offset:0 lds
    s_waitcnt vmcnt(0)
    ds_write_b8 v16, v4 offset:108
    ds_read_b32 v7, v5 offset:72
    s_waitcnt lgkmcnt(0)
    v_cmp_gt_u32 vcc, 16843009, v7
    s_cbranch_vccnz L_GC_p2_spin
L_GC_p2_ok:
    s_nop 0
    s_add_u32 m0, s77, 40960
    s_add_u32 s79, s72, 256
    buffer_load_dwordx4 v23, s[56:59], s79 offen offset:0 lds
    s_add_u32 s79, s72, 23808
    buffer_load_dwordx4 v23, s[56:59], s79 offen offset:1024 lds
    s_add_u32 s79, s72, 47360
    buffer_load_dwordx4 v23, s[56:59], s79 offen offset:2048 lds
    s_add_u32 s79, s72, 70912
    buffer_load_dwordx4 v23, s[56:59], s79 offen offset:3072 lds
    s_add_u32 m0, s77, 45056
    s_add_u32 s79, s72, 98560
    buffer_load_dwordx4 v23, s[56:59], s79 offen offset:0 lds
    s_add_u32 m0, s77, 61440
    s_add_u32 s79, s73, 256
    buffer_load_dwordx4 v23, s[56:59], s79 offen offset:0 lds
    s_add_u32 s79, s73, 23808
    s_waitcnt vmcnt(5)
    buffer_load_dwordx4 v23, s[56:59], s79 offen offset:1024 lds
    s_add_u32 s79, s73, 47360
    s_waitcnt vmcnt(5)
    buffer_load_dwordx4 v23, s[56:59], s79 offen offset:2048 lds
    s_add_u32 s79, s73, 70912
    s_waitcnt vmcnt(5)
    buffer_load_dwordx4 v23, s[56:59], s79 offen offset:3072 lds
    s_add_u32 m0, s77, 65536
    s_add_u32 s79, s73, 98560
    s_waitcnt vmcnt(5)
    buffer_load_dwordx4 v23, s[56:59], s79 offen offset:0 lds
    ds_read_b32 v7, v5 offset:76
    s_waitcnt lgkmcnt(0)
    v_cmp_gt_u32 vcc, 16843009, v7
    s_cbranch_vccnz L_GC_p3_spin
L_GC_p3_ok:
    s_add_u32 m0, s77, 81920
    s_add_u32 s79, s74, 256
    s_waitcnt vmcnt(5)
    buffer_load_dwordx4 v23, s[56:59], s79 offen offset:0 lds
    s_add_u32 s79, s74, 23808
    s_waitcnt vmcnt(5)
    buffer_load_dwordx4 v23, s[56:59], s79 offen offset:1024 lds
    s_add_u32 s79, s74, 47360
    s_waitcnt vmcnt(5)
    buffer_load_dwordx4 v23, s[56:59], s79 offen offset:2048 lds
    s_add_u32 s79, s74, 70912
    s_waitcnt vmcnt(5)
    buffer_load_dwordx4 v23, s[56:59], s79 offen offset:3072 lds
    s_add_u32 m0, s77, 86016
    s_add_u32 s79, s74, 98560
    s_waitcnt vmcnt(5)
    buffer_load_dwordx4 v23, s[56:59], s79 offen offset:0 lds
    s_waitcnt vmcnt(0)
    ds_write_b8 v16, v4 offset:112
    ds_read_b32 v7, v5 offset:80
    s_waitcnt lgkmcnt(0)
    v_cmp_gt_u32 vcc, 16843009, v7
    s_cbranch_vccnz L_GC_p4_spin
L_GC_p4_ok:
    s_add_u32 m0, s77, 102400
    s_add_u32 s79, s75, 256
    buffer_load_dwordx4 v23, s[56:59], s79 offen offset:0 lds
    s_add_u32 s79, s75, 23808
    buffer_load_dwordx4 v23, s[56:59], s79 offen offset:1024 lds
    s_add_u32 s79, s75, 47360
    buffer_load_dwordx4 v23, s[56:59], s79 offen offset:2048 lds
    s_add_u32 s79, s75, 70912
    buffer_load_dwordx4 v23, s[56:59], s79 offen offset:3072 lds
    s_add_u32 m0, s77, 106496
    s_add_u32 s79, s75, 98560
    buffer_load_dwordx4 v23, s[56:59], s79 offen offset:0 lds
    s_waitcnt vmcnt(0)
    ds_write_b8 v16, v4 offset:116
    ds_read_b32 v7, v5 offset:84
    s_waitcnt lgkmcnt(0)
    v_cmp_gt_u32 vcc, 16843009, v7
    s_cbranch_vccnz L_GC_p5_spin
L_GC_p5_ok:
    s_nop 0
    s_add_u32 m0, s77, 122880
    s_add_u32 s79, s72, 384
    buffer_load_dwordx4 v23, s[56:59], s79 offen offset:0 lds
    s_add_u32 s79, s72, 23936
    buffer_load_dwordx4 v23, s[56:59], s79 offen offset:1024 lds
    s_add_u32 s79, s72, 47488
    buffer_load_dwordx4 v23, s[56:59], s79 offen offset:2048 lds
    s_add_u32 s79, s72, 71040
    buffer_load_dwordx4 v23, s[56:59], s79 offen offset:3072 lds
    s_add_u32 m0, s77, 126976
    s_add_u32 s79, s72, 98688
    buffer_load_dwordx4 v23, s[56:59], s79 offen offset:0 lds
    s_add_u32 m0, s77, 143360
    s_add_u32 s79, s73, 384
    buffer_load_dwordx4 v23, s[56:59], s79 offen offset:0 lds
    s_add_u32 s79, s73, 23936
    s_waitcnt vmcnt(5)
    buffer_load_dwordx4 v23, s[56:59], s79 offen offset:1024 lds
    s_add_u32 s79, s73, 47488
    s_waitcnt vmcnt(5)
    buffer_load_dwordx4 v23, s[56:59], s79 offen offset:2048 lds
    s_add_u32 s79, s73, 71040
    s_waitcnt vmcnt(5)
    buffer_load_dwordx4 v23, s[56:59], s79 offen offset:3072 lds
    s_add_u32 m0, s77, 147456
    s_add_u32 s79, s73, 98688
    s_waitcnt vmcnt(5)
    buffer_load_dwordx4 v23, s[56:59], s79 offen offset:0 lds
    ds_read_b32 v7, v5 offset:88
    s_waitcnt lgkmcnt(0)
    v_cmp_gt_u32 vcc, 16843009, v7
    s_cbranch_vccnz L_GC_p6_spin
L_GC_p6_ok:
    s_add_u32 m0, s77, 0
    s_add_u32 s79, s74, 384
    s_waitcnt vmcnt(5)
    buffer_load_dwordx4 v23, s[56:59], s79 offen offset:0 lds
    s_add_u32 s79, s74, 23936
    s_waitcnt vmcnt(5)
    buffer_load_dwordx4 v23, s[56:59], s79 offen offset:1024 lds
    s_add_u32 s79, s74, 47488
    s_waitcnt vmcnt(5)
    buffer_load_dwordx4 v23, s[56:59], s79 offen offset:2048 lds
    s_add_u32 s79, s74, 71040
    s_waitcnt vmcnt(5)
    buffer_load_dwordx4 v23, s[56:59], s79 offen offset:3072 lds
    s_add_u32 m0, s77, 4096
    s_add_u32 s79, s74, 98688
    s_waitcnt vmcnt(5)
    buffer_load_dwordx4 v23, s[56:59], s79 offen offset:0 lds
    s_waitcnt vmcnt(0)
    ds_write_b8 v16, v4 offset:120
    ds_read_b32 v7, v5 offset:92
    s_waitcnt lgkmcnt(0)
    v_cmp_gt_u32 vcc, 16843009, v7
    s_cbranch_vccnz L_GC_p7_spin
L_GC_p7_ok:
    s_nop 0
    s_add_u32 m0, s77, 40960
    s_add_u32 s79, s75, 384
    buffer_load_dwordx4 v23, s[56:59], s79 offen offset:0 lds
    s_add_u32 s79, s75, 23936
    buffer_load_dwordx4 v23, s[56:59], s79 offen offset:1024 lds
    s_add_u32 s79, s75, 47488
    buffer_load_dwordx4 v23, s[56:59], s79 offen offset:2048 lds
    s_add_u32 s79, s75, 71040
    buffer_load_dwordx4 v23, s[56:59], s79 offen offset:3072 lds
    s_add_u32 m0, s77, 45056
    s_add_u32 s79, s75, 98688
    buffer_load_dwordx4 v23, s[56:59], s79 offen offset:0 lds
    s_waitcnt vmcnt(0)
    ds_write_b8 v16, v4 offset:124
    s_endpgm
L_GC_p1_spin:
    s_mov_b32 s81, 0
L_GC_p1_chk:
    s_sleep 2
    ds_read_b32 v7, v5 offset:68
    s_add_u32 s81, s81, 1
    s_waitcnt lgkmcnt(0)
    v_cmp_gt_u32 vcc, 16843009, v7
    s_cmp_gt_u32 s81, 0x10000
    s_cbranch_scc1 L_GC_p1_ok
    s_cbranch_vccnz L_GC_p1_chk
    s_branch L_GC_p1_ok
L_GC_p2_spin:
    s_mov_b32 s81, 0
L_GC_p2_chk:
    s_sleep 2
    ds_read_b32 v7, v5 offset:72
    s_add_u32 s81, s81, 1
    s_waitcnt lgkmcnt(0)
    v_cmp_gt_u32 vcc, 16843009, v7
    s_cmp_gt_u32 s81, 0x10000
    s_cbranch_scc1 L_GC_p2_ok
    s_cbranch_vccnz L_GC_p2_chk
    s_branch L_GC_p2_ok
L_GC_p3_spin:
    s_mov_b32 s81, 0
L_GC_p3_chk:
    s_sleep 2
    ds_read_b32 v7, v5 offset:76
    s_add_u32 s81, s81, 1
    s_waitcnt lgkmcnt(0)
    v_cmp_gt_u32 vcc, 16843009, v7
    s_cmp_gt_u32 s81, 0x10000
    s_cbranch_scc1 L_GC_p3_ok
    s_cbranch_vccnz L_GC_p3_chk
    s_branch L_GC_p3_ok
L_GC_p4_spin:
    s_mov_b32 s81, 0
L_GC_p4_chk:
    s_sleep 2
    ds_read_b32 v7, v5 offset:80
    s_add_u32 s81, s81, 1
    s_waitcnt lgkmcnt(0)
    v_cmp_gt_u32 vcc, 16843009, v7
    s_cmp_gt_u32 s81, 0x10000
    s_cbranch_scc1 L_GC_p4_ok
    s_cbranch_vccnz L_GC_p4_chk
    s_branch L_GC_p4_ok
L_GC_p5_spin:
    s_mov_b32 s81, 0
L_GC_p5_chk:
    s_sleep 2
    ds_read_b32 v7, v5 offset:84
    s_add_u32 s81, s81, 1
    s_waitcnt lgkmcnt(0)
    v_cmp_gt_u32 vcc, 16843009, v7
    s_cmp_gt_u32 s81, 0x10000
    s_cbranch_scc1 L_GC_p5_ok
    s_cbranch_vccnz L_GC_p5_chk
    s_branch L_GC_p5_ok
L_GC_p6_spin:
    s_mov_b32 s81, 0
L_GC_p6_chk:
    s_sleep 2
    ds_read_b32 v7, v5 offset:88
    s_add_u32 s81, s81, 1
    s_waitcnt lgkmcnt(0)
    v_cmp_gt_u32 vcc, 16843009, v7
    s_cmp_gt_u32 s81, 0x10000
    s_cbranch_scc1 L_GC_p6_ok
    s_cbranch_vccnz L_GC_p6_chk
    s_branch L_GC_p6_ok
L_GC_p7_spin:
    s_mov_b32 s81, 0
L_GC_p7_chk:
    s_sleep 2
    ds_read_b32 v7, v5 offset:92
    s_add_u32 s81, s81, 1
    s_waitcnt lgkmcnt(0)
    v_cmp_gt_u32 vcc, 16843009, v7
    s_cmp_gt_u32 s81, 0x10000
    s_cbranch_scc1 L_GC_p7_ok
    s_cbranch_vccnz L_GC_p7_chk
    s_branch L_GC_p7_ok
.p2align 8
.type L_table,@object
L_table:
    .long 0x0, 0x0, 0x0, 0x0
    .long 0x0, 0x0, 0x0, 0x0
    .long 0x0, 0x0, 0x0, 0x0
    .long 0x0, 0x0, 0x0, 0x0
    .long 0x0, 0x0, 0x0, 0x0
    .long 0x0, 0x0, 0x0, 0x0
    .long 0x0, 0x0, 0x0, 0x0
    .long 0x0, 0x0, 0x0, 0x0
    .long 0x0, 0x0, 0x0, 0x0
    .long 0x0, 0x0, 0x0, 0x0
    .long 0x0, 0x0, 0x0, 0x0
    .long 0x0, 0x0, 0x0, 0x0
    .long 0x0, 0x0, 0x0, 0x0
    .long 0x0, 0x0, 0x0, 0x0
    .long 0x0, 0x0, 0x0, 0x0
    .long 0x0, 0x0, 0x0, 0x0
    .long 0x0, 0x3f800000, 0x3f803f80, 0x0
    .long 0x0, 0x0, 0x3f803f80, 0x3f80
    .long 0x0, 0x0, 0x3f800000, 0x3f803f80
    .long 0x0, 0x0, 0x0, 0x3f803f80
    .long 0x0, 0x0, 0x0, 0x3f800000
    .long 0x0, 0x0, 0x0, 0x0
    .long 0x0, 0x0, 0x0, 0x0
    .long 0x0, 0x0, 0x0, 0x0
    .long 0x0, 0x0, 0x0, 0x0
    .long 0x0, 0x0, 0x0, 0x0
    .long 0x0, 0x0, 0x0, 0x0
    .long 0x0, 0x0, 0x0, 0x0
    .long 0x0, 0x0, 0x0, 0x0
    .long 0x0, 0x0, 0x0, 0x0
    .long 0x0, 0x0, 0x0, 0x0
    .long 0x0, 0x0, 0x0, 0x0
    .long 0x0, 0x0, 0x0, 0x0
    .long 0x0, 0x0, 0x0, 0x0
    .long 0x0, 0x0, 0x0, 0x0
    .long 0x3f80, 0x0, 0x0, 0x0
    .long 0x3f803f80, 0x0, 0x0, 0x0
    .long 0x3f803f80, 0x3f80, 0x0, 0x0
    .long 0x3f800000, 0x3f803f80, 0x0, 0x0
    .long 0x0, 0x3f803f80, 0x3f80, 0x0
    .long 0x0, 0x3f800000, 0x3f803f80, 0x0
    .long 0x0, 0x0, 0x3f803f80, 0x3f80
    .long 0x0, 0x0, 0x3f800000, 0x3f803f80
    .long 0x0, 0x0, 0x0, 0x3f803f80
    .long 0x0, 0x0, 0x0, 0x3f800000
    .long 0x0, 0x0, 0x0, 0x0
    .long 0x0, 0x0, 0x0, 0x0
    .long 0x0, 0x0, 0x0, 0x0
    .long 0x0, 0x0, 0x0, 0x0
    .long 0x0, 0x0, 0x0, 0x0
    .long 0x0, 0x0, 0x0, 0x0
    .long 0x0, 0x0, 0x0, 0x0
    .long 0x0, 0x0, 0x0, 0x0
    .long 0x0, 0x0, 0x0, 0x0
    .long 0x0, 0x0, 0x0, 0x0
    .long 0x0, 0x0, 0x0, 0x0
    .long 0x0, 0x0, 0x0, 0x0
    .long 0x0, 0x0, 0x0, 0x0
    .long 0x0, 0x0, 0x0, 0x0
    .long 0x3f80, 0x0, 0x0, 0x0
    .long 0x3f803f80, 0x0, 0x0, 0x0
    .long 0x3f803f80, 0x3f80, 0x0, 0x0
    .long 0x3f800000, 0x3f803f80, 0x0, 0x0
    .long 0x0, 0x3f803f80, 0x3f80, 0x0
    .long 0x0, 0x0, 0x0, 0x3f803f80
    .long 0x0, 0x0, 0x0, 0x3f800000
    .long 0x0, 0x0, 0x0, 0x0
    .long 0x0, 0x0, 0x0, 0x0
    .long 0x0, 0x0, 0x0, 0x0
    .long 0x0, 0x0, 0x0, 0x0
    .long 0x0, 0x0, 0x0, 0x0
    .long 0x0, 0x0, 0x0, 0x0
    .long 0x0, 0x0, 0x0, 0x0
    .long 0x0, 0x0, 0x0, 0x0
    .long 0x0, 0x0, 0x0, 0x0
    .long 0x0, 0x0, 0x0, 0x0
    .long 0x0, 0x0, 0x0, 0x0
    .long 0x0, 0x0, 0x0, 0x0
    .long 0x0, 0x0, 0x0, 0x0
    .long 0x0, 0x0, 0x0, 0x0
    .long 0x3f803f80, 0x3f80, 0x0, 0x0
    .long 0x3f803f80, 0x3f803f80, 0x0, 0x0
    .long 0x3f803f80, 0x3f803f80, 0x3f80, 0x0
    .long 0x3f800000, 0x3f803f80, 0x3f803f80, 0x0
    .long 0x0, 0x3f803f80, 0x3f803f80, 0x3f80
    .long 0x0, 0x3f800000, 0x3f803f80, 0x3f803f80
    .long 0x0, 0x0, 0x3f803f80, 0x3f803f80
    .long 0x0, 0x0, 0x3f800000, 0x3f803f80
    .long 0x0, 0x0, 0x0, 0x3f803f80
    .long 0x0, 0x0, 0x0, 0x3f800000
    .long 0x0, 0x0, 0x0, 0x0
    .long 0x0, 0x0, 0x0, 0x0
    .long 0x0, 0x0, 0x0, 0x0
    .long 0x0, 0x0, 0x0, 0x0
    .long 0x0, 0x0, 0x0, 0x0
    .long 0x0, 0x0, 0x0, 0x0
    .long 0x0, 0x0, 0x0, 0x0
    .long 0x0, 0x0, 0x0, 0x0
    .long 0x0, 0x0, 0x0, 0x0
    .long 0x0, 0x0, 0x0, 0x0
    .long 0x0, 0x0, 0x0, 0x0
    .long 0x0, 0x0, 0x0, 0x0
    .long 0x3f80, 0x0, 0x0, 0x0
    .long 0x3f803f80, 0x0, 0x0, 0x0
    .long 0x3f803f80, 0x3f80, 0x0, 0x0
    .long 0x3f803f80, 0x3f803f80, 0x0, 0x0
    .long 0x3f803f80, 0x3f803f80, 0x3f80, 0x0
    .long 0x3f800000, 0x3f803f80, 0x3f803f80, 0x0
    .long 0x0, 0x3f803f80, 0x3f803f80, 0x3f80
    .long 0x0, 0x3f800000, 0x3f803f80, 0x3f803f80
    .long 0x0, 0x0, 0x3f803f80, 0x3f803f80
    .long 0x0, 0x0, 0x3f800000, 0x3f803f80
    .long 0x0, 0x0, 0x0, 0x0
    .long 0x0, 0x0, 0x0, 0x0
    .long 0x0, 0x0, 0x0, 0x0
    .long 0x0, 0x0, 0x0, 0x0
    .long 0x0, 0x0, 0x0, 0x0
    .long 0x0, 0x0, 0x0, 0x0
    .long 0x0, 0x0, 0x0, 0x0
    .long 0x0, 0x0, 0x0, 0x0
    .long 0x0, 0x0, 0x0, 0x0
    .long 0x0, 0x0, 0x0, 0x0
    .long 0x0, 0x0, 0x0, 0x0
    .long 0x0, 0x0, 0x0, 0x0
    .long 0x0, 0x0, 0x0, 0x0
    .long 0x0, 0x0, 0x0, 0x0
    .long 0x3f80, 0x0, 0x0, 0x0
    .long 0x3f803f80, 0x0, 0x0, 0x0
    .long 0x0, 0x0, 0x0, 0x0
    .long 0x0, 0x0, 0x0, 0x0
    .long 0x0, 0x0, 0x0, 0x0
    .long 0x0, 0x0, 0x0, 0x0
    .long 0x0, 0x0, 0x0, 0x0
    .long 0x0, 0x0, 0x0, 0x0
    .long 0x0, 0x0, 0x0, 0x0
    .long 0x0, 0x0, 0x0, 0x0
    .long 0x0, 0x0, 0x0, 0x0
    .long 0x0, 0x0, 0x0, 0x0
    .long 0x0, 0x0, 0x0, 0x0
    .long 0x0, 0x0, 0x0, 0x0
    .long 0x0, 0x0, 0x0, 0x0
    .long 0x0, 0x0, 0x0, 0x0
    .long 0x0, 0x0, 0x0, 0x0
    .long 0x0, 0x0, 0x0, 0x0
    .long 0x0, 0x3f800000, 0x3f803f80, 0x0
    .long 0x0, 0x0, 0x3f803f80, 0x3f80
    .long 0x0, 0x0, 0x3f800000, 0x3f803f80
    .long 0x0, 0x0, 0x0, 0x3f803f80
    .long 0x0, 0x0, 0x0, 0x3f800000
    .long 0x0, 0x0, 0x0, 0x0
    .long 0x0, 0x0, 0x0, 0x0
    .long 0x0, 0x0, 0x0, 0x0
    .long 0x0, 0x0, 0x0, 0x0
    .long 0x0, 0x0, 0x0, 0x0
    .long 0x0, 0x0, 0x0, 0x0
    .long 0x0, 0x0, 0x0, 0x0
    .long 0x0, 0x0, 0x0, 0x0
    .long 0x0, 0x0, 0x0, 0x0
    .long 0x0, 0x0, 0x0, 0x0
    .long 0x0, 0x0, 0x0, 0x0
    .long 0x0, 0x0, 0x0, 0x0
    .long 0x0, 0x0, 0x0, 0x0
    .long 0x0, 0x0, 0x0, 0x0
    .long 0x3f80, 0x0, 0x0, 0x0
    .long 0x3f803f80, 0x0, 0x0, 0x0
    .long 0x3f803f80, 0x3f80, 0x0, 0x0
    .long 0x3f800000, 0x3f803f80, 0x0, 0x0
    .long 0x0, 0x3f803f80, 0x3f80, 0x0
    .long 0x0, 0x3f800000, 0x3f803f80, 0x0
    .long 0x0, 0x0, 0x3f803f80, 0x3f80
    .long 0x0, 0x0, 0x3f800000, 0x3f803f80
    .long 0x0, 0x0, 0x0, 0x3f803f80
    .long 0x0, 0x0, 0x0, 0x3f800000
    .long 0x0, 0x0, 0x0, 0x0
    .long 0x0, 0x0, 0x0, 0x0
    .long 0x0, 0x0, 0x0, 0x0
    .long 0x0, 0x0, 0x0, 0x0
    .long 0x0, 0x0, 0x0, 0x0
    .long 0x0, 0x0, 0x0, 0x0
    .long 0x0, 0x0, 0x0, 0x0
    .long 0x0, 0x0, 0x0, 0x0
    .long 0x0, 0x0, 0x0, 0x0
    .long 0x0, 0x0, 0x0, 0x0
    .long 0x0, 0x0, 0x0, 0x0
    .long 0x0, 0x0, 0x0, 0x0
    .long 0x0, 0x0, 0x0, 0x0
    .long 0x0, 0x0, 0x0, 0x0
    .long 0x3f80, 0x0, 0x0, 0x0
    .long 0x3f803f80, 0x0, 0x0, 0x0
    .long 0x3f803f80, 0x3f80, 0x0, 0x0
    .long 0x3f800000, 0x3f803f80, 0x0, 0x0
    .long 0x0, 0x3f803f80, 0x3f80, 0x0
    .long 0x0, 0x0, 0x0, 0x3f803f80
    .long 0x0, 0x0, 0x0, 0x3f800000
    .long 0x0, 0x0, 0x0, 0x0
    .long 0x0, 0x0, 0x0, 0x0
    .long 0x0, 0x0, 0x0, 0x0
    .long 0x0, 0x0, 0x0, 0x0
    .long 0x0, 0x0, 0x0, 0x0
    .long 0x0, 0x0, 0x0, 0x0
    .long 0x0, 0x0, 0x0, 0x0
    .long 0x0, 0x0, 0x0, 0x0
    .long 0x0, 0x0, 0x0, 0x0
    .long 0x0, 0x0, 0x0, 0x0
    .long 0x0, 0x0, 0x0, 0x0
    .long 0x0, 0x0, 0x0, 0x0
    .long 0x0, 0x0, 0x0, 0x0
    .long 0x0, 0x0, 0x0, 0x0
    .long 0x3f803f80, 0x3f80, 0x0, 0x0
    .long 0x3f803f80, 0x3f803f80, 0x0, 0x0
    .long 0x3f803f80, 0x3f803f80, 0x3f80, 0x0
    .long 0x3f800000, 0x3f803f80, 0x3f803f80, 0x0
    .long 0x0, 0x3f803f80, 0x3f803f80, 0x3f80
    .long 0x0, 0x3f800000, 0x3f803f80, 0x3f803f80
    .long 0x0, 0x0, 0x3f803f80, 0x3f803f80
    .long 0x0, 0x0, 0x3f800000, 0x3f803f80
    .long 0x0, 0x0, 0x0, 0x3f803f80
    .long 0x0, 0x0, 0x0, 0x3f800000
    .long 0x0, 0x0, 0x0, 0x0
    .long 0x0, 0x0, 0x0, 0x0
    .long 0x0, 0x0, 0x0, 0x0
    .long 0x0, 0x0, 0x0, 0x0
    .long 0x0, 0x0, 0x0, 0x0
    .long 0x0, 0x0, 0x0, 0x0
    .long 0x0, 0x0, 0x0, 0x0
    .long 0x0, 0x0, 0x0, 0x0
    .long 0x0, 0x0, 0x0, 0x0
    .long 0x0, 0x0, 0x0, 0x0
    .long 0x0, 0x0, 0x0, 0x0
    .long 0x0, 0x0, 0x0, 0x0
    .long 0x3f80, 0x0, 0x0, 0x0
    .long 0x3f803f80, 0x0, 0x0, 0x0
    .long 0x3f803f80, 0x3f80, 0x0, 0x0
    .long 0x3f803f80, 0x3f803f80, 0x0, 0x0
    .long 0x3f803f80, 0x3f803f80, 0x3f80, 0x0
    .long 0x3f800000, 0x3f803f80, 0x3f803f80, 0x0
    .long 0x0, 0x3f803f80, 0x3f803f80, 0x3f80
    .long 0x0, 0x3f800000, 0x3f803f80, 0x3f803f80
    .long 0x0, 0x0, 0x3f803f80, 0x3f803f80
    .long 0x0, 0x0, 0x3f800000, 0x3f803f80
    .long 0x0, 0x0, 0x0, 0x0
    .long 0x0, 0x0, 0x0, 0x0
    .long 0x0, 0x0, 0x0, 0x0
    .long 0x0, 0x0, 0x0, 0x0
    .long 0x0, 0x0, 0x0, 0x0
    .long 0x0, 0x0, 0x0, 0x0
    .long 0x0, 0x0, 0x0, 0x0
    .long 0x0, 0x0, 0x0, 0x0
    .long 0x0, 0x0, 0x0, 0x0
    .long 0x0, 0x0, 0x0, 0x0
    .long 0x0, 0x0, 0x0, 0x0
    .long 0x0, 0x0, 0x0, 0x0
    .long 0x0, 0x0, 0x0, 0x0
    .long 0x0, 0x0, 0x0, 0x0
    .long 0x3f80, 0x0, 0x0, 0x0
    .long 0x3f803f80, 0x0, 0x0, 0x0
    .long 0x0, 0x0, 0x3f800000, 0x3f803f80
    .long 0x0, 0x0, 0x0, 0x3f803f80
    .long 0x0, 0x0, 0x0, 0x3f800000
    .long 0x0, 0x0, 0x0, 0x0
    .long 0x0, 0x0, 0x0, 0x0
    .long 0x0, 0x0, 0x0, 0x0
    .long 0x0, 0x0, 0x0, 0x0
    .long 0x0, 0x0, 0x0, 0x0
    .long 0x0, 0x0, 0x0, 0x0
    .long 0x0, 0x0, 0x0, 0x0
    .long 0x0, 0x0, 0x0, 0x0
    .long 0x0, 0x0, 0x0, 0x0
    .long 0x0, 0x0, 0x0, 0x0
    .long 0x0, 0x0, 0x0, 0x0
    .long 0x0, 0x0, 0x0, 0x0
    .long 0x0, 0x0, 0x0, 0x0
    .long 0x3f803f80, 0x3f803f80, 0x0, 0x0
    .long 0x3f803f80, 0x3f803f80, 0x3f80, 0x0
    .long 0x3f803f80, 0x3f803f80, 0x3f803f80, 0x0
    .long 0x3f803f80, 0x3f803f80, 0x3f803f80, 0x3f80
    .long 0x3f800000, 0x3f803f80, 0x3f803f80, 0x3f803f80
    .long 0x0, 0x3f803f80, 0x3f803f80, 0x3f803f80
    .long 0x0, 0x3f800000, 0x3f803f80, 0x3f803f80
    .long 0x0, 0x0, 0x3f803f80, 0x3f803f80
    .long 0x0, 0x0, 0x3f800000, 0x3f803f80
    .long 0x0, 0x0, 0x0, 0x3f803f80
    .long 0x0, 0x0, 0x0, 0x3f800000
    .long 0x0, 0x0, 0x0, 0x0
    .long 0x0, 0x0, 0x0, 0x0
    .long 0x0, 0x0, 0x0, 0x0
    .long 0x0, 0x0, 0x0, 0x0
    .long 0x0, 0x0, 0x0, 0x0
    .long 0x0, 0x0, 0x0, 0x0
    .long 0x0, 0x0, 0x0, 0x0
    .long 0x0, 0x0, 0x0, 0x0
    .long 0x0, 0x0, 0x0, 0x0
    .long 0x0, 0x0, 0x0, 0x0
    .long 0x3f80, 0x0, 0x0, 0x0
    .long 0x3f803f80, 0x0, 0x0, 0x0
    .long 0x3f803f80, 0x3f80, 0x0, 0x0
    .long 0x3f803f80, 0x3f803f80, 0x0, 0x0
    .long 0x3f803f80, 0x3f803f80, 0x3f80, 0x0
    .long 0x3f803f80, 0x3f803f80, 0x3f803f80, 0x0
    .long 0x3f803f80, 0x3f803f80, 0x3f803f80, 0x3f80
    .long 0x3f800000, 0x3f803f80, 0x3f803f80, 0x3f803f80
    .long 0x0, 0x3f803f80, 0x3f803f80, 0x3f803f80
    .long 0x0, 0x3f800000, 0x3f803f80, 0x3f803f80
    .long 0x0, 0x0, 0x3f803f80, 0x3f803f80
    .long 0x0, 0x0, 0x0, 0x0
    .long 0x0, 0x0, 0x0, 0x0
    .long 0x0, 0x0, 0x0, 0x0
    .long 0x0, 0x0, 0x0, 0x0
    .long 0x0, 0x0, 0x0, 0x0
    .long 0x0, 0x0, 0x0, 0x0
    .long 0x0, 0x0, 0x0, 0x0
    .long 0x0, 0x0, 0x0, 0x0
    .long 0x0, 0x0, 0x0, 0x0
    .long 0x0, 0x0, 0x0, 0x0
    .long 0x0, 0x0, 0x0, 0x0
    .long 0x0, 0x0, 0x0, 0x0
    .long 0x0, 0x0, 0x0, 0x0
    .long 0x3f80, 0x0, 0x0, 0x0
    .long 0x3f803f80, 0x0, 0x0, 0x0
    .long 0x3f803f80, 0x3f80, 0x0, 0x0
    .long 0x0, 0x0, 0x3f803f80, 0x3f803f80
    .long 0x0, 0x0, 0x3f800000, 0x3f803f80
    .long 0x0, 0x0, 0x0, 0x3f803f80
    .long 0x0, 0x0, 0x0, 0x3f800000
    .long 0x0, 0x0, 0x0, 0x0
    .long 0x0, 0x0, 0x0, 0x0
    .long 0x0, 0x0, 0x0, 0x0
    .long 0x0, 0x0, 0x0, 0x0
    .long 0x0, 0x0, 0x0, 0x0
    .long 0x0, 0x0, 0x0, 0x0
    .long 0x0, 0x0, 0x0, 0x0
    .long 0x0, 0x0, 0x0, 0x0
    .long 0x0, 0x0, 0x0, 0x0
    .long 0x0, 0x0, 0x0, 0x0
    .long 0x0, 0x0, 0x0, 0x0
    .long 0x0, 0x0, 0x0, 0x0
    .long 0x3f803f80, 0x3f803f80, 0x3f80, 0x0
    .long 0x3f803f80, 0x3f803f80, 0x3f803f80, 0x0
    .long 0x3f803f80, 0x3f803f80, 0x3f803f80, 0x3f80
    .long 0x3f803f80, 0x3f803f80, 0x3f803f80, 0x3f803f80
    .long 0x3f803f80, 0x3f803f80, 0x3f803f80, 0x3f803f80
    .long 0x3f800000, 0x3f803f80, 0x3f803f80, 0x3f803f80
    .long 0x0, 0x3f803f80, 0x3f803f80, 0x3f803f80
    .long 0x0, 0x3f800000, 0x3f803f80, 0x3f803f80
    .long 0x0, 0x0, 0x3f803f80, 0x3f803f80
    .long 0x0, 0x0, 0x3f800000, 0x3f803f80
    .long 0x0, 0x0, 0x0, 0x3f803f80
    .long 0x0, 0x0, 0x0, 0x3f800000
    .long 0x0, 0x0, 0x0, 0x0
    .long 0x0, 0x0, 0x0, 0x0
    .long 0x0, 0x0, 0x0, 0x0
    .long 0x0, 0x0, 0x0, 0x0
    .long 0x0, 0x0, 0x0, 0x0
    .long 0x0, 0x0, 0x0, 0x0
    .long 0x0, 0x0, 0x0, 0x0
    .long 0x0, 0x0, 0x0, 0x0
    .long 0x3f80, 0x0, 0x0, 0x0
    .long 0x3f803f80, 0x0, 0x0, 0x0
    .long 0x3f803f80, 0x3f80, 0x0, 0x0
    .long 0x3f803f80, 0x3f803f80, 0x0, 0x0
    .long 0x3f803f80, 0x3f803f80, 0x3f80, 0x0
    .long 0x3f803f80, 0x3f803f80, 0x3f803f80, 0x0
    .long 0x3f803f80, 0x3f803f80, 0x3f803f80, 0x3f80
    .long 0x3f803f80, 0x3f803f80, 0x3f803f80, 0x3f803f80
    .long 0x3f803f80, 0x3f803f80, 0x3f803f80, 0x3f803f80
    .long 0x3f800000, 0x3f803f80, 0x3f803f80, 0x3f803f80
    .long 0x0, 0x3f803f80, 0x3f803f80, 0x3f803f80
    .long 0x0, 0x3f800000, 0x3f803f80, 0x3f803f80
    .long 0x0, 0x0, 0x0, 0x0
    .long 0x0, 0x0, 0x0, 0x0
    .long 0x0, 0x0, 0x0, 0x0
    .long 0x0, 0x0, 0x0, 0x0
    .long 0x0, 0x0, 0x0, 0x0
    .long 0x0, 0x0, 0x0, 0x0
    .long 0x0, 0x0, 0x0, 0x0
    .long 0x0, 0x0, 0x0, 0x0
    .long 0x0, 0x0, 0x0, 0x0
    .long 0x0, 0x0, 0x0, 0x0
    .long 0x0, 0x0, 0x0, 0x0
    .long 0x0, 0x0, 0x0, 0x0
    .long 0x3f80, 0x0, 0x0, 0x0
    .long 0x3f803f80, 0x0, 0x0, 0x0
    .long 0x3f803f80, 0x3f80, 0x0, 0x0
    .long 0x3f803f80, 0x3f803f80, 0x0, 0x0
    .long 0x0, 0x0, 0x0, 0x0
    .long 0x0, 0x0, 0x0, 0x0
    .long 0x0, 0x0, 0x0, 0x0
    .long 0x0, 0x0, 0x0, 0x0
    .long 0x0, 0x0, 0x0, 0x0
    .long 0x0, 0x0, 0x0, 0x0
    .long 0x0, 0x0, 0x0, 0x0
    .long 0x0, 0x0, 0x0, 0x0
    .long 0x0, 0x0, 0x0, 0x0
    .long 0x0, 0x0, 0x0, 0x0
    .long 0x0, 0x0, 0x0, 0x0
    .long 0x0, 0x0, 0x0, 0x0
    .long 0x0, 0x0, 0x0, 0x0
    .long 0x0, 0x0, 0x0, 0x0
    .long 0x0, 0x0, 0x0, 0x0
    .long 0x0, 0x0, 0x0, 0x0
    .long 0x0, 0x0, 0xffffffff, 0x0
    .long 0x0, 0x0, 0xffff0000, 0xffff
    .long 0x0, 0x0, 0x0, 0xffffffff
    .long 0x0, 0x0, 0x0, 0xffff0000
    .long 0x0, 0x0, 0x0, 0x0
    .long 0x0, 0x0, 0x0, 0x0
    .long 0x0, 0x0, 0x0, 0x0
    .long 0x0, 0x0, 0x0, 0x0
    .long 0x0, 0x0, 0x0, 0x0
    .long 0x0, 0x0, 0x0, 0x0
    .long 0x0, 0x0, 0x0, 0x0
    .long 0x0, 0x0, 0x0, 0x0
    .long 0x0, 0x0, 0x0, 0x0
    .long 0x0, 0x0, 0x0, 0x0
    .long 0x0, 0x0, 0x0, 0x0
    .long 0x0, 0x0, 0x0, 0x0
    .long 0x0, 0x0, 0x0, 0x0
    .long 0x0, 0x0, 0x0, 0x0
    .long 0x0, 0x0, 0x0, 0x0
    .long 0xffff, 0x0, 0x0, 0x0
    .long 0xffffffff, 0x0, 0x0, 0x0
    .long 0xffff0000, 0xffff, 0x0, 0x0
    .long 0x0, 0xffffffff, 0x0, 0x0
    .long 0x0, 0xffff0000, 0xffff, 0x0
    .long 0x0, 0x0, 0xffffffff, 0x0
    .long 0x0, 0x0, 0xffff0000, 0xffff
    .long 0x0, 0x0, 0x0, 0xffffffff
    .long 0x0, 0x0, 0x0, 0xffff0000
    .long 0x0, 0x0, 0x0, 0x0
    .long 0x0, 0x0, 0x0, 0x0
    .long 0x0, 0x0, 0x0, 0x0
    .long 0x0, 0x0, 0x0, 0x0
    .long 0x0, 0x0, 0x0, 0x0
    .long 0x0, 0x0, 0x0, 0x0
    .long 0x0, 0x0, 0x0, 0x0
    .long 0x0, 0x0, 0x0, 0x0
    .long 0x0, 0x0, 0x0, 0x0
    .long 0x0, 0x0, 0x0, 0x0
    .long 0x0, 0x0, 0x0, 0x0
    .long 0x0, 0x0, 0x0, 0x0
    .long 0x0, 0x0, 0x0, 0x0
    .long 0x0, 0x0, 0x0, 0x0
    .long 0x0, 0x0, 0x0, 0x0
    .long 0xffff, 0x0, 0x0, 0x0
    .long 0xffffffff, 0x0, 0x0, 0x0
    .long 0xffff0000, 0xffff, 0x0, 0x0
    .long 0x0, 0xffffffff, 0x0, 0x0
    .long 0x0, 0xffff0000, 0xffff, 0x0
L_table_end:
.size L_table, L_table_end-L_table
.section .rodata,"a"
.p2align 6
.amdhsa_kernel parallel_sum__ssm_conv_s4__mixer_channel_mlp__prompt_kernel
  .amdhsa_next_free_vgpr 256
  .amdhsa_next_free_sgpr 102
  .amdhsa_accum_offset 136
  .amdhsa_group_segment_fixed_size 0
  .amdhsa_kernarg_size 136
  .amdhsa_user_sgpr_count 2
  .amdhsa_user_sgpr_kernarg_segment_ptr 1
  .amdhsa_system_sgpr_workgroup_id_x 1
.end_amdhsa_kernel
```
